```python
import torch

def _softmax(x, axis=-1):
    return torch.softmax(x, dim=axis)
def _gelu(x):
    return torch.nn.functional.gelu(x, approximate="tanh")
def _silu(x):
    return torch.nn.functional.silu(x)
def _sigmoid(x):
    return torch.sigmoid(x)
def _layernorm(x, axis=-1, eps=1e-5):
    m = x.mean(dim=axis, keepdim=True)
    v = x.var(dim=axis, keepdim=True, unbiased=False)
    return (x - m) / torch.sqrt(v + eps)
def _scatter_add(tgt, idx, src, axis=0):
    return tgt.clone().index_add_(axis, idx, src)
def _segment_sum(src, seg, n):
    out = torch.zeros((n,) + src.shape[1:], dtype=src.dtype)
    return out.index_add_(0, seg, src)
def _pad(x, pw):
    flat = tuple(v for pair in reversed(pw) for v in pair)
    return torch.nn.functional.pad(x, flat)

kernel_name = 'interleave_layers__mha_block_cached__glu_gated_geglu__decode'

def setup_inputs():

    _w = (lambda a: (lambda t: t.to(torch.bfloat16) if t.is_floating_point() else t)(torch.as_tensor(a)))
    def _A_setup():
        B, Sq, D = 2, 1, 576
        H, Sk, Dh = 32, 8192, 128
        return {
            "x": _w((lambda *s: torch.randn(*s, dtype=torch.bfloat16) * 0.05)(B, Sq, D)),
            "k_cache": _w((lambda *s: torch.randn(*s, dtype=torch.bfloat16) * 0.8)(B, H, Sk, Dh)),
            "v_cache": _w((lambda *s: torch.randn(*s, dtype=torch.bfloat16) * 1.6)(B, H, Sk, Dh)),
            "wq": _w((lambda *s: torch.randn(*s, dtype=torch.bfloat16) * 0.8)(D, H * Dh) * (D ** -0.5)),
            "wo": _w((lambda *s: torch.randn(*s, dtype=torch.bfloat16) * 1.6)(H * Dh, D) * ((H * Dh) ** -0.5)),
        }
    _A_in = _A_setup()

    def _B_setup():
        B, S, Dm, Df = 2, 1, 576, 4608
        return {
            "x": _w((lambda *s: torch.randn(*s, dtype=torch.bfloat16) * 0.05)(B, S, Dm)),
            "w_gate": _w((lambda *s: torch.randn(*s, dtype=torch.bfloat16) * 0.8)(Dm, Df) * (Dm ** -0.5)),
            "w_up": _w((lambda *s: torch.randn(*s, dtype=torch.bfloat16) * 0.8)(Dm, Df) * (Dm ** -0.5)),
            "w_down": _w((lambda *s: torch.randn(*s, dtype=torch.bfloat16) * 0.8)(Df, Dm) * (Df ** -0.5)),
        }
    _B_in = _B_setup()

    return {
        "A_x": _A_in["x"],
        "A_k_cache": _A_in["k_cache"],
        "A_v_cache": _A_in["v_cache"],
        "A_wq": _A_in["wq"],
        "A_wo": _A_in["wo"],
        "B_x": _B_in["x"],
        "B_w_gate": _B_in["w_gate"],
        "B_w_up": _B_in["w_up"],
        "B_w_down": _B_in["w_down"],
    }

def reference(A_x, A_k_cache, A_v_cache, A_wq, A_wo, B_x, B_w_gate, B_w_up, B_w_down):
    def _A_ref(x, k_cache, v_cache, wq, wo):
        B, Sq, D = x.shape
        H, Dh = 32, 128
        q = (lambda x, *d: x.permute(*d))((x @ wq).reshape(B, Sq, H, Dh), 0, 2, 1, 3)
        scores = torch.einsum("bhqd,bhkd->bhqk", q, k_cache) * (Dh ** -0.5)
        p = _softmax(scores, axis=-1)
        o = torch.einsum("bhqk,bhkd->bhqd", p, v_cache)
        return (lambda x, *d: x.permute(*d))(o, 0, 2, 1, 3).reshape(B, Sq, H * Dh) @ wo

    def _B_ref(x, w_gate, w_up, w_down):
        g = torch.einsum("bsd,df->bsf", x, w_gate)
        u = torch.einsum("bsd,df->bsf", x, w_up)
        h = _gelu(g) * u
        return torch.einsum("bsf,fd->bsd", h, w_down)

    x = A_x
    x = x + _A_ref(_layernorm(x, axis=-1), A_k_cache, A_v_cache, A_wq, A_wo)
    x = x + _B_ref(_layernorm(x, axis=-1), B_w_gate, B_w_up, B_w_down)
    x = x + _A_ref(_layernorm(x, axis=-1), A_k_cache, A_v_cache, A_wq, A_wo)
    x = x + _B_ref(_layernorm(x, axis=-1), B_w_gate, B_w_up, B_w_down)
    return x
```

```asm
; @launch grid=(256,1,1) block=(256,1,1) lds=163840
.amdgcn_target "amdgcn-amd-amdhsa--gfx950"
.text
.globl interleave_layers__mha_block_cached__glu_gated_geglu__decode_kernel
.p2align 8
.type interleave_layers__mha_block_cached__glu_gated_geglu__decode_kernel,@function
interleave_layers__mha_block_cached__glu_gated_geglu__decode_kernel:
    s_cmp_ge_u32 s2, 256
    s_cbranch_scc1 L_end
    s_load_dwordx16 s[64:79], s[0:1], 0
    s_load_dwordx8 s[80:87], s[0:1], 64
    v_lshrrev_b32 v1, 6, v0
    v_lshlrev_b32 v13, 4, v0
    v_readfirstlane_b32 s3, v1
    v_and_b32 v0, 63, v0
    s_nop 0
    s_getpc_b64 s[98:99]
C1:
    s_add_u32 s98, s98, L_0-C1
    s_addc_u32 s99, s99, 0
    v_lshl_add_u32 v48, s3, 6, v0
    v_lshlrev_b32 v48, 6, v48
    v_min_u32 v50, L_end-L_0, v48
    v_mov_b32 v51, s99
    v_add_co_u32 v50, vcc, s98, v50
    s_nop 1
    v_addc_co_u32 v51, vcc, 0, v51, vcc
    global_load_dword v5, v[50:51], off
    v_add_u32 v48, 0x4000, v48
L_0:
    s_and_b32 s4, s2, 7
    s_lshl_b32 s4, s4, 5
    s_and_b32 s5, s2, 24
    s_or_b32 s4, s4, s5
    s_lshr_b32 s2, s2, 5
    s_or_b32 s2, s2, s4
    s_lshr_b32 s4, s2, 3
    s_and_b32 s5, s2, 7
    s_mov_b32 s6, 400000
    v_lshlrev_b32 v1, 3, v0
    s_lshl_b32 s7, s2, 2
    s_add_u32 s7, s7, s3
    s_lshr_b32 s101, s7, 5
    s_and_b32 s60, s7, 31
    s_sub_u32 s7, s7, s60
    s_lshl_b32 s7, s7, 16
    s_mul_i32 s60, s60, 4096
    s_add_u32 s7, s7, s60
    v_lshl_add_u32 v3, v0, 4, s7
    v_bfe_u32 v10, v0, 2, 2
    v_lshl_add_u32 v2, v10, 8, s7
    v_lshrrev_b32 v10, 4, v0
    v_lshl_add_u32 v2, v10, 6, v2
    v_and_b32 v10, 3, v0
    v_lshl_add_u32 v2, v10, 4, v2
    s_mul_i32 s62, s3, 14336
    s_add_u32 s62, s62, 18432
    s_mul_i32 s101, s101, 4
    s_lshl_b32 s101, s101, 15
    s_mov_b32 s10, 134217728
    s_mov_b32 s11, 0x20000
    s_waitcnt lgkmcnt(0)
    s_mov_b32 s8, s66
    s_and_b32 s9, s67, 0xffff
    s_add_u32 s63, s101, 0
    s_and_b32 s63, s63, 0x1fffff
    s_add_u32 m0, s62, 0
    s_nop 0
    buffer_load_dwordx4 v2, s[8:11], s63 offen offset:0 nt lds
    buffer_load_dwordx4 v[56:59], v2, s[8:11], s63 offen offset:1024 nt
    s_add_u32 m0, s62, 4294966272
    s_nop 0
    buffer_load_dwordx4 v2, s[8:11], s63 offen offset:2048 nt lds
    buffer_load_dwordx4 v[60:63], v2, s[8:11], s63 offen offset:3072 nt
    s_mov_b32 s14, 134217728
    s_mov_b32 s15, 0x20000
    s_mov_b32 s12, s68
    s_and_b32 s13, s69, 0xffff
    s_mov_b32 s18, 4718592
    s_mov_b32 s19, 0x20000
    s_mov_b32 s16, s70
    s_and_b32 s17, s71, 0xffff
    s_mov_b32 s22, 4718592
    s_mov_b32 s23, 0x20000
    s_mov_b32 s20, s72
    s_and_b32 s21, s73, 0xffff
    s_mov_b32 s26, 5308416
    s_mov_b32 s27, 0x20000
    s_mov_b32 s24, s76
    s_and_b32 s25, s77, 0xffff
    s_mov_b32 s30, 5308416
    s_mov_b32 s31, 0x20000
    s_mov_b32 s28, s78
    s_and_b32 s29, s79, 0xffff
    s_mov_b32 s34, 5308416
    s_mov_b32 s35, 0x20000
    s_mov_b32 s32, s80
    s_and_b32 s33, s81, 0xffff
    s_mov_b32 s38, 2304
    s_mov_b32 s39, 0x20000
    s_mov_b32 s36, s64
    s_and_b32 s37, s65, 0xffff
    s_mov_b32 s42, 2304
    s_mov_b32 s43, 0x20000
    s_mov_b32 s40, s82
    s_and_b32 s41, s83, 0xffff
    s_mov_b32 s46, 256
    s_mov_b32 s47, 0x20000
    s_mov_b32 s44, s84
    s_and_b32 s45, s85, 0xffff
    s_mov_b32 s50, 536870912
    s_mov_b32 s51, 0x20000
    s_mov_b32 s48, s86
    s_and_b32 s49, s87, 0xffff
    s_mov_b32 s52, 0xf000f
    s_mov_b32 s53, 0xf000f
    s_mov_b32 s54, 0xf000f0
    s_mov_b32 s55, 0xf000f0
    s_mov_b32 s56, 0xf000f00
    s_mov_b32 s57, 0xf000f00
    s_mov_b32 s58, 0xf000f000
    s_mov_b32 s59, 0xf000f000
    v_mov_b32 v16, -1
    v_mov_b32 v17, -1
    v_mov_b32 v18, -1
    v_mov_b32 v19, -1
    v_lshrrev_b32 v14, 1, v13
    s_lshl_b32 s60, s2, 11
    buffer_store_dwordx2 v[16:17], v14, s[48:51], s60 offen sc1
    s_mul_i32 s60, s2, 15616
    v_cmp_gt_u32 vcc, 0xd00, v13
    v_bfrev_b32 v15, 1
    s_nop 0
    v_cndmask_b32 v15, v15, v13, vcc
    s_add_u32 s60, s60, 524288
    buffer_store_dwordx4 v[16:19], v13, s[48:51], s60 offen sc1
    s_add_u32 s60, s60, 4096
    buffer_store_dwordx4 v[16:19], v13, s[48:51], s60 offen sc1
    s_add_u32 s60, s60, 4096
    buffer_store_dwordx4 v[16:19], v13, s[48:51], s60 offen sc1
    s_add_u32 s60, s60, 4096
    buffer_store_dwordx4 v[16:19], v15, s[48:51], s60 offen sc1
    s_getreg_b32 s60, hwreg(HW_REG_XCC_ID, 0, 4)
    s_mul_i32 s61, s60, s60
    s_lshl_b32 s61, s61, 9
    s_add_u32 s60, s60, s61
    s_lshl_b32 s60, s60, 8
    s_add_u32 s97, s60, 1
    v_and_b32 v47, 15, v0
    v_bfe_u32 v44, v0, 3, 1
    v_mad_u32_u24 v46, v44, s3, v47
    v_lshlrev_b32 v46, 3, v46
    v_lshl_add_u32 v47, s3, 3, v47
    s_mul_i32 s7, s3, 7
    s_sub_u32 s7, 24, s7
    v_mad_u32_u24 v47, v44, s7, v47
    v_lshrrev_b32 v45, 5, v0
    v_lshlrev_b32 v45, 1, v45
    v_lshl_add_u32 v45, v47, 2, v45
    v_bfe_u32 v44, v0, 4, 1
    v_mul_u32_u24 v44, 1152, v44
    v_add_u32 v45, v45, v44
    s_mov_b32 vcc_lo, 0x1ff01ff
    s_mov_b32 vcc_hi, 0x1ff01ff
    v_bfrev_b32 v44, 1
    v_cndmask_b32 v45, v44, v45, vcc
    s_mul_i32 s7, s5, 144
    buffer_load_short_d16_hi v4, v45, s[36:39], s7 offen
    s_mul_i32 s98, s5, 589824
    s_mul_i32 s99, s4, 256
    s_add_u32 s98, s98, s99
    s_lshl_b32 s99, s3, 6
    s_add_u32 s96, s99, 0
    s_min_u32 s99, s96, 1088
    v_add_u32 v49, s99, v0
    v_mul_u32_u24 v50, 65536, v49
    v_lshrrev_b32 v50, 20, v50
    v_mul_u32_u24 v51, 16, v50
    v_sub_u32 v49, v49, v51
    v_and_b32 v51, 7, v50
    v_lshlrev_b32 v51, 1, v51
    v_xor_b32 v49, v49, v51
    v_mul_u32_u24 v50, 8192, v50
    v_lshl_add_u32 v49, v49, 4, v50
    s_lshl_b32 s99, s99, 4
    s_add_u32 m0, s99, 0
    s_nop 0
    buffer_load_dwordx4 v49, s[16:19], s98 offen lds
    s_mul_i32 s98, s5, 589824
    s_mul_i32 s99, s4, 256
    s_add_u32 s98, s98, s99
    s_lshl_b32 s99, s3, 6
    s_add_u32 s96, s99, 256
    s_min_u32 s99, s96, 1088
    v_add_u32 v49, s99, v0
    v_mul_u32_u24 v50, 65536, v49
    v_lshrrev_b32 v50, 20, v50
    v_mul_u32_u24 v51, 16, v50
    v_sub_u32 v49, v49, v51
    v_and_b32 v51, 7, v50
    v_lshlrev_b32 v51, 1, v51
    v_xor_b32 v49, v49, v51
    v_mul_u32_u24 v50, 8192, v50
    v_lshl_add_u32 v49, v49, 4, v50
    s_lshl_b32 s99, s99, 4
    s_add_u32 m0, s99, 0
    s_nop 0
    buffer_load_dwordx4 v49, s[16:19], s98 offen lds
    s_mul_i32 s98, s5, 589824
    s_mul_i32 s99, s4, 256
    s_add_u32 s98, s98, s99
    s_lshl_b32 s99, s3, 6
    s_add_u32 s96, s99, 512
    s_min_u32 s99, s96, 1088
    v_add_u32 v49, s99, v0
    v_mul_u32_u24 v50, 65536, v49
    v_lshrrev_b32 v50, 20, v50
    v_mul_u32_u24 v51, 16, v50
    v_sub_u32 v49, v49, v51
    v_and_b32 v51, 7, v50
    v_lshlrev_b32 v51, 1, v51
    v_xor_b32 v49, v49, v51
    v_mul_u32_u24 v50, 8192, v50
    v_lshl_add_u32 v49, v49, 4, v50
    s_lshl_b32 s99, s99, 4
    s_add_u32 m0, s99, 0
    s_nop 0
    buffer_load_dwordx4 v49, s[16:19], s98 offen lds
    s_mul_i32 s98, s5, 589824
    s_mul_i32 s99, s4, 256
    s_add_u32 s98, s98, s99
    s_lshl_b32 s99, s3, 6
    s_add_u32 s96, s99, 768
    s_min_u32 s99, s96, 1088
    v_add_u32 v49, s99, v0
    v_mul_u32_u24 v50, 65536, v49
    v_lshrrev_b32 v50, 20, v50
    v_mul_u32_u24 v51, 16, v50
    v_sub_u32 v49, v49, v51
    v_and_b32 v51, 7, v50
    v_lshlrev_b32 v51, 1, v51
    v_xor_b32 v49, v49, v51
    v_mul_u32_u24 v50, 8192, v50
    v_lshl_add_u32 v49, v49, 4, v50
    s_lshl_b32 s99, s99, 4
    s_add_u32 m0, s99, 0
    s_nop 0
    buffer_load_dwordx4 v49, s[16:19], s98 offen lds
    s_mul_i32 s98, s5, 589824
    s_mul_i32 s99, s4, 256
    s_add_u32 s98, s98, s99
    s_lshl_b32 s99, s3, 6
    s_add_u32 s96, s99, 1024
    s_min_u32 s99, s96, 1088
    s_sub_u32 s96, s96, s99
    s_min_u32 s96, s96, 63
    v_add_u32 v49, s99, v0
    v_mul_u32_u24 v50, 65536, v49
    v_lshrrev_b32 v50, 20, v50
    v_mul_u32_u24 v51, 16, v50
    v_sub_u32 v49, v49, v51
    v_and_b32 v51, 7, v50
    v_lshlrev_b32 v51, 1, v51
    v_xor_b32 v49, v49, v51
    v_mul_u32_u24 v50, 8192, v50
    v_lshl_add_u32 v49, v49, 4, v50
    s_lshl_b32 s99, s99, 4
    s_lshl_b64 exec, -1, s96
    s_add_u32 m0, s99, 0
    s_nop 0
    buffer_load_dwordx4 v49, s[16:19], s98 offen lds
    s_mov_b64 exec, -1
    s_add_u32 s63, s101, 131072
    s_and_b32 s63, s63, 0x1fffff
    s_add_u32 m0, s62, 2048
    s_nop 0
    buffer_load_dwordx4 v2, s[8:11], s63 offen offset:0 nt lds
    buffer_load_dwordx4 v[64:67], v2, s[8:11], s63 offen offset:1024 nt
    s_add_u32 m0, s62, 1024
    s_nop 0
    buffer_load_dwordx4 v2, s[8:11], s63 offen offset:2048 nt lds
    buffer_load_dwordx4 v[68:71], v2, s[8:11], s63 offen offset:3072 nt
    s_add_u32 s63, s101, 262144
    s_and_b32 s63, s63, 0x1fffff
    s_add_u32 m0, s62, 4096
    s_nop 0
    buffer_load_dwordx4 v2, s[8:11], s63 offen offset:0 nt lds
    buffer_load_dwordx4 v[72:75], v2, s[8:11], s63 offen offset:1024 nt
    s_add_u32 m0, s62, 3072
    s_nop 0
    buffer_load_dwordx4 v2, s[8:11], s63 offen offset:2048 nt lds
    buffer_load_dwordx4 v[76:79], v2, s[8:11], s63 offen offset:3072 nt
    s_add_u32 s63, s101, 393216
    s_and_b32 s63, s63, 0x1fffff
    s_add_u32 m0, s62, 6144
    s_nop 0
    buffer_load_dwordx4 v2, s[8:11], s63 offen offset:0 nt lds
    buffer_load_dwordx4 v[80:83], v2, s[8:11], s63 offen offset:1024 nt
    s_add_u32 m0, s62, 5120
    s_nop 0
    buffer_load_dwordx4 v2, s[8:11], s63 offen offset:2048 nt lds
    buffer_load_dwordx4 v[84:87], v2, s[8:11], s63 offen offset:3072 nt
    s_mul_i32 s98, s4, 147456
    s_mul_i32 s99, s5, 144
    s_add_u32 s98, s98, s99
    s_lshl_b32 s99, s3, 6
    s_add_u32 s96, s99, 0
    s_min_u32 s99, s96, 1088
    v_add_u32 v49, s99, v0
    v_mul_u32_u24 v50, 116509, v49
    v_lshrrev_b32 v50, 20, v50
    v_mul_u32_u24 v51, 9, v50
    v_sub_u32 v49, v49, v51
    v_mul_u32_u24 v50, 1152, v50
    v_lshl_add_u32 v49, v49, 4, v50
    s_lshl_b32 s99, s99, 4
    s_add_u32 m0, s99, 117248
    s_nop 0
    buffer_load_dwordx4 v49, s[20:23], s98 offen lds
    s_add_u32 s63, s101, 524288
    s_and_b32 s63, s63, 0x1fffff
    s_add_u32 m0, s62, 8192
    s_nop 0
    buffer_load_dwordx4 v2, s[8:11], s63 offen offset:0 nt lds
    s_mul_i32 s98, s4, 147456
    s_mul_i32 s99, s5, 144
    s_add_u32 s98, s98, s99
    s_lshl_b32 s99, s3, 6
    s_add_u32 s96, s99, 256
    s_min_u32 s99, s96, 1088
    v_add_u32 v49, s99, v0
    v_mul_u32_u24 v50, 116509, v49
    v_lshrrev_b32 v50, 20, v50
    v_mul_u32_u24 v51, 9, v50
    v_sub_u32 v49, v49, v51
    v_mul_u32_u24 v50, 1152, v50
    v_lshl_add_u32 v49, v49, 4, v50
    s_lshl_b32 s99, s99, 4
    s_add_u32 m0, s99, 117248
    s_nop 0
    buffer_load_dwordx4 v49, s[20:23], s98 offen lds
    buffer_load_dwordx4 v[88:91], v2, s[8:11], s63 offen offset:1024 nt
    s_mul_i32 s98, s4, 147456
    s_mul_i32 s99, s5, 144
    s_add_u32 s98, s98, s99
    s_lshl_b32 s99, s3, 6
    s_add_u32 s96, s99, 512
    s_min_u32 s99, s96, 1088
    v_add_u32 v49, s99, v0
    v_mul_u32_u24 v50, 116509, v49
    v_lshrrev_b32 v50, 20, v50
    v_mul_u32_u24 v51, 9, v50
    v_sub_u32 v49, v49, v51
    v_mul_u32_u24 v50, 1152, v50
    v_lshl_add_u32 v49, v49, 4, v50
    s_lshl_b32 s99, s99, 4
    s_add_u32 m0, s99, 117248
    s_nop 0
    buffer_load_dwordx4 v49, s[20:23], s98 offen lds
    s_add_u32 m0, s62, 7168
    s_nop 0
    buffer_load_dwordx4 v2, s[8:11], s63 offen offset:2048 nt lds
    s_mul_i32 s98, s4, 147456
    s_mul_i32 s99, s5, 144
    s_add_u32 s98, s98, s99
    s_lshl_b32 s99, s3, 6
    s_add_u32 s96, s99, 768
    s_min_u32 s99, s96, 1088
    v_add_u32 v49, s99, v0
    v_mul_u32_u24 v50, 116509, v49
    v_lshrrev_b32 v50, 20, v50
    v_mul_u32_u24 v51, 9, v50
    v_sub_u32 v49, v49, v51
    v_mul_u32_u24 v50, 1152, v50
    v_lshl_add_u32 v49, v49, 4, v50
    s_lshl_b32 s99, s99, 4
    s_add_u32 m0, s99, 117248
    s_nop 0
    buffer_load_dwordx4 v49, s[20:23], s98 offen lds
    buffer_load_dwordx4 v[92:95], v2, s[8:11], s63 offen offset:3072 nt
    s_mul_i32 s98, s4, 147456
    s_mul_i32 s99, s5, 144
    s_add_u32 s98, s98, s99
    s_lshl_b32 s99, s3, 6
    s_add_u32 s96, s99, 1024
    s_min_u32 s99, s96, 1088
    s_sub_u32 s96, s96, s99
    s_min_u32 s96, s96, 63
    v_add_u32 v49, s99, v0
    v_mul_u32_u24 v50, 116509, v49
    v_lshrrev_b32 v50, 20, v50
    v_mul_u32_u24 v51, 9, v50
    v_sub_u32 v49, v49, v51
    v_mul_u32_u24 v50, 1152, v50
    v_lshl_add_u32 v49, v49, 4, v50
    s_lshl_b32 s99, s99, 4
    s_lshl_b64 exec, -1, s96
    s_add_u32 m0, s99, 117248
    s_nop 0
    buffer_load_dwordx4 v49, s[20:23], s98 offen lds
    s_mov_b64 exec, -1
    s_add_u32 s63, s101, 655360
    s_and_b32 s63, s63, 0x1fffff
    s_add_u32 m0, s62, 10240
    s_nop 0
    buffer_load_dwordx4 v2, s[8:11], s63 offen offset:0 nt lds
    s_mul_i32 s98, s5, 663552
    s_mul_i32 s99, s4, 288
    s_add_u32 s98, s98, s99
    s_lshl_b32 s99, s3, 6
    s_add_u32 s96, s99, 0
    s_min_u32 s99, s96, 1232
    v_add_u32 v49, s99, v0
    v_mul_u32_u24 v50, 58255, v49
    v_lshrrev_b32 v50, 20, v50
    v_mul_u32_u24 v51, 18, v50
    v_sub_u32 v49, v49, v51
    v_mul_u32_u24 v50, 9216, v50
    v_lshl_add_u32 v49, v49, 4, v50
    s_lshl_b32 s99, s99, 4
    s_add_u32 m0, s99, 75776
    s_nop 0
    buffer_load_dwordx4 v49, s[24:27], s98 offen lds
    s_add_u32 m0, s99, 96512
    s_nop 0
    buffer_load_dwordx4 v49, s[28:31], s98 offen lds
    buffer_load_dwordx4 v[96:99], v2, s[8:11], s63 offen offset:1024 nt
    s_mul_i32 s98, s5, 663552
    s_mul_i32 s99, s4, 288
    s_add_u32 s98, s98, s99
    s_lshl_b32 s99, s3, 6
    s_add_u32 s96, s99, 256
    s_min_u32 s99, s96, 1232
    v_add_u32 v49, s99, v0
    v_mul_u32_u24 v50, 58255, v49
    v_lshrrev_b32 v50, 20, v50
    v_mul_u32_u24 v51, 18, v50
    v_sub_u32 v49, v49, v51
    v_mul_u32_u24 v50, 9216, v50
    v_lshl_add_u32 v49, v49, 4, v50
    s_lshl_b32 s99, s99, 4
    s_add_u32 m0, s99, 75776
    s_nop 0
    buffer_load_dwordx4 v49, s[24:27], s98 offen lds
    s_add_u32 m0, s99, 96512
    s_nop 0
    buffer_load_dwordx4 v49, s[28:31], s98 offen lds
    s_add_u32 m0, s62, 9216
    s_nop 0
    buffer_load_dwordx4 v2, s[8:11], s63 offen offset:2048 nt lds
    s_mul_i32 s98, s5, 663552
    s_mul_i32 s99, s4, 288
    s_add_u32 s98, s98, s99
    s_lshl_b32 s99, s3, 6
    s_add_u32 s96, s99, 512
    s_min_u32 s99, s96, 1232
    v_add_u32 v49, s99, v0
    v_mul_u32_u24 v50, 58255, v49
    v_lshrrev_b32 v50, 20, v50
    v_mul_u32_u24 v51, 18, v50
    v_sub_u32 v49, v49, v51
    v_mul_u32_u24 v50, 9216, v50
    v_lshl_add_u32 v49, v49, 4, v50
    s_lshl_b32 s99, s99, 4
    s_add_u32 m0, s99, 75776
    s_nop 0
    buffer_load_dwordx4 v49, s[24:27], s98 offen lds
    s_add_u32 m0, s99, 96512
    s_nop 0
    buffer_load_dwordx4 v49, s[28:31], s98 offen lds
    buffer_load_dwordx4 v[100:103], v2, s[8:11], s63 offen offset:3072 nt
    v_mov_b32 v20, 0
    v_mov_b32 v21, 0
    v_add_u32 v14, 156416, v14
    ds_write_b64 v14, v[20:21]
    v_and_b32 v47, 15, v0
    v_bfe_u32 v44, v0, 3, 1
    v_mad_u32_u24 v46, v44, s3, v47
    v_lshlrev_b32 v46, 3, v46
    v_lshl_add_u32 v47, s3, 3, v47
    s_mul_i32 s7, s3, 7
    s_sub_u32 s7, 24, s7
    v_mad_u32_u24 v47, v44, s7, v47
    v_lshrrev_b32 v45, 5, v0
    v_lshlrev_b32 v45, 1, v45
    v_lshl_add_u32 v45, v47, 2, v45
    v_add_u32 v43, 156416, v45
    v_and_b32 v47, 15, v0
    v_bfe_u32 v44, v0, 3, 1
    v_mad_u32_u24 v46, v44, s3, v47
    v_lshlrev_b32 v46, 3, v46
    v_lshl_add_u32 v47, s3, 3, v47
    s_mul_i32 s7, s3, 7
    s_sub_u32 s7, 24, s7
    v_mad_u32_u24 v47, v44, s7, v47
    v_lshrrev_b32 v45, 5, v0
    v_lshlrev_b32 v45, 1, v45
    v_lshl_add_u32 v45, v47, 2, v45
    v_bfe_u32 v44, v0, 4, 1
    v_mul_u32_u24 v44, 160, v44
    v_add_u32 v45, v45, v44
    v_add_u32 v45, 156416, v45
    v_mov_b32 v20, 0x3f80
    v_and_b32 v48, 15, v0
    v_lshlrev_b32 v55, 1, v48
    s_mov_b32 s98, 0x24924924
    v_lshrrev_b32_e64 v55, v55, s98
    v_and_b32 v55, 3, v55
    v_mul_u32_u24 v55, 160, v55
    v_lshrrev_b32 v49, 4, v0
    v_lshl_add_u32 v55, v49, 3, v55
    v_add_u32 v55, 156416, v55
    v_mul_u32_u24 v50, 11, v48
    v_lshrrev_b32 v50, 5, v50
    v_mul_u32_u24 v52, 3, v50
    v_sub_u32 v48, v48, v52
    v_mul_u32_u24 v52, 640, v48
    v_lshl_add_u32 v52, v49, 4, v52
    v_lshl_add_u32 v52, v50, 6, v52
    v_lshrrev_b32 v48, 1, v50
    v_mul_u32_u24 v48, 384, v48
    v_add_u32 v52, v52, v48
    s_cmp_eq_u32 s3, 0
    s_cselect_b32 s98, 4, 2
    v_cmp_gt_u32 vcc, s98, v50
    v_or_b32 v48, 0x80000000, v52
    s_nop 0
    v_cndmask_b32 v52, v48, v52, vcc
    s_mul_i32 s64, s2, 2048
    s_mul_i32 s98, s3, 128
    s_add_u32 s64, s64, s98
    s_add_u32 s64, s64, 0
    v_lshrrev_b32 v54, 2, v0
    v_mul_u32_u24 v54, 256, v54
    v_and_b32 v48, 24, v1
    v_add_u32 v54, v54, v48
    v_bfe_u32 v48, v0, 2, 3
    s_lshl_b32 s99, s3, 1
    v_xor_b32 v48, s99, v48
    v_lshl_add_u32 v54, v48, 5, v54
    v_xor_b32 v51, 32, v54
    v_add_u32 v54, 0, v54
    v_add_u32 v51, 0, v51
    s_waitcnt vmcnt(31)
    s_waitcnt lgkmcnt(0)
    s_barrier
    v_mov_b32 v21, s97
    s_lshr_b32 s60, s4, 2
    s_lshl_b32 s60, s60, 2
    v_cmp_eq_u32 vcc, 0, v13
    v_bfrev_b32 v22, 1
    s_nop 0
    v_cndmask_b32 v22, v22, v13, vcc
    buffer_atomic_add v21, v22, s[44:47], s60 offen offset:128 sc1
    s_mov_b32 exec_lo, 0x1ff01ff
    s_mov_b32 exec_hi, 0x1ff01ff
    ds_write_b16_d16_hi v45, v4
    ds_write_b16 v43, v20 offset:320
    s_mov_b64 exec, -1
    ds_read_b64_tr_b16 v[20:21], v54 offset:0
    ds_read_b64_tr_b16 v[22:23], v54 offset:4096
    ds_read_b64_tr_b16 v[24:25], v54 offset:8192
    ds_read_b64_tr_b16 v[26:27], v54 offset:12288
    ds_read_b64_tr_b16 v[28:29], v54 offset:16384
    ds_read_b64_tr_b16 v[30:31], v51 offset:0
    ds_read_b64_tr_b16 v[32:33], v51 offset:4096
    ds_read_b64_tr_b16 v[34:35], v51 offset:8192
    ds_read_b64_tr_b16 v[36:37], v51 offset:12288
    ds_read_b64_tr_b16 v[38:39], v51 offset:16384
    s_waitcnt lgkmcnt(10)
    s_barrier
    ds_read2_b64 v[10:13], v55 offset0:0 offset1:4
    ds_read2_b64 v[14:17], v55 offset0:8 offset1:12
    ds_read_b64 v[18:19], v55 offset:128
    s_waitcnt lgkmcnt(0)
    v_mfma_f32_16x16x32_bf16 v[40:43], v[10:13], v[10:13], 0
    v_mfma_f32_16x16x32_bf16 v[44:47], v[20:23], v[10:13], 0
    v_mfma_f32_16x16x32_bf16 v[48:51], v[30:33], v[10:13], 0
    v_mfma_f32_16x16x32_bf16 v[40:43], v[14:17], v[14:17], v[40:43]
    v_mfma_f32_16x16x32_bf16 v[44:47], v[24:27], v[14:17], v[44:47]
    v_mfma_f32_16x16x32_bf16 v[48:51], v[34:37], v[14:17], v[48:51]
    s_nop 4
    v_mfma_f32_16x16x16_bf16 v[40:43], v[18:19], v[18:19], v[40:43]
    v_mfma_f32_16x16x16_bf16 v[44:47], v[28:29], v[18:19], v[44:47]
    v_mfma_f32_16x16x16_bf16 v[48:51], v[38:39], v[18:19], v[48:51]
    s_nop 5
    s_mov_b32 vcc_lo, 0x70007
    s_mov_b32 vcc_hi, 0x70007
    v_cndmask_b32 v40, v40, v44, vcc
    v_cndmask_b32 v41, v41, v45, vcc
    v_cndmask_b32 v42, v42, v46, vcc
    v_cndmask_b32 v43, v43, v47, vcc
    s_mov_b32 vcc_lo, 0x380038
    s_mov_b32 vcc_hi, 0x380038
    v_cndmask_b32 v40, v40, v48, vcc
    v_cndmask_b32 v41, v41, v49, vcc
    v_cndmask_b32 v42, v42, v50, vcc
    v_cndmask_b32 v43, v43, v51, vcc
    buffer_store_dwordx4 v[40:43], v52, s[48:51], s64 offen sc1
    s_waitcnt vmcnt(14)
    s_mul_i32 s98, s5, 663552
    s_mul_i32 s99, s4, 288
    s_add_u32 s98, s98, s99
    s_lshl_b32 s99, s3, 6
    s_add_u32 s96, s99, 768
    s_min_u32 s99, s96, 1232
    v_add_u32 v49, s99, v0
    v_mul_u32_u24 v50, 58255, v49
    v_lshrrev_b32 v50, 20, v50
    v_mul_u32_u24 v51, 18, v50
    v_sub_u32 v49, v49, v51
    v_mul_u32_u24 v50, 9216, v50
    v_lshl_add_u32 v49, v49, 4, v50
    s_lshl_b32 s99, s99, 4
    s_add_u32 m0, s99, 75776
    s_nop 0
    buffer_load_dwordx4 v49, s[24:27], s98 offen lds
    s_add_u32 m0, s99, 96512
    s_nop 0
    buffer_load_dwordx4 v49, s[28:31], s98 offen lds
    s_add_u32 s63, s101, 786432
    s_and_b32 s63, s63, 0x1fffff
    s_add_u32 m0, s62, 12288
    s_nop 0
    buffer_load_dwordx4 v2, s[8:11], s63 offen offset:0 nt lds
    s_mul_i32 s98, s5, 663552
    s_mul_i32 s99, s4, 288
    s_add_u32 s98, s98, s99
    s_lshl_b32 s99, s3, 6
    s_add_u32 s96, s99, 1024
    s_min_u32 s99, s96, 1232
    v_add_u32 v49, s99, v0
    v_mul_u32_u24 v50, 58255, v49
    v_lshrrev_b32 v50, 20, v50
    v_mul_u32_u24 v51, 18, v50
    v_sub_u32 v49, v49, v51
    v_mul_u32_u24 v50, 9216, v50
    v_lshl_add_u32 v49, v49, 4, v50
    s_lshl_b32 s99, s99, 4
    s_add_u32 m0, s99, 75776
    s_nop 0
    buffer_load_dwordx4 v49, s[24:27], s98 offen lds
    s_add_u32 m0, s99, 96512
    s_nop 0
    buffer_load_dwordx4 v49, s[28:31], s98 offen lds
    buffer_load_dwordx4 v[104:107], v2, s[8:11], s63 offen offset:1024 nt
    s_waitcnt vmcnt(14)
    s_mul_i32 s98, s5, 663552
    s_mul_i32 s99, s4, 288
    s_add_u32 s98, s98, s99
    s_lshl_b32 s99, s3, 6
    s_add_u32 s96, s99, 1280
    s_min_u32 s99, s96, 1232
    s_sub_u32 s96, s96, s99
    s_min_u32 s96, s96, 63
    v_add_u32 v49, s99, v0
    v_mul_u32_u24 v50, 58255, v49
    v_lshrrev_b32 v50, 20, v50
    v_mul_u32_u24 v51, 18, v50
    v_sub_u32 v49, v49, v51
    v_mul_u32_u24 v50, 9216, v50
    v_lshl_add_u32 v49, v49, 4, v50
    s_lshl_b32 s99, s99, 4
    s_lshl_b64 exec, -1, s96
    s_add_u32 m0, s99, 75776
    s_nop 0
    buffer_load_dwordx4 v49, s[24:27], s98 offen lds
    s_add_u32 m0, s99, 96512
    s_nop 0
    buffer_load_dwordx4 v49, s[28:31], s98 offen lds
    s_mov_b64 exec, -1
    s_add_u32 m0, s62, 11264
    s_nop 0
    buffer_load_dwordx4 v2, s[8:11], s63 offen offset:2048 nt lds
    s_mul_i32 s98, s4, 165888
    s_mul_i32 s99, s5, 144
    s_add_u32 s98, s98, s99
    s_lshl_b32 s99, s3, 6
    s_add_u32 s96, s99, 0
    s_min_u32 s99, s96, 1232
    v_add_u32 v49, s99, v0
    v_mul_u32_u24 v50, 116509, v49
    v_lshrrev_b32 v50, 20, v50
    v_mul_u32_u24 v51, 9, v50
    v_sub_u32 v49, v49, v51
    v_mul_u32_u24 v50, 1152, v50
    v_lshl_add_u32 v49, v49, 4, v50
    s_lshl_b32 s99, s99, 4
    s_add_u32 m0, s99, 135680
    s_nop 0
    buffer_load_dwordx4 v49, s[32:35], s98 offen lds
    buffer_load_dwordx4 v[108:111], v2, s[8:11], s63 offen offset:3072 nt
    s_waitcnt vmcnt(14)
    s_mul_i32 s98, s4, 165888
    s_mul_i32 s99, s5, 144
    s_add_u32 s98, s98, s99
    s_lshl_b32 s99, s3, 6
    s_add_u32 s96, s99, 256
    s_min_u32 s99, s96, 1232
    v_add_u32 v49, s99, v0
    v_mul_u32_u24 v50, 116509, v49
    v_lshrrev_b32 v50, 20, v50
    v_mul_u32_u24 v51, 9, v50
    v_sub_u32 v49, v49, v51
    v_mul_u32_u24 v50, 1152, v50
    v_lshl_add_u32 v49, v49, 4, v50
    s_lshl_b32 s99, s99, 4
    s_add_u32 m0, s99, 135680
    s_nop 0
    buffer_load_dwordx4 v49, s[32:35], s98 offen lds
    s_add_u32 s63, s101, 917504
    s_and_b32 s63, s63, 0x1fffff
    buffer_load_dwordx4 v[112:115], v2, s[8:11], s63 offen offset:0 nt
    s_mul_i32 s98, s4, 165888
    s_mul_i32 s99, s5, 144
    s_add_u32 s98, s98, s99
    s_lshl_b32 s99, s3, 6
    s_add_u32 s96, s99, 512
    s_min_u32 s99, s96, 1232
    v_add_u32 v49, s99, v0
    v_mul_u32_u24 v50, 116509, v49
    v_lshrrev_b32 v50, 20, v50
    v_mul_u32_u24 v51, 9, v50
    v_sub_u32 v49, v49, v51
    v_mul_u32_u24 v50, 1152, v50
    v_lshl_add_u32 v49, v49, 4, v50
    s_lshl_b32 s99, s99, 4
    s_add_u32 m0, s99, 135680
    s_nop 0
    buffer_load_dwordx4 v49, s[32:35], s98 offen lds
    buffer_load_dwordx4 v[116:119], v2, s[8:11], s63 offen offset:1024 nt
    s_waitcnt vmcnt(14)
    s_mul_i32 s98, s4, 165888
    s_mul_i32 s99, s5, 144
    s_add_u32 s98, s98, s99
    s_lshl_b32 s99, s3, 6
    s_add_u32 s96, s99, 768
    s_min_u32 s99, s96, 1232
    v_add_u32 v49, s99, v0
    v_mul_u32_u24 v50, 116509, v49
    v_lshrrev_b32 v50, 20, v50
    v_mul_u32_u24 v51, 9, v50
    v_sub_u32 v49, v49, v51
    v_mul_u32_u24 v50, 1152, v50
    v_lshl_add_u32 v49, v49, 4, v50
    s_lshl_b32 s99, s99, 4
    s_add_u32 m0, s99, 135680
    s_nop 0
    buffer_load_dwordx4 v49, s[32:35], s98 offen lds
    buffer_load_dwordx4 v[120:123], v2, s[8:11], s63 offen offset:2048 nt
    s_mul_i32 s98, s4, 165888
    s_mul_i32 s99, s5, 144
    s_add_u32 s98, s98, s99
    s_lshl_b32 s99, s3, 6
    s_add_u32 s96, s99, 1024
    s_min_u32 s99, s96, 1232
    v_add_u32 v49, s99, v0
    v_mul_u32_u24 v50, 116509, v49
    v_lshrrev_b32 v50, 20, v50
    v_mul_u32_u24 v51, 9, v50
    v_sub_u32 v49, v49, v51
    v_mul_u32_u24 v50, 1152, v50
    v_lshl_add_u32 v49, v49, 4, v50
    s_lshl_b32 s99, s99, 4
    s_add_u32 m0, s99, 135680
    s_nop 0
    buffer_load_dwordx4 v49, s[32:35], s98 offen lds
    buffer_load_dwordx4 v[124:127], v2, s[8:11], s63 offen offset:3072 nt
    s_waitcnt vmcnt(14)
    s_mul_i32 s98, s4, 165888
    s_mul_i32 s99, s5, 144
    s_add_u32 s98, s98, s99
    s_lshl_b32 s99, s3, 6
    s_add_u32 s96, s99, 1280
    s_min_u32 s99, s96, 1232
    s_sub_u32 s96, s96, s99
    s_min_u32 s96, s96, 63
    v_add_u32 v49, s99, v0
    v_mul_u32_u24 v50, 116509, v49
    v_lshrrev_b32 v50, 20, v50
    v_mul_u32_u24 v51, 9, v50
    v_sub_u32 v49, v49, v51
    v_mul_u32_u24 v50, 1152, v50
    v_lshl_add_u32 v49, v49, 4, v50
    s_lshl_b32 s99, s99, 4
    s_lshl_b64 exec, -1, s96
    s_add_u32 m0, s99, 135680
    s_nop 0
    buffer_load_dwordx4 v49, s[32:35], s98 offen lds
    s_mov_b64 exec, -1
    s_add_u32 s63, s101, 1048576
    s_and_b32 s63, s63, 0x1fffff
    buffer_load_dwordx4 v[128:131], v2, s[8:11], s63 offen offset:0 nt
    buffer_load_dwordx4 v[132:135], v2, s[8:11], s63 offen offset:1024 nt
    s_waitcnt vmcnt(14)
    buffer_load_dwordx4 v[136:139], v2, s[8:11], s63 offen offset:2048 nt
    buffer_load_dwordx4 v[140:143], v2, s[8:11], s63 offen offset:3072 nt
    s_waitcnt vmcnt(14)
    s_add_u32 s63, s101, 1179648
    s_and_b32 s63, s63, 0x1fffff
    buffer_load_dwordx4 v[144:147], v2, s[8:11], s63 offen offset:0 nt
    buffer_load_dwordx4 v[148:151], v2, s[8:11], s63 offen offset:1024 nt
    s_waitcnt vmcnt(14)
    buffer_load_dwordx4 v[152:155], v2, s[8:11], s63 offen offset:2048 nt
    buffer_load_dwordx4 v[156:159], v2, s[8:11], s63 offen offset:3072 nt
    s_getpc_b64 s[98:99]
C2:
    s_add_u32 s98, s98, L_a-C2
    s_addc_u32 s99, s99, 0
    v_lshl_add_u32 v48, s3, 6, v0
    v_lshlrev_b32 v48, 6, v48
    v_min_u32 v50, L_end-L_a, v48
    v_mov_b32 v51, s99
    v_add_co_u32 v50, vcc, s98, v50
    s_nop 1
    v_addc_co_u32 v51, vcc, 0, v51, vcc
    global_load_dword v5, v[50:51], off
    v_add_u32 v48, 0x4000, v48
    v_min_u32 v50, L_end-L_a, v48
    v_mov_b32 v51, s99
    v_add_co_u32 v50, vcc, s98, v50
    s_nop 1
    v_addc_co_u32 v51, vcc, 0, v51, vcc
    global_load_dword v5, v[50:51], off
    v_add_u32 v48, 0x4000, v48
    v_min_u32 v50, L_end-L_a, v48
    v_mov_b32 v51, s99
    v_add_co_u32 v50, vcc, s98, v50
    s_nop 1
    v_addc_co_u32 v51, vcc, 0, v51, vcc
    global_load_dword v5, v[50:51], off
    v_add_u32 v48, 0x4000, v48
    v_and_b32 v11, 7, v0
    v_lshlrev_b32 v11, 2, v11
    buffer_load_dword v10, v11, s[44:47], 0 offen offset:128 sc1
    s_waitcnt vmcnt(14)
    s_add_u32 s63, s101, 1310720
    s_and_b32 s63, s63, 0x1fffff
    buffer_load_dwordx4 v[160:163], v2, s[8:11], s63 offen offset:0 nt
    buffer_load_dwordx4 v[164:167], v2, s[8:11], s63 offen offset:1024 nt
    s_waitcnt vmcnt(14)
    buffer_load_dwordx4 v[168:171], v2, s[8:11], s63 offen offset:2048 nt
    buffer_load_dwordx4 v[172:175], v2, s[8:11], s63 offen offset:3072 nt
    s_waitcnt vmcnt(14)
    s_add_u32 s63, s101, 1441792
    s_and_b32 s63, s63, 0x1fffff
    buffer_load_dwordx4 v[176:179], v2, s[8:11], s63 offen offset:0 nt
    buffer_load_dwordx4 v[180:183], v2, s[8:11], s63 offen offset:1024 nt
    s_waitcnt vmcnt(14)
    buffer_load_dwordx4 v[184:187], v2, s[8:11], s63 offen offset:2048 nt
    buffer_load_dwordx4 v[188:191], v2, s[8:11], s63 offen offset:3072 nt
    s_waitcnt vmcnt(14)
    s_add_u32 s63, s101, 1572864
    s_and_b32 s63, s63, 0x1fffff
    buffer_load_dwordx4 v[192:195], v2, s[8:11], s63 offen offset:0 nt
    buffer_load_dwordx4 v[196:199], v2, s[8:11], s63 offen offset:1024 nt
    s_waitcnt vmcnt(14)
    buffer_load_dwordx4 v[200:203], v2, s[8:11], s63 offen offset:2048 nt
    buffer_load_dwordx4 v[204:207], v2, s[8:11], s63 offen offset:3072 nt
    s_waitcnt vmcnt(14)
    s_add_u32 s63, s101, 1703936
    s_and_b32 s63, s63, 0x1fffff
    buffer_load_dwordx4 v[208:211], v2, s[8:11], s63 offen offset:0 nt
    buffer_load_dwordx4 v[212:215], v2, s[8:11], s63 offen offset:1024 nt
    s_waitcnt vmcnt(14)
    buffer_load_dwordx4 v[216:219], v2, s[8:11], s63 offen offset:2048 nt
    buffer_load_dwordx4 v[220:223], v2, s[8:11], s63 offen offset:3072 nt
    s_waitcnt vmcnt(16)
    v_and_b32 v12, 0xff, v10
    v_cmp_gt_u32 vcc, 32, v12
    s_cbranch_vccz P3d
P3:
    buffer_load_dword v10, v11, s[44:47], 0 offen offset:128 sc1
    s_waitcnt vmcnt(0)
    s_sub_u32 s6, s6, 1
    s_cselect_b32 s6, 0, s6
    s_cbranch_scc1 P3x
    v_and_b32 v12, 0xff, v10
    v_cmp_gt_u32 vcc, 32, v12
    s_cbranch_vccnz P3
P3x:
P3d:
    s_lshr_b32 s61, s4, 2
    v_readlane_b32 s60, v10, s61
    s_lshl_b32 s97, s97, 5
    s_nop 1
    s_cmp_eq_u32 s60, s97
    s_cselect_b32 s97, 1, 0
    v_lshrrev_b32 v46, 3, v0
    v_mul_u32_u24 v46, 2048, v46
    v_and_b32 v45, 7, v0
    v_lshl_add_u32 v45, s3, 3, v45
    v_lshl_add_u32 v47, v45, 4, v46
    s_mul_i32 s60, s4, 16384
    s_add_u32 s60, s60, 0
    v_mul_u32_u24 v46, 2048, v0
    v_cmp_gt_u32 vcc, 8, v0
    v_or_b32 v44, 0x80000000, v46
    s_nop 0
    v_cndmask_b32 v46, v44, v46, vcc
    v_lshrrev_b32 v44, 4, v0
    v_bfrev_b32 v44, v44
    v_lshrrev_b32 v44, 29, v44
    v_lshl_add_u32 v45, v45, 3, v44
    v_add_u32 v45, 162432, v45
    buffer_load_dwordx4 v[18:21], v46, s[48:51], s60 offen offset:560 sc1
    buffer_load_dwordx4 v[10:13], v47, s[48:51], s60 offen offset:0 sc1
    buffer_load_dwordx4 v[14:17], v47, s[48:51], s60 offen offset:1280 sc1
    s_waitcnt vmcnt(14)
    s_add_u32 s63, s101, 1835008
    s_and_b32 s63, s63, 0x1fffff
    buffer_load_dwordx4 v[224:227], v2, s[8:11], s63 offen offset:0 nt
    buffer_load_dwordx4 v[228:231], v2, s[8:11], s63 offen offset:1024 nt
    s_waitcnt vmcnt(14)
    buffer_load_dwordx4 v[232:235], v2, s[8:11], s63 offen offset:2048 nt
    buffer_load_dwordx4 v[236:239], v2, s[8:11], s63 offen offset:3072 nt
    s_waitcnt vmcnt(14)
    s_add_u32 s63, s101, 1966080
    s_and_b32 s63, s63, 0x1fffff
    buffer_load_dwordx4 v[240:243], v2, s[8:11], s63 offen offset:0 nt
    buffer_load_dwordx4 v[244:247], v2, s[8:11], s63 offen offset:1024 nt
    s_waitcnt vmcnt(14)
    buffer_load_dwordx4 v[248:251], v2, s[8:11], s63 offen offset:2048 nt
    buffer_load_dwordx4 v[252:255], v2, s[8:11], s63 offen offset:3072 nt
    s_waitcnt vmcnt(14)
    s_add_u32 s63, s101, 0
    s_and_b32 s63, s63, 0x1fffff
    buffer_load_dwordx4 a[0:3], v3, s[12:15], s63 offen offset:0 nt
    buffer_load_dwordx4 a[4:7], v3, s[12:15], s63 offen offset:1024 nt
    s_waitcnt vmcnt(14)
    buffer_load_dwordx4 a[8:11], v3, s[12:15], s63 offen offset:2048 nt
    buffer_load_dwordx4 a[12:15], v3, s[12:15], s63 offen offset:3072 nt
    s_waitcnt vmcnt(14)
    s_add_u32 s63, s101, 131072
    s_and_b32 s63, s63, 0x1fffff
    buffer_load_dwordx4 a[16:19], v3, s[12:15], s63 offen offset:0 nt
    buffer_load_dwordx4 a[20:23], v3, s[12:15], s63 offen offset:1024 nt
    s_waitcnt vmcnt(14)
    buffer_load_dwordx4 a[24:27], v3, s[12:15], s63 offen offset:2048 nt
    buffer_load_dwordx4 a[28:31], v3, s[12:15], s63 offen offset:3072 nt
    s_waitcnt vmcnt(16)
    v_max_u32 v44, v10, v11
    v_max3_u32 v44, v44, v12, v13
    v_max3_u32 v44, v44, v18, v20
    v_max3_u32 v44, v44, v14, v15
    v_max3_u32 v44, v44, v16, v17
    v_cmp_eq_u32 vcc, -1, v44
    s_cbranch_vccz P4d
P4:
    buffer_load_dwordx4 v[18:21], v46, s[48:51], s60 offen offset:560 sc1
    buffer_load_dwordx4 v[10:13], v47, s[48:51], s60 offen offset:0 sc1
    buffer_load_dwordx4 v[14:17], v47, s[48:51], s60 offen offset:1280 sc1
    s_waitcnt vmcnt(0)
    s_sub_u32 s6, s6, 1
    s_cselect_b32 s6, 0, s6
    s_cbranch_scc1 P4x
    v_max_u32 v44, v10, v11
    v_max3_u32 v44, v44, v12, v13
    v_max3_u32 v44, v44, v18, v20
    v_max3_u32 v44, v44, v14, v15
    v_max3_u32 v44, v44, v16, v17
    v_cmp_eq_u32 vcc, -1, v44
    s_cbranch_vccnz P4
P4x:
P4d:
    v_permlane32_swap_b32 v10, v11
    v_permlane32_swap_b32 v12, v13
    v_add_f32_dpp v18, v18, v18 quad_perm:[1,0,3,2] row_mask:0xf bank_mask:0xf
    v_add_f32 v10, v10, v11
    v_add_f32_dpp v20, v20, v20 quad_perm:[1,0,3,2] row_mask:0xf bank_mask:0xf
    v_add_f32 v11, v12, v13
    v_add_f32_dpp v18, v18, v18 quad_perm:[2,3,0,1] row_mask:0xf bank_mask:0xf
    v_add_f32_dpp v20, v20, v20 quad_perm:[2,3,0,1] row_mask:0xf bank_mask:0xf
    v_permlane16_swap_b32 v10, v11
    v_add_f32_dpp v18, v18, v18 row_half_mirror row_mask:0xf bank_mask:0xf
    v_add_f32 v10, v10, v11
    v_add_f32_dpp v20, v20, v20 row_half_mirror row_mask:0xf bank_mask:0xf
    v_mul_f32 v20, 0x3ae38e39, v20
    v_add_f32_dpp v10, v10, v10 row_ror:8 row_mask:0xf bank_mask:0xf
    v_mul_f32 v18, 0x3ae38e39, v18
    v_fma_f32 v18, -v20, v20, v18
    v_max_f32 v18, 0, v18
    v_add_f32 v18, 0x3727c5ac, v18
    v_rsq_f32 v18, v18
    v_readfirstlane_b32 s0, v20
    v_readfirstlane_b32 s1, v18
    s_nop 0
    v_permlane32_swap_b32 v14, v15
    v_permlane32_swap_b32 v16, v17
    v_add_f32 v14, v14, v15
    v_add_f32 v15, v16, v17
    s_nop 1
    v_permlane16_swap_b32 v14, v15
    v_add_f32 v14, v14, v15
    s_nop 1
    v_add_f32_dpp v14, v14, v14 row_ror:8 row_mask:0xf bank_mask:0xf
    v_mov_b32 v8, v14
    v_fma_f32 v10, -s0, v8, v10
    v_mul_f32 v10, s1, v10
    v_cvt_pk_bf16_f32 v10, v10, v10
    ds_write_b16 v45, v10
    s_waitcnt lgkmcnt(0)
    s_barrier
    v_lshrrev_b32 v46, 3, v0
    v_mul_u32_u24 v46, 2048, v46
    v_and_b32 v45, 7, v0
    v_lshl_add_u32 v45, s3, 3, v45
    v_lshl_add_u32 v47, v45, 4, v46
    s_mul_i32 s60, s4, 16384
    s_add_u32 s60, s60, 0
    v_mul_u32_u24 v46, 2048, v0
    v_cmp_gt_u32 vcc, 8, v0
    v_or_b32 v44, 0x80000000, v46
    s_nop 0
    v_cndmask_b32 v46, v44, v46, vcc
    v_lshrrev_b32 v44, 4, v0
    v_bfrev_b32 v44, v44
    v_lshrrev_b32 v44, 29, v44
    v_lshl_add_u32 v45, v45, 3, v44
    v_add_u32 v45, 162688, v45
    buffer_load_dwordx4 v[18:21], v46, s[48:51], s60 offen offset:1200 sc1
    buffer_load_dwordx4 v[10:13], v47, s[48:51], s60 offen offset:640 sc1
    s_waitcnt vmcnt(14)
    s_add_u32 s63, s101, 262144
    s_and_b32 s63, s63, 0x1fffff
    buffer_load_dwordx4 a[32:35], v3, s[12:15], s63 offen offset:0 nt
    buffer_load_dwordx4 a[36:39], v3, s[12:15], s63 offen offset:1024 nt
    s_waitcnt vmcnt(14)
    buffer_load_dwordx4 a[40:43], v3, s[12:15], s63 offen offset:2048 nt
    buffer_load_dwordx4 a[44:47], v3, s[12:15], s63 offen offset:3072 nt
    s_waitcnt vmcnt(14)
    s_add_u32 s63, s101, 393216
    s_and_b32 s63, s63, 0x1fffff
    buffer_load_dwordx4 a[48:51], v3, s[12:15], s63 offen offset:0 nt
    buffer_load_dwordx4 a[52:55], v3, s[12:15], s63 offen offset:1024 nt
    s_waitcnt vmcnt(14)
    buffer_load_dwordx4 a[56:59], v3, s[12:15], s63 offen offset:2048 nt
    buffer_load_dwordx4 a[60:63], v3, s[12:15], s63 offen offset:3072 nt
    s_waitcnt vmcnt(14)
    s_add_u32 s63, s101, 524288
    s_and_b32 s63, s63, 0x1fffff
    buffer_load_dwordx4 a[64:67], v3, s[12:15], s63 offen offset:0 nt
    buffer_load_dwordx4 a[68:71], v3, s[12:15], s63 offen offset:1024 nt
    s_waitcnt vmcnt(14)
    buffer_load_dwordx4 a[72:75], v3, s[12:15], s63 offen offset:2048 nt
    buffer_load_dwordx4 a[76:79], v3, s[12:15], s63 offen offset:3072 nt
    s_waitcnt vmcnt(14)
    s_add_u32 s63, s101, 655360
    s_and_b32 s63, s63, 0x1fffff
    buffer_load_dwordx4 a[80:83], v3, s[12:15], s63 offen offset:0 nt
    buffer_load_dwordx4 a[84:87], v3, s[12:15], s63 offen offset:1024 nt
    s_waitcnt vmcnt(14)
    buffer_load_dwordx4 a[88:91], v3, s[12:15], s63 offen offset:2048 nt
    buffer_load_dwordx4 a[92:95], v3, s[12:15], s63 offen offset:3072 nt
    s_waitcnt vmcnt(16)
    v_max_u32 v44, v10, v11
    v_max3_u32 v44, v44, v12, v13
    v_max3_u32 v44, v44, v19, v20
    v_cmp_eq_u32 vcc, -1, v44
    s_cbranch_vccz P5d
P5:
    buffer_load_dwordx4 v[18:21], v46, s[48:51], s60 offen offset:1200 sc1
    buffer_load_dwordx4 v[10:13], v47, s[48:51], s60 offen offset:640 sc1
    s_waitcnt vmcnt(0)
    s_sub_u32 s6, s6, 1
    s_cselect_b32 s6, 0, s6
    s_cbranch_scc1 P5x
    v_max_u32 v44, v10, v11
    v_max3_u32 v44, v44, v12, v13
    v_max3_u32 v44, v44, v19, v20
    v_cmp_eq_u32 vcc, -1, v44
    s_cbranch_vccnz P5
P5x:
P5d:
    v_permlane32_swap_b32 v10, v11
    v_permlane32_swap_b32 v12, v13
    v_add_f32_dpp v19, v19, v19 quad_perm:[1,0,3,2] row_mask:0xf bank_mask:0xf
    v_add_f32 v10, v10, v11
    v_add_f32_dpp v20, v20, v20 quad_perm:[1,0,3,2] row_mask:0xf bank_mask:0xf
    v_add_f32 v11, v12, v13
    v_add_f32_dpp v19, v19, v19 quad_perm:[2,3,0,1] row_mask:0xf bank_mask:0xf
    v_add_f32_dpp v20, v20, v20 quad_perm:[2,3,0,1] row_mask:0xf bank_mask:0xf
    v_permlane16_swap_b32 v10, v11
    v_add_f32_dpp v19, v19, v19 row_half_mirror row_mask:0xf bank_mask:0xf
    v_add_f32 v10, v10, v11
    v_add_f32_dpp v20, v20, v20 row_half_mirror row_mask:0xf bank_mask:0xf
    v_mul_f32 v20, 0x3ae38e39, v20
    v_add_f32_dpp v10, v10, v10 row_ror:8 row_mask:0xf bank_mask:0xf
    v_mul_f32 v19, 0x3ae38e39, v19
    v_fma_f32 v19, -v20, v20, v19
    v_max_f32 v19, 0, v19
    v_add_f32 v19, 0x3727c5ac, v19
    v_rsq_f32 v19, v19
    v_readfirstlane_b32 s0, v20
    v_readfirstlane_b32 s1, v19
    s_nop 0
    v_fma_f32 v10, -s0, v8, v10
    v_mul_f32 v10, s1, v10
    v_cvt_pk_bf16_f32 v10, v10, v10
    ds_write_b16 v45, v10
    s_waitcnt lgkmcnt(0)
    s_barrier
L_a:
    s_waitcnt vmcnt(26)
    v_lshrrev_b32 v10, 4, v0
    v_and_b32 v9, 3, v0
    v_lshl_add_u32 v10, v10, 2, v9
    v_lshlrev_b32 v10, 4, v10
    v_add_u32 v10, 162432, v10
    v_lshl_add_u32 v9, v1, 1, s62
    ds_read_b128 v[28:31], v9 offset:0
    ds_read_b128 v[52:55], v9 offset:1024
    ds_read_b128 v[32:35], v9 offset:2048
    ds_read_b128 v[40:43], v9 offset:3072
    ds_read_b128 v[36:39], v9 offset:4096
    ds_read_b128 v[48:51], v10
    s_waitcnt lgkmcnt(0)
    v_cndmask_b32 v12, 0, v48, s[52:53]
    v_cndmask_b32 v13, 0, v49, s[52:53]
    v_cndmask_b32 v14, 0, v50, s[52:53]
    v_cndmask_b32 v15, 0, v51, s[52:53]
    v_cndmask_b32 v16, 0, v48, s[54:55]
    v_cndmask_b32 v17, 0, v49, s[54:55]
    v_cndmask_b32 v18, 0, v50, s[54:55]
    v_cndmask_b32 v19, 0, v51, s[54:55]
    s_waitcnt lgkmcnt(2)
    v_mfma_f32_16x16x32_bf16 v[44:47], v[28:31], v[12:15], 0
    v_cndmask_b32 v20, 0, v48, s[56:57]
    v_cndmask_b32 v21, 0, v49, s[56:57]
    v_cndmask_b32 v22, 0, v50, s[56:57]
    v_cndmask_b32 v23, 0, v51, s[56:57]
    v_mfma_f32_16x16x32_bf16 v[44:47], v[56:59], v[16:19], v[44:47]
    v_cndmask_b32 v24, 0, v48, s[58:59]
    v_cndmask_b32 v25, 0, v49, s[58:59]
    v_cndmask_b32 v26, 0, v50, s[58:59]
    v_cndmask_b32 v27, 0, v51, s[58:59]
    s_waitcnt lgkmcnt(2)
    v_mfma_f32_16x16x32_bf16 v[44:47], v[52:55], v[20:23], v[44:47]
    s_nop 0
    v_mfma_f32_16x16x32_bf16 v[44:47], v[60:63], v[24:27], v[44:47]
    s_waitcnt lgkmcnt(2)
    v_mfma_f32_16x16x32_bf16 v[48:51], v[32:35], v[12:15], 0
    ds_read_b128 v[32:35], v9 offset:5120
    v_mfma_f32_16x16x32_bf16 v[48:51], v[64:67], v[16:19], v[48:51]
    s_waitcnt lgkmcnt(2)
    v_mfma_f32_16x16x32_bf16 v[48:51], v[40:43], v[20:23], v[48:51]
    ds_read_b128 v[40:43], v9 offset:6144
    v_mfma_f32_16x16x32_bf16 v[48:51], v[68:71], v[24:27], v[48:51]
    s_add_u32 s63, s101, 786432
    s_and_b32 s63, s63, 0x1fffff
    buffer_load_dwordx4 a[96:99], v3, s[12:15], s63 offen offset:0 nt
    s_waitcnt lgkmcnt(2)
    v_mfma_f32_16x16x32_bf16 v[52:55], v[36:39], v[12:15], 0
    ds_read_b128 v[36:39], v9 offset:7168
    v_mov_b32_dpp v28, v44 quad_perm:[0,0,0,0] row_mask:0xf bank_mask:0xf
    v_mfma_f32_16x16x32_bf16 v[52:55], v[72:75], v[16:19], v[52:55]
    v_add_f32_dpp v28, v45, v28 quad_perm:[1,1,1,1] row_mask:0xf bank_mask:0xf
    s_waitcnt lgkmcnt(2)
    v_mfma_f32_16x16x32_bf16 v[52:55], v[32:35], v[20:23], v[52:55]
    ds_read_b128 v[32:35], v9 offset:8192
    v_add_f32_dpp v28, v46, v28 quad_perm:[2,2,2,2] row_mask:0xf bank_mask:0xf
    v_mfma_f32_16x16x32_bf16 v[52:55], v[76:79], v[24:27], v[52:55]
    v_add_f32_dpp v28, v47, v28 quad_perm:[3,3,3,3] row_mask:0xf bank_mask:0xf
    v_max_f32 v10, v28, v28
    s_waitcnt lgkmcnt(2)
    v_mfma_f32_16x16x32_bf16 v[44:47], v[40:43], v[12:15], 0
    ds_read_b128 v[40:43], v9 offset:9216
    v_mov_b32_dpp v29, v48 quad_perm:[0,0,0,0] row_mask:0xf bank_mask:0xf
    v_mfma_f32_16x16x32_bf16 v[44:47], v[80:83], v[16:19], v[44:47]
    v_add_f32_dpp v29, v49, v29 quad_perm:[1,1,1,1] row_mask:0xf bank_mask:0xf
    s_waitcnt lgkmcnt(2)
    v_mfma_f32_16x16x32_bf16 v[44:47], v[36:39], v[20:23], v[44:47]
    ds_read_b128 v[36:39], v9 offset:10240
    v_add_f32_dpp v29, v50, v29 quad_perm:[2,2,2,2] row_mask:0xf bank_mask:0xf
    v_mfma_f32_16x16x32_bf16 v[44:47], v[84:87], v[24:27], v[44:47]
    v_add_f32_dpp v29, v51, v29 quad_perm:[3,3,3,3] row_mask:0xf bank_mask:0xf
    v_max_f32 v10, v10, v29
    buffer_load_dwordx4 a[100:103], v3, s[12:15], s63 offen offset:1024 nt
    s_waitcnt lgkmcnt(2)
    v_mfma_f32_16x16x32_bf16 v[48:51], v[32:35], v[12:15], 0
    ds_read_b128 v[32:35], v9 offset:11264
    v_mov_b32_dpp v30, v52 quad_perm:[0,0,0,0] row_mask:0xf bank_mask:0xf
    v_mfma_f32_16x16x32_bf16 v[48:51], v[88:91], v[16:19], v[48:51]
    v_add_f32_dpp v30, v53, v30 quad_perm:[1,1,1,1] row_mask:0xf bank_mask:0xf
    s_waitcnt lgkmcnt(2)
    v_mfma_f32_16x16x32_bf16 v[48:51], v[40:43], v[20:23], v[48:51]
    ds_read_b128 v[40:43], v9 offset:12288
    v_add_f32_dpp v30, v54, v30 quad_perm:[2,2,2,2] row_mask:0xf bank_mask:0xf
    v_mfma_f32_16x16x32_bf16 v[48:51], v[92:95], v[24:27], v[48:51]
    v_add_f32_dpp v30, v55, v30 quad_perm:[3,3,3,3] row_mask:0xf bank_mask:0xf
    v_max_f32 v10, v10, v30
    s_waitcnt lgkmcnt(2)
    v_mfma_f32_16x16x32_bf16 v[52:55], v[36:39], v[12:15], 0
    ds_read_b128 v[36:39], v9 offset:13312
    v_mov_b32_dpp v31, v44 quad_perm:[0,0,0,0] row_mask:0xf bank_mask:0xf
    v_mfma_f32_16x16x32_bf16 v[52:55], v[96:99], v[16:19], v[52:55]
    v_add_f32_dpp v31, v45, v31 quad_perm:[1,1,1,1] row_mask:0xf bank_mask:0xf
    s_waitcnt lgkmcnt(2)
    v_mfma_f32_16x16x32_bf16 v[52:55], v[32:35], v[20:23], v[52:55]
    v_add_f32_dpp v31, v46, v31 quad_perm:[2,2,2,2] row_mask:0xf bank_mask:0xf
    v_mfma_f32_16x16x32_bf16 v[52:55], v[100:103], v[24:27], v[52:55]
    v_add_f32_dpp v31, v47, v31 quad_perm:[3,3,3,3] row_mask:0xf bank_mask:0xf
    v_max_f32 v10, v10, v31
    buffer_load_dwordx4 a[104:107], v3, s[12:15], s63 offen offset:2048 nt
    s_waitcnt lgkmcnt(1)
    v_mfma_f32_16x16x32_bf16 v[44:47], v[40:43], v[12:15], 0
    v_mov_b32_dpp v32, v48 quad_perm:[0,0,0,0] row_mask:0xf bank_mask:0xf
    v_mfma_f32_16x16x32_bf16 v[44:47], v[104:107], v[16:19], v[44:47]
    v_add_f32_dpp v32, v49, v32 quad_perm:[1,1,1,1] row_mask:0xf bank_mask:0xf
    s_waitcnt lgkmcnt(0)
    v_mfma_f32_16x16x32_bf16 v[44:47], v[36:39], v[20:23], v[44:47]
    v_add_f32_dpp v32, v50, v32 quad_perm:[2,2,2,2] row_mask:0xf bank_mask:0xf
    v_mfma_f32_16x16x32_bf16 v[44:47], v[108:111], v[24:27], v[44:47]
    v_add_f32_dpp v32, v51, v32 quad_perm:[3,3,3,3] row_mask:0xf bank_mask:0xf
    v_max_f32 v10, v10, v32
    v_mfma_f32_16x16x32_bf16 v[48:51], v[112:115], v[12:15], 0
    v_mov_b32_dpp v33, v52 quad_perm:[0,0,0,0] row_mask:0xf bank_mask:0xf
    v_mfma_f32_16x16x32_bf16 v[48:51], v[116:119], v[16:19], v[48:51]
    v_add_f32_dpp v33, v53, v33 quad_perm:[1,1,1,1] row_mask:0xf bank_mask:0xf
    v_mfma_f32_16x16x32_bf16 v[48:51], v[120:123], v[20:23], v[48:51]
    v_add_f32_dpp v33, v54, v33 quad_perm:[2,2,2,2] row_mask:0xf bank_mask:0xf
    v_mfma_f32_16x16x32_bf16 v[48:51], v[124:127], v[24:27], v[48:51]
    v_add_f32_dpp v33, v55, v33 quad_perm:[3,3,3,3] row_mask:0xf bank_mask:0xf
    v_max_f32 v10, v10, v33
    buffer_load_dwordx4 a[108:111], v3, s[12:15], s63 offen offset:3072 nt
    v_mfma_f32_16x16x32_bf16 v[52:55], v[128:131], v[12:15], 0
    v_mov_b32_dpp v34, v44 quad_perm:[0,0,0,0] row_mask:0xf bank_mask:0xf
    v_mfma_f32_16x16x32_bf16 v[52:55], v[132:135], v[16:19], v[52:55]
    v_add_f32_dpp v34, v45, v34 quad_perm:[1,1,1,1] row_mask:0xf bank_mask:0xf
    v_mfma_f32_16x16x32_bf16 v[52:55], v[136:139], v[20:23], v[52:55]
    v_add_f32_dpp v34, v46, v34 quad_perm:[2,2,2,2] row_mask:0xf bank_mask:0xf
    v_mfma_f32_16x16x32_bf16 v[52:55], v[140:143], v[24:27], v[52:55]
    v_add_f32_dpp v34, v47, v34 quad_perm:[3,3,3,3] row_mask:0xf bank_mask:0xf
    v_max_f32 v10, v10, v34
    v_mfma_f32_16x16x32_bf16 v[44:47], v[144:147], v[12:15], 0
    v_mov_b32_dpp v35, v48 quad_perm:[0,0,0,0] row_mask:0xf bank_mask:0xf
    v_mfma_f32_16x16x32_bf16 v[44:47], v[148:151], v[16:19], v[44:47]
    v_add_f32_dpp v35, v49, v35 quad_perm:[1,1,1,1] row_mask:0xf bank_mask:0xf
    v_mfma_f32_16x16x32_bf16 v[44:47], v[152:155], v[20:23], v[44:47]
    v_add_f32_dpp v35, v50, v35 quad_perm:[2,2,2,2] row_mask:0xf bank_mask:0xf
    v_mfma_f32_16x16x32_bf16 v[44:47], v[156:159], v[24:27], v[44:47]
    v_add_f32_dpp v35, v51, v35 quad_perm:[3,3,3,3] row_mask:0xf bank_mask:0xf
    v_max_f32 v10, v10, v35
    s_add_u32 s63, s101, 917504
    s_and_b32 s63, s63, 0x1fffff
    buffer_load_dwordx4 a[112:115], v3, s[12:15], s63 offen offset:0 nt
    v_mfma_f32_16x16x32_bf16 v[48:51], v[160:163], v[12:15], 0
    v_mov_b32_dpp v36, v52 quad_perm:[0,0,0,0] row_mask:0xf bank_mask:0xf
    v_mfma_f32_16x16x32_bf16 v[48:51], v[164:167], v[16:19], v[48:51]
    v_add_f32_dpp v36, v53, v36 quad_perm:[1,1,1,1] row_mask:0xf bank_mask:0xf
    v_mfma_f32_16x16x32_bf16 v[48:51], v[168:171], v[20:23], v[48:51]
    v_add_f32_dpp v36, v54, v36 quad_perm:[2,2,2,2] row_mask:0xf bank_mask:0xf
    v_mfma_f32_16x16x32_bf16 v[48:51], v[172:175], v[24:27], v[48:51]
    v_add_f32_dpp v36, v55, v36 quad_perm:[3,3,3,3] row_mask:0xf bank_mask:0xf
    v_max_f32 v10, v10, v36
    v_mfma_f32_16x16x32_bf16 v[52:55], v[176:179], v[12:15], 0
    v_mov_b32_dpp v37, v44 quad_perm:[0,0,0,0] row_mask:0xf bank_mask:0xf
    v_mfma_f32_16x16x32_bf16 v[52:55], v[180:183], v[16:19], v[52:55]
    v_add_f32_dpp v37, v45, v37 quad_perm:[1,1,1,1] row_mask:0xf bank_mask:0xf
    v_mfma_f32_16x16x32_bf16 v[52:55], v[184:187], v[20:23], v[52:55]
    v_add_f32_dpp v37, v46, v37 quad_perm:[2,2,2,2] row_mask:0xf bank_mask:0xf
    v_mfma_f32_16x16x32_bf16 v[52:55], v[188:191], v[24:27], v[52:55]
    v_add_f32_dpp v37, v47, v37 quad_perm:[3,3,3,3] row_mask:0xf bank_mask:0xf
    v_max_f32 v10, v10, v37
    buffer_load_dwordx4 a[116:119], v3, s[12:15], s63 offen offset:1024 nt
    v_mfma_f32_16x16x32_bf16 v[44:47], v[192:195], v[12:15], 0
    v_mov_b32_dpp v38, v48 quad_perm:[0,0,0,0] row_mask:0xf bank_mask:0xf
    v_mfma_f32_16x16x32_bf16 v[44:47], v[196:199], v[16:19], v[44:47]
    v_add_f32_dpp v38, v49, v38 quad_perm:[1,1,1,1] row_mask:0xf bank_mask:0xf
    v_mfma_f32_16x16x32_bf16 v[44:47], v[200:203], v[20:23], v[44:47]
    v_add_f32_dpp v38, v50, v38 quad_perm:[2,2,2,2] row_mask:0xf bank_mask:0xf
    v_mfma_f32_16x16x32_bf16 v[44:47], v[204:207], v[24:27], v[44:47]
    v_add_f32_dpp v38, v51, v38 quad_perm:[3,3,3,3] row_mask:0xf bank_mask:0xf
    v_max_f32 v10, v10, v38
    v_mfma_f32_16x16x32_bf16 v[48:51], v[208:211], v[12:15], 0
    v_mov_b32_dpp v39, v52 quad_perm:[0,0,0,0] row_mask:0xf bank_mask:0xf
    v_mfma_f32_16x16x32_bf16 v[48:51], v[212:215], v[16:19], v[48:51]
    v_add_f32_dpp v39, v53, v39 quad_perm:[1,1,1,1] row_mask:0xf bank_mask:0xf
    v_mfma_f32_16x16x32_bf16 v[48:51], v[216:219], v[20:23], v[48:51]
    v_add_f32_dpp v39, v54, v39 quad_perm:[2,2,2,2] row_mask:0xf bank_mask:0xf
    v_mfma_f32_16x16x32_bf16 v[48:51], v[220:223], v[24:27], v[48:51]
    v_add_f32_dpp v39, v55, v39 quad_perm:[3,3,3,3] row_mask:0xf bank_mask:0xf
    v_max_f32 v10, v10, v39
    buffer_load_dwordx4 a[120:123], v3, s[12:15], s63 offen offset:2048 nt
    v_mfma_f32_16x16x32_bf16 v[52:55], v[224:227], v[12:15], 0
    v_mov_b32_dpp v40, v44 quad_perm:[0,0,0,0] row_mask:0xf bank_mask:0xf
    v_mfma_f32_16x16x32_bf16 v[52:55], v[228:231], v[16:19], v[52:55]
    v_add_f32_dpp v40, v45, v40 quad_perm:[1,1,1,1] row_mask:0xf bank_mask:0xf
    v_mfma_f32_16x16x32_bf16 v[52:55], v[232:235], v[20:23], v[52:55]
    v_add_f32_dpp v40, v46, v40 quad_perm:[2,2,2,2] row_mask:0xf bank_mask:0xf
    v_mfma_f32_16x16x32_bf16 v[52:55], v[236:239], v[24:27], v[52:55]
    v_add_f32_dpp v40, v47, v40 quad_perm:[3,3,3,3] row_mask:0xf bank_mask:0xf
    v_max_f32 v10, v10, v40
    v_mfma_f32_16x16x32_bf16 v[44:47], v[240:243], v[12:15], 0
    v_mov_b32_dpp v41, v48 quad_perm:[0,0,0,0] row_mask:0xf bank_mask:0xf
    v_mfma_f32_16x16x32_bf16 v[44:47], v[244:247], v[16:19], v[44:47]
    v_add_f32_dpp v41, v49, v41 quad_perm:[1,1,1,1] row_mask:0xf bank_mask:0xf
    v_mfma_f32_16x16x32_bf16 v[44:47], v[248:251], v[20:23], v[44:47]
    v_add_f32_dpp v41, v50, v41 quad_perm:[2,2,2,2] row_mask:0xf bank_mask:0xf
    v_mfma_f32_16x16x32_bf16 v[44:47], v[252:255], v[24:27], v[44:47]
    v_add_f32_dpp v41, v51, v41 quad_perm:[3,3,3,3] row_mask:0xf bank_mask:0xf
    v_max_f32 v10, v10, v41
    buffer_load_dwordx4 a[124:127], v3, s[12:15], s63 offen offset:3072 nt
    v_mov_b32_dpp v42, v52 quad_perm:[0,0,0,0] row_mask:0xf bank_mask:0xf
    v_add_f32_dpp v42, v53, v42 quad_perm:[1,1,1,1] row_mask:0xf bank_mask:0xf
    v_add_f32_dpp v42, v54, v42 quad_perm:[2,2,2,2] row_mask:0xf bank_mask:0xf
    v_add_f32_dpp v42, v55, v42 quad_perm:[3,3,3,3] row_mask:0xf bank_mask:0xf
    v_max_f32 v10, v10, v42
    v_and_b32 v11, 1, v0
    v_lshlrev_b32 v11, 4, v11
    v_mov_b32 v48, 0xffff
    v_lshlrev_b32 v48, v11, v48
    v_mov_b32_dpp v43, v44 quad_perm:[0,0,0,0] row_mask:0xf bank_mask:0xf
    v_add_f32_dpp v43, v45, v43 quad_perm:[1,1,1,1] row_mask:0xf bank_mask:0xf
    v_add_f32_dpp v43, v46, v43 quad_perm:[2,2,2,2] row_mask:0xf bank_mask:0xf
    v_add_f32_dpp v43, v47, v43 quad_perm:[3,3,3,3] row_mask:0xf bank_mask:0xf
    v_max_f32 v10, v10, v43
    s_mov_b32 vcc_lo, 0x33333333
    s_mov_b32 vcc_hi, 0x33333333
    v_cndmask_b32 v44, 0, v48, vcc
    s_mov_b32 vcc_lo, 0xcccccccc
    s_mov_b32 vcc_hi, 0xcccccccc
    v_cndmask_b32 v45, 0, v48, vcc
    s_mov_b32 s7, 0x3e0293ee
    s_nop 1
    v_max_f32_dpp v10, v10, v10 row_ror:4 row_mask:0xf bank_mask:0xf
    s_nop 1
    v_max_f32_dpp v10, v10, v10 row_ror:8 row_mask:0xf bank_mask:0xf
    v_mov_b32 v11, v10
    s_nop 1
    v_permlane32_swap_b32 v10, v11
    v_max_f32 v10, v10, v11
    v_mov_b32 v11, v10
    s_nop 1
    v_permlane16_swap_b32 v10, v11
    v_max_f32 v10, v10, v11
    v_mul_f32 v10, s7, v10
    v_mov_b32 v11, 0
    v_fma_f32 v28, v28, s7, -v10
    v_fma_f32 v29, v29, s7, -v10
    v_exp_f32 v28, v28
    v_exp_f32 v29, v29
    v_add_f32 v11, v11, v28
    v_add_f32 v11, v11, v29
    v_cvt_pk_bf16_f32 v28, v28, v28
    v_cvt_pk_bf16_f32 v29, v29, v29
    v_and_b32 v48, v28, v44
    v_and_b32 v49, v28, v45
    s_nop 1
    s_waitcnt vmcnt(30)
    v_mfma_f32_4x4x4_16b_bf16 v[12:15], v[48:49], a[0:1], 0 cbsz:2 abid:0
    v_and_b32 v50, v29, v44
    v_mfma_f32_4x4x4_16b_bf16 v[16:19], v[48:49], a[2:3], 0 cbsz:2 abid:0
    v_and_b32 v51, v29, v45
    v_mfma_f32_4x4x4_16b_bf16 v[20:23], v[48:49], a[4:5], 0 cbsz:2 abid:1
    v_fma_f32 v30, v30, s7, -v10
    v_mfma_f32_4x4x4_16b_bf16 v[24:27], v[48:49], a[6:7], 0 cbsz:2 abid:1
    v_exp_f32 v30, v30
    v_mfma_f32_4x4x4_16b_bf16 v[12:15], v[48:49], a[8:9], v[12:15] cbsz:2 abid:2
    v_add_f32 v11, v11, v30
    v_mfma_f32_4x4x4_16b_bf16 v[16:19], v[48:49], a[10:11], v[16:19] cbsz:2 abid:2
    v_cvt_pk_bf16_f32 v30, v30, v30
    v_mfma_f32_4x4x4_16b_bf16 v[20:23], v[48:49], a[12:13], v[20:23] cbsz:2 abid:3
    v_mfma_f32_4x4x4_16b_bf16 v[24:27], v[48:49], a[14:15], v[24:27] cbsz:2 abid:3
    s_waitcnt vmcnt(26)
    v_mfma_f32_4x4x4_16b_bf16 v[12:15], v[50:51], a[16:17], v[12:15] cbsz:2 abid:0
    v_and_b32 v48, v30, v44
    v_mfma_f32_4x4x4_16b_bf16 v[16:19], v[50:51], a[18:19], v[16:19] cbsz:2 abid:0
    v_and_b32 v49, v30, v45
    v_mfma_f32_4x4x4_16b_bf16 v[20:23], v[50:51], a[20:21], v[20:23] cbsz:2 abid:1
    v_fma_f32 v31, v31, s7, -v10
    v_mfma_f32_4x4x4_16b_bf16 v[24:27], v[50:51], a[22:23], v[24:27] cbsz:2 abid:1
    v_exp_f32 v31, v31
    v_mfma_f32_4x4x4_16b_bf16 v[12:15], v[50:51], a[24:25], v[12:15] cbsz:2 abid:2
    v_add_f32 v11, v11, v31
    v_mfma_f32_4x4x4_16b_bf16 v[16:19], v[50:51], a[26:27], v[16:19] cbsz:2 abid:2
    v_cvt_pk_bf16_f32 v31, v31, v31
    v_mfma_f32_4x4x4_16b_bf16 v[20:23], v[50:51], a[28:29], v[20:23] cbsz:2 abid:3
    v_mfma_f32_4x4x4_16b_bf16 v[24:27], v[50:51], a[30:31], v[24:27] cbsz:2 abid:3
    s_waitcnt vmcnt(20)
    v_mfma_f32_4x4x4_16b_bf16 v[12:15], v[48:49], a[32:33], v[12:15] cbsz:2 abid:0
    v_and_b32 v50, v31, v44
    v_mfma_f32_4x4x4_16b_bf16 v[16:19], v[48:49], a[34:35], v[16:19] cbsz:2 abid:0
    v_and_b32 v51, v31, v45
    v_mfma_f32_4x4x4_16b_bf16 v[20:23], v[48:49], a[36:37], v[20:23] cbsz:2 abid:1
    v_fma_f32 v32, v32, s7, -v10
    v_mfma_f32_4x4x4_16b_bf16 v[24:27], v[48:49], a[38:39], v[24:27] cbsz:2 abid:1
    v_exp_f32 v32, v32
    v_mfma_f32_4x4x4_16b_bf16 v[12:15], v[48:49], a[40:41], v[12:15] cbsz:2 abid:2
    v_add_f32 v11, v11, v32
    v_mfma_f32_4x4x4_16b_bf16 v[16:19], v[48:49], a[42:43], v[16:19] cbsz:2 abid:2
    v_cvt_pk_bf16_f32 v32, v32, v32
    v_mfma_f32_4x4x4_16b_bf16 v[20:23], v[48:49], a[44:45], v[20:23] cbsz:2 abid:3
    v_mfma_f32_4x4x4_16b_bf16 v[24:27], v[48:49], a[46:47], v[24:27] cbsz:2 abid:3
    s_waitcnt vmcnt(16)
    v_mfma_f32_4x4x4_16b_bf16 v[12:15], v[50:51], a[48:49], v[12:15] cbsz:2 abid:0
    v_and_b32 v48, v32, v44
    v_mfma_f32_4x4x4_16b_bf16 v[16:19], v[50:51], a[50:51], v[16:19] cbsz:2 abid:0
    v_and_b32 v49, v32, v45
    v_mfma_f32_4x4x4_16b_bf16 v[20:23], v[50:51], a[52:53], v[20:23] cbsz:2 abid:1
    v_fma_f32 v33, v33, s7, -v10
    v_mfma_f32_4x4x4_16b_bf16 v[24:27], v[50:51], a[54:55], v[24:27] cbsz:2 abid:1
    v_exp_f32 v33, v33
    v_mfma_f32_4x4x4_16b_bf16 v[12:15], v[50:51], a[56:57], v[12:15] cbsz:2 abid:2
    v_add_f32 v11, v11, v33
    v_mfma_f32_4x4x4_16b_bf16 v[16:19], v[50:51], a[58:59], v[16:19] cbsz:2 abid:2
    v_cvt_pk_bf16_f32 v33, v33, v33
    v_mfma_f32_4x4x4_16b_bf16 v[20:23], v[50:51], a[60:61], v[20:23] cbsz:2 abid:3
    v_mfma_f32_4x4x4_16b_bf16 v[24:27], v[50:51], a[62:63], v[24:27] cbsz:2 abid:3
    s_add_u32 s63, s101, 1048576
    s_and_b32 s63, s63, 0x1fffff
    buffer_load_dwordx4 a[128:131], v3, s[12:15], s63 offen offset:0 nt
    buffer_load_dwordx4 a[132:135], v3, s[12:15], s63 offen offset:1024 nt
    buffer_load_dwordx4 a[136:139], v3, s[12:15], s63 offen offset:2048 nt
    buffer_load_dwordx4 a[140:143], v3, s[12:15], s63 offen offset:3072 nt
    s_waitcnt vmcnt(16)
    v_mfma_f32_4x4x4_16b_bf16 v[12:15], v[48:49], a[64:65], v[12:15] cbsz:2 abid:0
    v_and_b32 v50, v33, v44
    v_mfma_f32_4x4x4_16b_bf16 v[16:19], v[48:49], a[66:67], v[16:19] cbsz:2 abid:0
    v_and_b32 v51, v33, v45
    v_mfma_f32_4x4x4_16b_bf16 v[20:23], v[48:49], a[68:69], v[20:23] cbsz:2 abid:1
    v_fma_f32 v34, v34, s7, -v10
    v_mfma_f32_4x4x4_16b_bf16 v[24:27], v[48:49], a[70:71], v[24:27] cbsz:2 abid:1
    v_exp_f32 v34, v34
    v_mfma_f32_4x4x4_16b_bf16 v[12:15], v[48:49], a[72:73], v[12:15] cbsz:2 abid:2
    v_add_f32 v11, v11, v34
    v_mfma_f32_4x4x4_16b_bf16 v[16:19], v[48:49], a[74:75], v[16:19] cbsz:2 abid:2
    v_cvt_pk_bf16_f32 v34, v34, v34
    v_mfma_f32_4x4x4_16b_bf16 v[20:23], v[48:49], a[76:77], v[20:23] cbsz:2 abid:3
    v_mfma_f32_4x4x4_16b_bf16 v[24:27], v[48:49], a[78:79], v[24:27] cbsz:2 abid:3
    s_add_u32 s63, s101, 1179648
    s_and_b32 s63, s63, 0x1fffff
    buffer_load_dwordx4 a[144:147], v3, s[12:15], s63 offen offset:0 nt
    buffer_load_dwordx4 a[148:151], v3, s[12:15], s63 offen offset:1024 nt
    buffer_load_dwordx4 a[152:155], v3, s[12:15], s63 offen offset:2048 nt
    buffer_load_dwordx4 a[156:159], v3, s[12:15], s63 offen offset:3072 nt
    s_waitcnt vmcnt(16)
    v_mfma_f32_4x4x4_16b_bf16 v[12:15], v[50:51], a[80:81], v[12:15] cbsz:2 abid:0
    v_and_b32 v48, v34, v44
    v_mfma_f32_4x4x4_16b_bf16 v[16:19], v[50:51], a[82:83], v[16:19] cbsz:2 abid:0
    v_and_b32 v49, v34, v45
    v_mfma_f32_4x4x4_16b_bf16 v[20:23], v[50:51], a[84:85], v[20:23] cbsz:2 abid:1
    v_fma_f32 v35, v35, s7, -v10
    v_mfma_f32_4x4x4_16b_bf16 v[24:27], v[50:51], a[86:87], v[24:27] cbsz:2 abid:1
    v_exp_f32 v35, v35
    v_mfma_f32_4x4x4_16b_bf16 v[12:15], v[50:51], a[88:89], v[12:15] cbsz:2 abid:2
    v_add_f32 v11, v11, v35
    v_mfma_f32_4x4x4_16b_bf16 v[16:19], v[50:51], a[90:91], v[16:19] cbsz:2 abid:2
    v_cvt_pk_bf16_f32 v35, v35, v35
    v_mfma_f32_4x4x4_16b_bf16 v[20:23], v[50:51], a[92:93], v[20:23] cbsz:2 abid:3
    v_mfma_f32_4x4x4_16b_bf16 v[24:27], v[50:51], a[94:95], v[24:27] cbsz:2 abid:3
    s_add_u32 s63, s101, 1310720
    s_and_b32 s63, s63, 0x1fffff
    buffer_load_dwordx4 a[160:163], v3, s[12:15], s63 offen offset:0 nt
    buffer_load_dwordx4 a[164:167], v3, s[12:15], s63 offen offset:1024 nt
    buffer_load_dwordx4 a[168:171], v3, s[12:15], s63 offen offset:2048 nt
    buffer_load_dwordx4 a[172:175], v3, s[12:15], s63 offen offset:3072 nt
    s_waitcnt vmcnt(16)
    v_mfma_f32_4x4x4_16b_bf16 v[12:15], v[48:49], a[96:97], v[12:15] cbsz:2 abid:0
    v_and_b32 v50, v35, v44
    v_mfma_f32_4x4x4_16b_bf16 v[16:19], v[48:49], a[98:99], v[16:19] cbsz:2 abid:0
    v_and_b32 v51, v35, v45
    v_mfma_f32_4x4x4_16b_bf16 v[20:23], v[48:49], a[100:101], v[20:23] cbsz:2 abid:1
    v_fma_f32 v36, v36, s7, -v10
    v_mfma_f32_4x4x4_16b_bf16 v[24:27], v[48:49], a[102:103], v[24:27] cbsz:2 abid:1
    v_exp_f32 v36, v36
    v_mfma_f32_4x4x4_16b_bf16 v[12:15], v[48:49], a[104:105], v[12:15] cbsz:2 abid:2
    v_add_f32 v11, v11, v36
    v_mfma_f32_4x4x4_16b_bf16 v[16:19], v[48:49], a[106:107], v[16:19] cbsz:2 abid:2
    v_cvt_pk_bf16_f32 v36, v36, v36
    v_mfma_f32_4x4x4_16b_bf16 v[20:23], v[48:49], a[108:109], v[20:23] cbsz:2 abid:3
    v_mfma_f32_4x4x4_16b_bf16 v[24:27], v[48:49], a[110:111], v[24:27] cbsz:2 abid:3
    s_add_u32 s63, s101, 1441792
    s_and_b32 s63, s63, 0x1fffff
    buffer_load_dwordx4 a[176:179], v3, s[12:15], s63 offen offset:0 nt
    buffer_load_dwordx4 a[180:183], v3, s[12:15], s63 offen offset:1024 nt
    buffer_load_dwordx4 a[184:187], v3, s[12:15], s63 offen offset:2048 nt
    buffer_load_dwordx4 a[188:191], v3, s[12:15], s63 offen offset:3072 nt
    s_waitcnt vmcnt(16)
    v_mfma_f32_4x4x4_16b_bf16 v[12:15], v[50:51], a[112:113], v[12:15] cbsz:2 abid:0
    v_and_b32 v48, v36, v44
    v_mfma_f32_4x4x4_16b_bf16 v[16:19], v[50:51], a[114:115], v[16:19] cbsz:2 abid:0
    v_and_b32 v49, v36, v45
    v_mfma_f32_4x4x4_16b_bf16 v[20:23], v[50:51], a[116:117], v[20:23] cbsz:2 abid:1
    v_fma_f32 v37, v37, s7, -v10
    v_mfma_f32_4x4x4_16b_bf16 v[24:27], v[50:51], a[118:119], v[24:27] cbsz:2 abid:1
    v_exp_f32 v37, v37
    v_mfma_f32_4x4x4_16b_bf16 v[12:15], v[50:51], a[120:121], v[12:15] cbsz:2 abid:2
    v_add_f32 v11, v11, v37
    v_mfma_f32_4x4x4_16b_bf16 v[16:19], v[50:51], a[122:123], v[16:19] cbsz:2 abid:2
    v_cvt_pk_bf16_f32 v37, v37, v37
    v_mfma_f32_4x4x4_16b_bf16 v[20:23], v[50:51], a[124:125], v[20:23] cbsz:2 abid:3
    v_mfma_f32_4x4x4_16b_bf16 v[24:27], v[50:51], a[126:127], v[24:27] cbsz:2 abid:3
    s_add_u32 s63, s101, 1572864
    s_and_b32 s63, s63, 0x1fffff
    buffer_load_dwordx4 a[192:195], v3, s[12:15], s63 offen offset:0 nt
    buffer_load_dwordx4 a[196:199], v3, s[12:15], s63 offen offset:1024 nt
    buffer_load_dwordx4 a[200:203], v3, s[12:15], s63 offen offset:2048 nt
    buffer_load_dwordx4 a[204:207], v3, s[12:15], s63 offen offset:3072 nt
    s_waitcnt vmcnt(16)
    v_mfma_f32_4x4x4_16b_bf16 v[12:15], v[48:49], a[128:129], v[12:15] cbsz:2 abid:0
    v_and_b32 v50, v37, v44
    v_mfma_f32_4x4x4_16b_bf16 v[16:19], v[48:49], a[130:131], v[16:19] cbsz:2 abid:0
    v_and_b32 v51, v37, v45
    v_mfma_f32_4x4x4_16b_bf16 v[20:23], v[48:49], a[132:133], v[20:23] cbsz:2 abid:1
    v_fma_f32 v38, v38, s7, -v10
    v_mfma_f32_4x4x4_16b_bf16 v[24:27], v[48:49], a[134:135], v[24:27] cbsz:2 abid:1
    v_exp_f32 v38, v38
    v_mfma_f32_4x4x4_16b_bf16 v[12:15], v[48:49], a[136:137], v[12:15] cbsz:2 abid:2
    v_add_f32 v11, v11, v38
    v_mfma_f32_4x4x4_16b_bf16 v[16:19], v[48:49], a[138:139], v[16:19] cbsz:2 abid:2
    v_cvt_pk_bf16_f32 v38, v38, v38
    v_mfma_f32_4x4x4_16b_bf16 v[20:23], v[48:49], a[140:141], v[20:23] cbsz:2 abid:3
    v_mfma_f32_4x4x4_16b_bf16 v[24:27], v[48:49], a[142:143], v[24:27] cbsz:2 abid:3
    s_add_u32 s63, s101, 1703936
    s_and_b32 s63, s63, 0x1fffff
    buffer_load_dwordx4 a[208:211], v3, s[12:15], s63 offen offset:0 nt
    buffer_load_dwordx4 a[212:215], v3, s[12:15], s63 offen offset:1024 nt
    buffer_load_dwordx4 a[216:219], v3, s[12:15], s63 offen offset:2048 nt
    buffer_load_dwordx4 a[220:223], v3, s[12:15], s63 offen offset:3072 nt
    s_waitcnt vmcnt(16)
    v_mfma_f32_4x4x4_16b_bf16 v[12:15], v[50:51], a[144:145], v[12:15] cbsz:2 abid:0
    v_and_b32 v48, v38, v44
    v_mfma_f32_4x4x4_16b_bf16 v[16:19], v[50:51], a[146:147], v[16:19] cbsz:2 abid:0
    v_and_b32 v49, v38, v45
    v_mfma_f32_4x4x4_16b_bf16 v[20:23], v[50:51], a[148:149], v[20:23] cbsz:2 abid:1
    v_fma_f32 v39, v39, s7, -v10
    v_mfma_f32_4x4x4_16b_bf16 v[24:27], v[50:51], a[150:151], v[24:27] cbsz:2 abid:1
    v_exp_f32 v39, v39
    v_mfma_f32_4x4x4_16b_bf16 v[12:15], v[50:51], a[152:153], v[12:15] cbsz:2 abid:2
    v_add_f32 v11, v11, v39
    v_mfma_f32_4x4x4_16b_bf16 v[16:19], v[50:51], a[154:155], v[16:19] cbsz:2 abid:2
    v_cvt_pk_bf16_f32 v39, v39, v39
    v_mfma_f32_4x4x4_16b_bf16 v[20:23], v[50:51], a[156:157], v[20:23] cbsz:2 abid:3
    v_mfma_f32_4x4x4_16b_bf16 v[24:27], v[50:51], a[158:159], v[24:27] cbsz:2 abid:3
    s_add_u32 s63, s101, 1835008
    s_and_b32 s63, s63, 0x1fffff
    buffer_load_dwordx4 a[224:227], v3, s[12:15], s63 offen offset:0 nt
    buffer_load_dwordx4 a[228:231], v3, s[12:15], s63 offen offset:1024 nt
    buffer_load_dwordx4 a[232:235], v3, s[12:15], s63 offen offset:2048 nt
    buffer_load_dwordx4 a[236:239], v3, s[12:15], s63 offen offset:3072 nt
    s_waitcnt vmcnt(16)
    v_mfma_f32_4x4x4_16b_bf16 v[12:15], v[48:49], a[160:161], v[12:15] cbsz:2 abid:0
    v_and_b32 v50, v39, v44
    v_mfma_f32_4x4x4_16b_bf16 v[16:19], v[48:49], a[162:163], v[16:19] cbsz:2 abid:0
    v_and_b32 v51, v39, v45
    v_mfma_f32_4x4x4_16b_bf16 v[20:23], v[48:49], a[164:165], v[20:23] cbsz:2 abid:1
    v_fma_f32 v40, v40, s7, -v10
    v_mfma_f32_4x4x4_16b_bf16 v[24:27], v[48:49], a[166:167], v[24:27] cbsz:2 abid:1
    v_exp_f32 v40, v40
    v_mfma_f32_4x4x4_16b_bf16 v[12:15], v[48:49], a[168:169], v[12:15] cbsz:2 abid:2
    v_add_f32 v11, v11, v40
    v_mfma_f32_4x4x4_16b_bf16 v[16:19], v[48:49], a[170:171], v[16:19] cbsz:2 abid:2
    v_cvt_pk_bf16_f32 v40, v40, v40
    v_mfma_f32_4x4x4_16b_bf16 v[20:23], v[48:49], a[172:173], v[20:23] cbsz:2 abid:3
    v_mfma_f32_4x4x4_16b_bf16 v[24:27], v[48:49], a[174:175], v[24:27] cbsz:2 abid:3
    s_add_u32 s63, s101, 1966080
    s_and_b32 s63, s63, 0x1fffff
    buffer_load_dwordx4 a[240:243], v3, s[12:15], s63 offen offset:0 nt
    buffer_load_dwordx4 a[244:247], v3, s[12:15], s63 offen offset:1024 nt
    buffer_load_dwordx4 a[248:251], v3, s[12:15], s63 offen offset:2048 nt
    buffer_load_dwordx4 a[252:255], v3, s[12:15], s63 offen offset:3072 nt
    s_waitcnt vmcnt(16)
    v_mfma_f32_4x4x4_16b_bf16 v[12:15], v[50:51], a[176:177], v[12:15] cbsz:2 abid:0
    v_and_b32 v48, v40, v44
    v_mfma_f32_4x4x4_16b_bf16 v[16:19], v[50:51], a[178:179], v[16:19] cbsz:2 abid:0
    v_and_b32 v49, v40, v45
    v_mfma_f32_4x4x4_16b_bf16 v[20:23], v[50:51], a[180:181], v[20:23] cbsz:2 abid:1
    v_fma_f32 v41, v41, s7, -v10
    v_mfma_f32_4x4x4_16b_bf16 v[24:27], v[50:51], a[182:183], v[24:27] cbsz:2 abid:1
    v_exp_f32 v41, v41
    v_mfma_f32_4x4x4_16b_bf16 v[12:15], v[50:51], a[184:185], v[12:15] cbsz:2 abid:2
    v_add_f32 v11, v11, v41
    v_mfma_f32_4x4x4_16b_bf16 v[16:19], v[50:51], a[186:187], v[16:19] cbsz:2 abid:2
    v_cvt_pk_bf16_f32 v41, v41, v41
    v_mfma_f32_4x4x4_16b_bf16 v[20:23], v[50:51], a[188:189], v[20:23] cbsz:2 abid:3
    v_mfma_f32_4x4x4_16b_bf16 v[24:27], v[50:51], a[190:191], v[24:27] cbsz:2 abid:3
    s_waitcnt vmcnt(12)
    v_mfma_f32_4x4x4_16b_bf16 v[12:15], v[48:49], a[192:193], v[12:15] cbsz:2 abid:0
    v_and_b32 v50, v41, v44
    v_mfma_f32_4x4x4_16b_bf16 v[16:19], v[48:49], a[194:195], v[16:19] cbsz:2 abid:0
    v_and_b32 v51, v41, v45
    v_mfma_f32_4x4x4_16b_bf16 v[20:23], v[48:49], a[196:197], v[20:23] cbsz:2 abid:1
    v_fma_f32 v42, v42, s7, -v10
    v_mfma_f32_4x4x4_16b_bf16 v[24:27], v[48:49], a[198:199], v[24:27] cbsz:2 abid:1
    v_exp_f32 v42, v42
    v_mfma_f32_4x4x4_16b_bf16 v[12:15], v[48:49], a[200:201], v[12:15] cbsz:2 abid:2
    v_add_f32 v11, v11, v42
    v_mfma_f32_4x4x4_16b_bf16 v[16:19], v[48:49], a[202:203], v[16:19] cbsz:2 abid:2
    v_cvt_pk_bf16_f32 v42, v42, v42
    v_mfma_f32_4x4x4_16b_bf16 v[20:23], v[48:49], a[204:205], v[20:23] cbsz:2 abid:3
    v_mfma_f32_4x4x4_16b_bf16 v[24:27], v[48:49], a[206:207], v[24:27] cbsz:2 abid:3
    s_waitcnt vmcnt(8)
    v_mfma_f32_4x4x4_16b_bf16 v[12:15], v[50:51], a[208:209], v[12:15] cbsz:2 abid:0
    v_and_b32 v48, v42, v44
    v_mfma_f32_4x4x4_16b_bf16 v[16:19], v[50:51], a[210:211], v[16:19] cbsz:2 abid:0
    v_and_b32 v49, v42, v45
    v_mfma_f32_4x4x4_16b_bf16 v[20:23], v[50:51], a[212:213], v[20:23] cbsz:2 abid:1
    v_fma_f32 v43, v43, s7, -v10
    v_mfma_f32_4x4x4_16b_bf16 v[24:27], v[50:51], a[214:215], v[24:27] cbsz:2 abid:1
    v_exp_f32 v43, v43
    v_mfma_f32_4x4x4_16b_bf16 v[12:15], v[50:51], a[216:217], v[12:15] cbsz:2 abid:2
    v_add_f32 v11, v11, v43
    v_mfma_f32_4x4x4_16b_bf16 v[16:19], v[50:51], a[218:219], v[16:19] cbsz:2 abid:2
    v_cvt_pk_bf16_f32 v43, v43, v43
    v_mfma_f32_4x4x4_16b_bf16 v[20:23], v[50:51], a[220:221], v[20:23] cbsz:2 abid:3
    v_mfma_f32_4x4x4_16b_bf16 v[24:27], v[50:51], a[222:223], v[24:27] cbsz:2 abid:3
    s_mov_b32 s60, 158080
    s_mov_b32 s61, 162304
    s_waitcnt vmcnt(4)
    v_mfma_f32_4x4x4_16b_bf16 v[12:15], v[48:49], a[224:225], v[12:15] cbsz:2 abid:0
    v_and_b32 v50, v43, v44
    v_mfma_f32_4x4x4_16b_bf16 v[16:19], v[48:49], a[226:227], v[16:19] cbsz:2 abid:0
    v_and_b32 v51, v43, v45
    v_mfma_f32_4x4x4_16b_bf16 v[20:23], v[48:49], a[228:229], v[20:23] cbsz:2 abid:1
    v_lshrrev_b32 v52, 5, v0
    v_mfma_f32_4x4x4_16b_bf16 v[24:27], v[48:49], a[230:231], v[24:27] cbsz:2 abid:1
    v_lshl_add_u32 v52, s3, 1, v52
    v_mfma_f32_4x4x4_16b_bf16 v[12:15], v[48:49], a[232:233], v[12:15] cbsz:2 abid:2
    v_mul_u32_u24 v52, 528, v52
    v_mfma_f32_4x4x4_16b_bf16 v[16:19], v[48:49], a[234:235], v[16:19] cbsz:2 abid:2
    v_and_b32 v5, 15, v0
    v_mfma_f32_4x4x4_16b_bf16 v[20:23], v[48:49], a[236:237], v[20:23] cbsz:2 abid:3
    v_lshl_add_u32 v52, v5, 5, v52
    v_mfma_f32_4x4x4_16b_bf16 v[24:27], v[48:49], a[238:239], v[24:27] cbsz:2 abid:3
    v_and_b32 v5, 16, v0
    s_waitcnt vmcnt(0)
    v_mfma_f32_4x4x4_16b_bf16 v[12:15], v[50:51], a[240:241], v[12:15] cbsz:2 abid:0
    v_add3_u32 v52, v52, v5, s60
    v_mfma_f32_4x4x4_16b_bf16 v[16:19], v[50:51], a[242:243], v[16:19] cbsz:2 abid:0
    v_lshrrev_b32 v54, 3, v0
    v_mfma_f32_4x4x4_16b_bf16 v[20:23], v[50:51], a[244:245], v[20:23] cbsz:2 abid:1
    v_lshl_add_u32 v54, s3, 3, v54
    v_mfma_f32_4x4x4_16b_bf16 v[24:27], v[50:51], a[246:247], v[24:27] cbsz:2 abid:1
    v_lshlrev_b32 v54, 4, v54
    v_mfma_f32_4x4x4_16b_bf16 v[12:15], v[50:51], a[248:249], v[12:15] cbsz:2 abid:2
    v_and_b32 v5, 7, v0
    v_mfma_f32_4x4x4_16b_bf16 v[16:19], v[50:51], a[250:251], v[16:19] cbsz:2 abid:2
    v_mul_u32_u24 v55, 528, v5
    v_mfma_f32_4x4x4_16b_bf16 v[20:23], v[50:51], a[252:253], v[20:23] cbsz:2 abid:3
    v_add3_u32 v55, v55, v54, s60
    v_mfma_f32_4x4x4_16b_bf16 v[24:27], v[50:51], a[254:255], v[24:27] cbsz:2 abid:3
    v_and_b32 v5, 6, v0
    v_lshl_add_u32 v5, v5, 2, s61
    s_nop 1
    v_add_f32_dpp v11, v11, v11 row_ror:4 row_mask:0xf bank_mask:0xf
    s_nop 1
    v_add_f32_dpp v11, v11, v11 row_ror:8 row_mask:0xf bank_mask:0xf
    v_mov_b32 v28, v11
    s_nop 1
    v_permlane32_swap_b32 v11, v28
    v_add_f32 v11, v11, v28
    v_mov_b32 v28, v11
    s_nop 1
    v_permlane16_swap_b32 v11, v28
    v_add_f32 v11, v11, v28
    s_lshl_b32 s60, s3, 3
    s_add_u32 s60, s60, s61
    v_mov_b32 v28, s60
    v_add_f32 v12, v12, v20
    v_add_f32 v13, v13, v21
    v_add_f32 v14, v14, v22
    v_add_f32 v15, v15, v23
    v_add_f32 v16, v16, v24
    v_add_f32 v17, v17, v25
    v_add_f32 v18, v18, v26
    v_add_f32 v19, v19, v27
    v_permlane16_swap_b32 v12, v16
    v_permlane16_swap_b32 v13, v17
    v_permlane16_swap_b32 v14, v18
    v_permlane16_swap_b32 v15, v19
    v_add_f32 v12, v12, v16
    v_add_f32 v13, v13, v17
    v_add_f32 v14, v14, v18
    v_add_f32 v15, v15, v19
    ds_write_b128 v52, v[12:15]
    ds_write_b64 v28, v[10:11]
    s_mov_b32 vcc_lo, 0x1010101
    s_mov_b32 vcc_hi, 0x1010101
    v_bfrev_b32 v23, 1
    v_cndmask_b32 v54, v23, v54, vcc
    v_or_b32 v24, s3, v0
    v_cmp_eq_u32 vcc, 0, v24
    s_mul_i32 s64, s2, 640
    s_add_u32 s64, s64, 851968
    v_cndmask_b32 v23, v23, v24, vcc
    s_waitcnt lgkmcnt(0)
    s_barrier
    ds_read_b64 v[16:17], v5
    ds_read_b128 v[12:15], v55
    s_waitcnt lgkmcnt(1)
    v_max_f32_dpp v10, v16, v16 quad_perm:[2,3,0,1] row_mask:0xf bank_mask:0xf
    s_nop 1
    v_max_f32_dpp v10, v10, v10 row_half_mirror row_mask:0xf bank_mask:0xf
    v_sub_f32 v16, v16, v10
    v_exp_f32 v16, v16
    s_waitcnt lgkmcnt(0)
    v_mul_f32 v11, v17, v16
    v_mul_f32 v12, v12, v16
    v_mul_f32 v13, v13, v16
    v_mul_f32 v14, v14, v16
    v_mul_f32 v15, v15, v16
    v_add_f32_dpp v12, v12, v12 quad_perm:[1,0,3,2] row_mask:0xf bank_mask:0xf
    v_add_f32_dpp v13, v13, v13 quad_perm:[1,0,3,2] row_mask:0xf bank_mask:0xf
    v_add_f32_dpp v14, v14, v14 quad_perm:[1,0,3,2] row_mask:0xf bank_mask:0xf
    v_add_f32_dpp v15, v15, v15 quad_perm:[1,0,3,2] row_mask:0xf bank_mask:0xf
    v_add_f32_dpp v11, v11, v11 quad_perm:[2,3,0,1] row_mask:0xf bank_mask:0xf
    v_add_f32_dpp v12, v12, v12 quad_perm:[2,3,0,1] row_mask:0xf bank_mask:0xf
    v_add_f32_dpp v13, v13, v13 quad_perm:[2,3,0,1] row_mask:0xf bank_mask:0xf
    v_add_f32_dpp v14, v14, v14 quad_perm:[2,3,0,1] row_mask:0xf bank_mask:0xf
    v_add_f32_dpp v15, v15, v15 quad_perm:[2,3,0,1] row_mask:0xf bank_mask:0xf
    v_add_f32_dpp v11, v11, v11 row_half_mirror row_mask:0xf bank_mask:0xf
    v_add_f32_dpp v12, v12, v12 row_half_mirror row_mask:0xf bank_mask:0xf
    v_add_f32_dpp v13, v13, v13 row_half_mirror row_mask:0xf bank_mask:0xf
    v_add_f32_dpp v14, v14, v14 row_half_mirror row_mask:0xf bank_mask:0xf
    v_add_f32_dpp v15, v15, v15 row_half_mirror row_mask:0xf bank_mask:0xf
    s_cmp_eq_u32 s97, 0
    s_cbranch_scc1 Y6
    buffer_store_dwordx4 v[12:15], v54, s[48:51], s64 offen
    buffer_store_dwordx2 v[10:11], v23, s[48:51], s64 offen offset:512
Y6d:
    v_and_b32 v47, 31, v0
    v_lshl_add_u32 v47, s3, 5, v47
    v_lshrrev_b32 v44, 5, v0
    v_lshlrev_b32 v45, 7, v44
    v_add_lshl_u32 v45, v45, v47, 1
    v_add_u32 v45, 156928, v45
    v_lshlrev_b32 v44, 31, v44
    v_lshl_add_u32 v47, v47, 2, v44
    v_and_b32 v46, 7, v0
    v_mul_u32_u24 v46, 640, v46
    v_add_u32 v46, v46, v44
    s_mov_b32 vcc_lo, 0xff00ff
    s_mov_b32 vcc_hi, 0xff00ff
    v_bfrev_b32 v44, 1
    v_cndmask_b32 v46, v44, v46, vcc
    s_mul_i32 s60, s4, 5120
    s_add_u32 s60, s60, 851968
    s_add_u32 s61, s60, 2560
    s_waitcnt vmcnt(0)
    buffer_load_dwordx2 v[18:19], v46, s[48:51], s60 offen offset:512 sc1
    buffer_load_dword v10, v47, s[48:51], s60 offen offset:0 sc1
    buffer_load_dword v11, v47, s[48:51], s60 offen offset:640 sc1
    buffer_load_dword v12, v47, s[48:51], s60 offen offset:1280 sc1
    buffer_load_dword v13, v47, s[48:51], s60 offen offset:1920 sc1
    buffer_load_dword v14, v47, s[48:51], s61 offen offset:0 sc1
    buffer_load_dword v15, v47, s[48:51], s61 offen offset:640 sc1
    buffer_load_dword v16, v47, s[48:51], s61 offen offset:1280 sc1
    buffer_load_dword v17, v47, s[48:51], s61 offen offset:1920 sc1
    v_and_b32 v50, 1, v0
    v_lshlrev_b32 v54, 31, v50
    v_and_b32 v50, 2, v0
    v_lshl_add_u32 v54, v50, 5, v54
    v_and_b32 v50, 48, v0
    v_add_u32 v54, v54, v50
    s_mov_b32 vcc_lo, 0xf000f
    s_mov_b32 vcc_hi, 0xf000f
    v_bfrev_b32 v50, 1
    v_cndmask_b32 v54, v50, v54, vcc
    s_lshl_b32 s64, s5, 5
    s_add_u32 s64, s64, s4
    s_lshl_b32 s64, s64, 2
    s_add_u32 s64, s64, s3
    s_lshl_b32 s64, s64, 7
    s_add_u32 s64, s64, 1507328
    v_lshrrev_b32 v55, 2, v0
    v_mul_u32_u24 v55, 144, v55
    v_and_b32 v50, 24, v1
    v_add_u32 v55, v55, v50
    v_add_u32 v55, 117248, v55
    v_and_b32 v5, 1, v0
    v_mul_u32_u24 v5, 256, v5
    v_lshrrev_b32 v50, 4, v0
    v_lshl_add_u32 v5, v50, 3, v5
    v_add_u32 v5, 156928, v5
    s_waitcnt vmcnt(0)
    v_max_u32 v44, v10, v11
    v_max3_u32 v44, v44, v12, v13
    v_max3_u32 v44, v44, v14, v15
    v_max3_u32 v44, v44, v16, v17
    v_max3_u32 v44, v44, v18, v19
    v_cmp_eq_u32 vcc, -1, v44
    s_cbranch_vccz P7d
P7:
    buffer_load_dwordx2 v[18:19], v46, s[48:51], s60 offen offset:512 sc1
    buffer_load_dword v10, v47, s[48:51], s60 offen offset:0 sc1
    buffer_load_dword v11, v47, s[48:51], s60 offen offset:640 sc1
    buffer_load_dword v12, v47, s[48:51], s60 offen offset:1280 sc1
    buffer_load_dword v13, v47, s[48:51], s60 offen offset:1920 sc1
    buffer_load_dword v14, v47, s[48:51], s61 offen offset:0 sc1
    buffer_load_dword v15, v47, s[48:51], s61 offen offset:640 sc1
    buffer_load_dword v16, v47, s[48:51], s61 offen offset:1280 sc1
    buffer_load_dword v17, v47, s[48:51], s61 offen offset:1920 sc1
    s_waitcnt vmcnt(0)
    s_sub_u32 s6, s6, 1
    s_cselect_b32 s6, 0, s6
    s_cbranch_scc1 P7x
    v_max_u32 v44, v10, v11
    v_max3_u32 v44, v44, v12, v13
    v_max3_u32 v44, v44, v14, v15
    v_max3_u32 v44, v44, v16, v17
    v_max3_u32 v44, v44, v18, v19
    v_cmp_eq_u32 vcc, -1, v44
    s_cbranch_vccnz P7
P7x:
P7d:
    v_max_f32_dpp v20, v18, v18 quad_perm:[1,0,3,2] row_mask:0xf bank_mask:0xf
    s_nop 1
    v_max_f32_dpp v20, v20, v20 quad_perm:[2,3,0,1] row_mask:0xf bank_mask:0xf
    s_nop 1
    v_max_f32_dpp v20, v20, v20 row_half_mirror row_mask:0xf bank_mask:0xf
    v_sub_f32 v18, v18, v20
    v_exp_f32 v18, v18
    s_nop 0
    v_mul_f32 v19, v19, v18
    s_nop 0
    v_mul_f32_dpp v44, v18, v10 row_newbcast:0 row_mask:0xf bank_mask:0xf
    v_add_f32_dpp v19, v19, v19 quad_perm:[1,0,3,2] row_mask:0xf bank_mask:0xf
    v_fmac_f32_dpp v44, v18, v11 row_newbcast:1 row_mask:0xf bank_mask:0xf
    v_fmac_f32_dpp v44, v18, v12 row_newbcast:2 row_mask:0xf bank_mask:0xf
    v_add_f32_dpp v19, v19, v19 quad_perm:[2,3,0,1] row_mask:0xf bank_mask:0xf
    v_fmac_f32_dpp v44, v18, v13 row_newbcast:3 row_mask:0xf bank_mask:0xf
    v_fmac_f32_dpp v44, v18, v14 row_newbcast:4 row_mask:0xf bank_mask:0xf
    v_add_f32_dpp v19, v19, v19 row_half_mirror row_mask:0xf bank_mask:0xf
    v_fmac_f32_dpp v44, v18, v15 row_newbcast:5 row_mask:0xf bank_mask:0xf
    v_fmac_f32_dpp v44, v18, v16 row_newbcast:6 row_mask:0xf bank_mask:0xf
    v_rcp_f32 v19, v19
    v_fmac_f32_dpp v44, v18, v17 row_newbcast:7 row_mask:0xf bank_mask:0xf
    s_nop 0
    v_mul_f32_dpp v44, v19, v44 row_newbcast:0 row_mask:0xf bank_mask:0xf
    v_cvt_pk_bf16_f32 v44, v44, v44
    ds_write_b16 v45, v44
    v_lshl_add_u32 v47, s3, 5, v55
    ds_read_b64_tr_b16 v[28:29], v47 offset:0
    ds_read_b64_tr_b16 v[30:31], v47 offset:2304
    ds_read_b64_tr_b16 v[32:33], v47 offset:4608
    ds_read_b64_tr_b16 v[34:35], v47 offset:6912
    ds_read_b64_tr_b16 v[36:37], v47 offset:9216
    ds_read_b64_tr_b16 v[38:39], v47 offset:11520
    ds_read_b64_tr_b16 v[40:41], v47 offset:13824
    ds_read_b64_tr_b16 v[42:43], v47 offset:16128
    s_waitcnt lgkmcnt(8)
    s_barrier
    ds_read2_b64 v[10:13], v5 offset0:0 offset1:4
    ds_read2_b64 v[14:17], v5 offset0:8 offset1:12
    ds_read2_b64 v[18:21], v5 offset0:16 offset1:20
    ds_read2_b64 v[22:25], v5 offset0:24 offset1:28
    s_waitcnt lgkmcnt(0)
    v_mfma_f32_16x16x32_bf16 v[46:49], v[28:31], v[10:13], 0
    ds_read_b64_tr_b16 v[28:29], v55 offset:128
    ds_read_b64_tr_b16 v[30:31], v55 offset:2432
    v_mfma_f32_16x16x32_bf16 v[46:49], v[32:35], v[14:17], v[46:49]
    ds_read_b64_tr_b16 v[32:33], v55 offset:4736
    ds_read_b64_tr_b16 v[34:35], v55 offset:7040
    v_mfma_f32_16x16x32_bf16 v[46:49], v[36:39], v[18:21], v[46:49]
    ds_read_b64_tr_b16 v[36:37], v55 offset:9344
    ds_read_b64_tr_b16 v[38:39], v55 offset:11648
    v_mfma_f32_16x16x32_bf16 v[46:49], v[40:43], v[22:25], v[46:49]
    ds_read_b64_tr_b16 v[40:41], v55 offset:13952
    ds_read_b64_tr_b16 v[42:43], v55 offset:16256
    s_waitcnt lgkmcnt(0)
    v_mfma_f32_16x16x32_bf16 v[50:53], v[28:31], v[10:13], 0
    v_mfma_f32_16x16x32_bf16 v[50:53], v[32:35], v[14:17], v[50:53]
    v_mfma_f32_16x16x32_bf16 v[50:53], v[36:39], v[18:21], v[50:53]
    v_mfma_f32_16x16x32_bf16 v[50:53], v[40:43], v[22:25], v[50:53]
    s_nop 5
    s_mov_b32 vcc_lo, 0xc000c
    s_mov_b32 vcc_hi, 0xc000c
    v_cndmask_b32 v46, v46, v50, vcc
    v_cndmask_b32 v47, v47, v51, vcc
    v_cndmask_b32 v48, v48, v52, vcc
    v_cndmask_b32 v49, v49, v53, vcc
    buffer_store_dwordx4 v[46:49], v54, s[48:51], s64 offen sc1
    v_and_b32 v47, 15, v0
    v_bfe_u32 v44, v0, 3, 1
    v_mad_u32_u24 v46, v44, s3, v47
    v_lshlrev_b32 v46, 3, v46
    v_lshl_add_u32 v47, s3, 3, v47
    s_mul_i32 s7, s3, 7
    s_sub_u32 s7, 24, s7
    v_mad_u32_u24 v47, v44, s7, v47
    v_lshrrev_b32 v45, 5, v0
    v_lshlrev_b32 v45, 1, v45
    v_lshl_add_u32 v45, v47, 2, v45
    v_lshrrev_b32 v44, 4, v0
    v_lshl_add_u32 v46, v44, 12, v46
    s_mov_b32 vcc_lo, 0x1ff01ff
    s_mov_b32 vcc_hi, 0x1ff01ff
    v_bfrev_b32 v44, 1
    v_cndmask_b32 v46, v44, v46, vcc
    s_lshl_b32 s60, s5, 7
    s_add_u32 s60, s60, s3
    s_lshl_b32 s60, s60, 7
    s_add_u32 s60, s60, 1507328
    v_add_u32 v45, 156416, v45
    s_waitcnt vmcnt(0)
    buffer_load_dwordx2 v[10:11], v46, s[48:51], s60 offen offset:0 sc1
    buffer_load_dwordx2 v[12:13], v46, s[48:51], s60 offen offset:512 sc1
    buffer_load_dwordx2 v[14:15], v46, s[48:51], s60 offen offset:1024 sc1
    buffer_load_dwordx2 v[16:17], v46, s[48:51], s60 offen offset:1536 sc1
    buffer_load_dwordx2 v[18:19], v46, s[48:51], s60 offen offset:2048 sc1
    buffer_load_dwordx2 v[20:21], v46, s[48:51], s60 offen offset:2560 sc1
    buffer_load_dwordx2 v[22:23], v46, s[48:51], s60 offen offset:3072 sc1
    buffer_load_dwordx2 v[24:25], v46, s[48:51], s60 offen offset:3584 sc1
    v_and_b32 v48, 15, v0
    v_lshlrev_b32 v55, 1, v48
    s_mov_b32 s98, 0xa8888888
    v_lshrrev_b32_e64 v55, v55, s98
    v_and_b32 v55, 3, v55
    v_mul_u32_u24 v55, 160, v55
    v_lshrrev_b32 v49, 4, v0
    v_lshl_add_u32 v55, v49, 3, v55
    v_add_u32 v55, 156416, v55
    v_lshrrev_b32 v50, 1, v48
    v_and_b32 v52, 14, v48
    v_sub_u32 v48, v48, v52
    v_mul_u32_u24 v52, 393216, v48
    v_lshl_add_u32 v52, v49, 4, v52
    v_lshl_add_u32 v52, v50, 6, v52
    s_mov_b32 s98, 6
    v_cmp_gt_u32 vcc, s98, v50
    v_or_b32 v48, 0x80000000, v52
    s_nop 0
    v_cndmask_b32 v52, v48, v52, vcc
    s_mul_i32 s64, s2, 1536
    s_mul_i32 s98, s3, 384
    s_add_u32 s64, s64, s98
    s_add_u32 s64, s64, 2555904
    v_lshrrev_b32 v54, 2, v0
    v_mul_u32_u24 v54, 288, v54
    v_and_b32 v48, 24, v1
    v_add_u32 v54, v54, v48
    s_lshr_b32 s98, s3, 1
    s_mul_i32 s98, s98, 20736
    s_and_b32 s99, s3, 1
    s_lshl_b32 s99, s99, 7
    s_add_u32 s98, s98, s99
    s_add_u32 s98, s98, 75776
    v_add_u32 v54, s98, v54
    v_lshl_add_u32 v26, s3, 6, v0
    v_bfrev_b32 v47, 1
    v_cmp_gt_u32 vcc, 5, v26
    v_lshlrev_b32 v27, 7, v26
    s_mul_i32 s98, s2, 640
    v_cndmask_b32 v27, v47, v27, vcc
    s_add_u32 s98, s98, 524288
    buffer_load_dword v53, v27, s[48:51], s98 offen sc1
    v_cmp_gt_u32 vcc, 12, v26
    v_lshlrev_b32 v27, 7, v26
    s_mul_i32 s98, s2, 1536
    v_cndmask_b32 v27, v47, v27, vcc
    s_add_u32 s98, s98, 2555904
    buffer_load_dword v53, v27, s[48:51], s98 offen sc1
    v_cmp_gt_u32 vcc, 12, v26
    v_lshlrev_b32 v27, 7, v26
    s_mul_i32 s98, s2, 1536
    v_cndmask_b32 v27, v47, v27, vcc
    s_add_u32 s98, s98, 2949120
    buffer_load_dword v53, v27, s[48:51], s98 offen sc1
    s_waitcnt vmcnt(3)
    v_max_u32 v44, v10, v11
    v_max3_u32 v44, v44, v12, v13
    v_max3_u32 v44, v44, v14, v15
    v_max3_u32 v44, v44, v16, v17
    v_max3_u32 v44, v44, v18, v19
    v_max3_u32 v44, v44, v20, v21
    v_max3_u32 v44, v44, v22, v23
    v_max3_u32 v44, v44, v24, v25
    v_cmp_eq_u32 vcc, -1, v44
    s_cbranch_vccz P8d
P8:
    buffer_load_dwordx2 v[10:11], v46, s[48:51], s60 offen offset:0 sc1
    buffer_load_dwordx2 v[12:13], v46, s[48:51], s60 offen offset:512 sc1
    buffer_load_dwordx2 v[14:15], v46, s[48:51], s60 offen offset:1024 sc1
    buffer_load_dwordx2 v[16:17], v46, s[48:51], s60 offen offset:1536 sc1
    buffer_load_dwordx2 v[18:19], v46, s[48:51], s60 offen offset:2048 sc1
    buffer_load_dwordx2 v[20:21], v46, s[48:51], s60 offen offset:2560 sc1
    buffer_load_dwordx2 v[22:23], v46, s[48:51], s60 offen offset:3072 sc1
    buffer_load_dwordx2 v[24:25], v46, s[48:51], s60 offen offset:3584 sc1
    s_waitcnt vmcnt(0)
    s_sub_u32 s6, s6, 1
    s_cselect_b32 s6, 0, s6
    s_cbranch_scc1 P8x
    v_max_u32 v44, v10, v11
    v_max3_u32 v44, v44, v12, v13
    v_max3_u32 v44, v44, v14, v15
    v_max3_u32 v44, v44, v16, v17
    v_max3_u32 v44, v44, v18, v19
    v_max3_u32 v44, v44, v20, v21
    v_max3_u32 v44, v44, v22, v23
    v_max3_u32 v44, v44, v24, v25
    v_cmp_eq_u32 vcc, -1, v44
    s_cbranch_vccnz P8
P8x:
P8d:
    v_add_f32 v10, v10, v12
    v_add_f32 v11, v11, v13
    v_add_f32 v14, v14, v16
    v_add_f32 v15, v15, v17
    v_add_f32 v18, v18, v20
    v_add_f32 v19, v19, v21
    v_add_f32 v22, v22, v24
    v_add_f32 v23, v23, v25
    v_add_f32 v10, v10, v14
    v_add_f32 v11, v11, v15
    v_add_f32 v18, v18, v22
    v_add_f32 v19, v19, v23
    v_add_f32 v10, v10, v18
    v_add_f32 v11, v11, v19
    v_and_b32 v47, 0xffff0000, v4
    s_nop 0
    v_permlane32_swap_b32 v10, v11
    v_add_f32 v26, v10, v11
    v_add_f32 v27, v10, v11
    s_nop 1
    v_permlane16_swap_b32 v26, v27
    s_mov_b32 exec_lo, 0x1ff
    s_mov_b32 exec_hi, 0x1ff
    v_add_f32 v26, v26, v27
    v_add_f32 v26, v26, v47
    v_cvt_pk_bf16_f32 v4, v26, v26
    ds_write_b16 v45, v4
    s_mov_b64 exec, -1
    ds_read_b64_tr_b16 v[20:21], v54 offset:0
    ds_read_b64_tr_b16 v[22:23], v54 offset:4608
    ds_read_b64_tr_b16 v[24:25], v54 offset:9216
    ds_read_b64_tr_b16 v[26:27], v54 offset:13824
    ds_read_b64_tr_b16 v[28:29], v54 offset:18432
    ds_read_b64_tr_b16 v[30:31], v54 offset:32
    ds_read_b64_tr_b16 v[32:33], v54 offset:4640
    ds_read_b64_tr_b16 v[34:35], v54 offset:9248
    ds_read_b64_tr_b16 v[36:37], v54 offset:13856
    ds_read_b64_tr_b16 v[38:39], v54 offset:18464
    s_waitcnt lgkmcnt(10)
    s_barrier
    ds_read2_b64 v[10:13], v55 offset0:0 offset1:4
    ds_read2_b64 v[14:17], v55 offset0:8 offset1:12
    ds_read_b64 v[18:19], v55 offset:128
    s_waitcnt lgkmcnt(0)
    v_mfma_f32_16x16x32_bf16 v[40:43], v[10:13], v[10:13], 0
    v_mfma_f32_16x16x32_bf16 v[44:47], v[20:23], v[10:13], 0
    v_mfma_f32_16x16x32_bf16 v[48:51], v[30:33], v[10:13], 0
    v_mfma_f32_16x16x32_bf16 v[40:43], v[14:17], v[14:17], v[40:43]
    v_mfma_f32_16x16x32_bf16 v[44:47], v[24:27], v[14:17], v[44:47]
    v_mfma_f32_16x16x32_bf16 v[48:51], v[34:37], v[14:17], v[48:51]
    s_nop 4
    v_mfma_f32_16x16x16_bf16 v[40:43], v[18:19], v[18:19], v[40:43]
    v_mfma_f32_16x16x16_bf16 v[44:47], v[28:29], v[18:19], v[44:47]
    v_mfma_f32_16x16x16_bf16 v[48:51], v[38:39], v[18:19], v[48:51]
    ds_read_b64_tr_b16 v[20:21], v54 offset:64
    ds_read_b64_tr_b16 v[22:23], v54 offset:4672
    ds_read_b64_tr_b16 v[24:25], v54 offset:9280
    ds_read_b64_tr_b16 v[26:27], v54 offset:13888
    ds_read_b64_tr_b16 v[28:29], v54 offset:18496
    ds_read_b64_tr_b16 v[30:31], v54 offset:96
    ds_read_b64_tr_b16 v[32:33], v54 offset:4704
    ds_read_b64_tr_b16 v[34:35], v54 offset:9312
    ds_read_b64_tr_b16 v[36:37], v54 offset:13920
    ds_read_b64_tr_b16 v[38:39], v54 offset:18528
    s_mov_b32 vcc_lo, 0x30003
    s_mov_b32 vcc_hi, 0x30003
    v_cndmask_b32 v40, v40, v44, vcc
    v_cndmask_b32 v41, v41, v45, vcc
    v_cndmask_b32 v42, v42, v46, vcc
    v_cndmask_b32 v43, v43, v47, vcc
    s_mov_b32 vcc_lo, 0xc000c
    s_mov_b32 vcc_hi, 0xc000c
    v_cndmask_b32 v40, v40, v48, vcc
    v_cndmask_b32 v41, v41, v49, vcc
    v_cndmask_b32 v42, v42, v50, vcc
    v_cndmask_b32 v43, v43, v51, vcc
    s_waitcnt lgkmcnt(0)
    v_mfma_f32_16x16x32_bf16 v[44:47], v[20:23], v[10:13], 0
    v_mfma_f32_16x16x32_bf16 v[48:51], v[30:33], v[10:13], 0
    v_mfma_f32_16x16x32_bf16 v[44:47], v[24:27], v[14:17], v[44:47]
    v_mfma_f32_16x16x32_bf16 v[48:51], v[34:37], v[14:17], v[48:51]
    s_nop 5
    v_mfma_f32_16x16x16_bf16 v[44:47], v[28:29], v[18:19], v[44:47]
    v_mfma_f32_16x16x16_bf16 v[48:51], v[38:39], v[18:19], v[48:51]
    ds_read_b64_tr_b16 v[20:21], v54 offset:128
    ds_read_b64_tr_b16 v[22:23], v54 offset:4736
    ds_read_b64_tr_b16 v[24:25], v54 offset:9344
    ds_read_b64_tr_b16 v[26:27], v54 offset:13952
    ds_read_b64_tr_b16 v[28:29], v54 offset:18560
    s_nop 0
    s_mov_b32 vcc_lo, 0x300030
    s_mov_b32 vcc_hi, 0x300030
    v_cndmask_b32 v40, v40, v44, vcc
    v_cndmask_b32 v41, v41, v45, vcc
    v_cndmask_b32 v42, v42, v46, vcc
    v_cndmask_b32 v43, v43, v47, vcc
    s_mov_b32 vcc_lo, 0xc000c0
    s_mov_b32 vcc_hi, 0xc000c0
    v_cndmask_b32 v40, v40, v48, vcc
    v_cndmask_b32 v41, v41, v49, vcc
    v_cndmask_b32 v42, v42, v50, vcc
    v_cndmask_b32 v43, v43, v51, vcc
    s_waitcnt lgkmcnt(0)
    v_mfma_f32_16x16x32_bf16 v[44:47], v[20:23], v[10:13], 0
    v_mfma_f32_16x16x32_bf16 v[44:47], v[24:27], v[14:17], v[44:47]
    s_nop 6
    v_mfma_f32_16x16x16_bf16 v[44:47], v[28:29], v[18:19], v[44:47]
    s_nop 5
    s_mov_b32 vcc_lo, 0x3000300
    s_mov_b32 vcc_hi, 0x3000300
    v_cndmask_b32 v40, v40, v44, vcc
    v_cndmask_b32 v41, v41, v45, vcc
    v_cndmask_b32 v42, v42, v46, vcc
    v_cndmask_b32 v43, v43, v47, vcc
    s_cmp_eq_u32 s97, 0
    s_cbranch_scc1 Y9
    buffer_store_dwordx4 v[40:43], v52, s[48:51], s64 offen
Y9d:
    s_waitcnt vmcnt(1)
    v_and_b32 v51, 15, v0
    s_mul_i32 s7, s3, 9
    v_add_u32 v51, s7, v51
    v_cmp_lt_u32 vcc, 19, v51
    v_lshrrev_b32 v53, 4, v0
    v_mul_u32_u24 v52, 768, v53
    v_lshl_add_u32 v52, v51, 4, v52
    v_add_u32 v50, 128, v52
    v_cndmask_b32 v52, v52, v50, vcc
    s_mov_b32 vcc_lo, 0x1ff01ff
    s_mov_b32 vcc_hi, 0x1ff01ff
    v_bfrev_b32 v50, 1
    v_cndmask_b32 v52, v50, v52, vcc
    v_bfrev_b32 v53, v53
    v_lshrrev_b32 v53, 29, v53
    v_lshl_add_u32 v51, v51, 3, v53
    v_add_u32 v51, 157440, v51
    v_mul_u32_u24 v53, 1536, v0
    v_cmp_gt_u32 vcc, 8, v0
    v_or_b32 v50, 0x80000000, v53
    s_nop 0
    v_cndmask_b32 v53, v50, v53, vcc
    s_mul_i32 s7, s4, 12288
    s_add_u32 s60, s7, 2555904
    s_add_u32 s61, s7, 2562048
    s_add_u32 s65, s7, 2949120
    s_add_u32 s66, s7, 2955264
    s_waitcnt vmcnt(0)
    buffer_load_dwordx4 v[46:49], v53, s[48:51], s60 offen offset:368 sc1
    buffer_load_dwordx4 v[10:13], v52, s[48:51], s60 offen offset:0 sc1
    buffer_load_dwordx4 v[14:17], v52, s[48:51], s60 offen offset:3072 sc1
    buffer_load_dwordx4 v[18:21], v52, s[48:51], s61 offen offset:0 sc1
    buffer_load_dwordx4 v[22:25], v52, s[48:51], s61 offen offset:3072 sc1
    buffer_load_dwordx4 v[30:33], v52, s[48:51], s65 offen offset:0 sc1
    buffer_load_dwordx4 v[34:37], v52, s[48:51], s65 offen offset:3072 sc1
    buffer_load_dwordx4 v[38:41], v52, s[48:51], s66 offen offset:0 sc1
    buffer_load_dwordx4 v[42:45], v52, s[48:51], s66 offen offset:3072 sc1
    v_and_b32 v50, 1, v0
    v_lshlrev_b32 v54, 31, v50
    v_and_b32 v50, 2, v0
    v_lshl_add_u32 v54, v50, 5, v54
    v_and_b32 v50, 48, v0
    v_add_u32 v54, v54, v50
    s_mov_b32 vcc_lo, 0xf000f
    s_mov_b32 vcc_hi, 0xf000f
    v_bfrev_b32 v50, 1
    v_cndmask_b32 v54, v50, v54, vcc
    s_lshl_b32 s64, s5, 5
    s_add_u32 s64, s64, s4
    s_lshl_b32 s64, s64, 2
    s_add_u32 s64, s64, s3
    s_lshl_b32 s64, s64, 7
    s_add_u32 s64, s64, 2031616
    v_lshrrev_b32 v55, 2, v0
    v_mul_u32_u24 v55, 144, v55
    v_and_b32 v50, 24, v1
    v_add_u32 v55, v55, v50
    v_add_u32 v55, 135680, v55
    v_and_b32 v5, 1, v0
    v_mul_u32_u24 v5, 288, v5
    v_lshrrev_b32 v50, 4, v0
    v_lshl_add_u32 v5, v50, 3, v5
    v_add_u32 v5, 157440, v5
    s_waitcnt vmcnt(0)
    v_max_u32 v50, v46, v48
    v_max3_u32 v50, v50, v10, v11
    v_max3_u32 v50, v50, v12, v13
    v_max3_u32 v50, v50, v14, v15
    v_max3_u32 v50, v50, v16, v17
    v_max3_u32 v50, v50, v18, v19
    v_max3_u32 v50, v50, v20, v21
    v_max3_u32 v50, v50, v22, v23
    v_max3_u32 v50, v50, v24, v25
    v_max3_u32 v50, v50, v30, v31
    v_max3_u32 v50, v50, v32, v33
    v_max3_u32 v50, v50, v34, v35
    v_max3_u32 v50, v50, v36, v37
    v_max3_u32 v50, v50, v38, v39
    v_max3_u32 v50, v50, v40, v41
    v_max3_u32 v50, v50, v42, v43
    v_max3_u32 v50, v50, v44, v45
    v_cmp_eq_u32 vcc, -1, v50
    s_cbranch_vccz P10d
P10:
    buffer_load_dwordx4 v[46:49], v53, s[48:51], s60 offen offset:368 sc1
    buffer_load_dwordx4 v[10:13], v52, s[48:51], s60 offen offset:0 sc1
    buffer_load_dwordx4 v[14:17], v52, s[48:51], s60 offen offset:3072 sc1
    buffer_load_dwordx4 v[18:21], v52, s[48:51], s61 offen offset:0 sc1
    buffer_load_dwordx4 v[22:25], v52, s[48:51], s61 offen offset:3072 sc1
    buffer_load_dwordx4 v[30:33], v52, s[48:51], s65 offen offset:0 sc1
    buffer_load_dwordx4 v[34:37], v52, s[48:51], s65 offen offset:3072 sc1
    buffer_load_dwordx4 v[38:41], v52, s[48:51], s66 offen offset:0 sc1
    buffer_load_dwordx4 v[42:45], v52, s[48:51], s66 offen offset:3072 sc1
    s_waitcnt vmcnt(0)
    s_sub_u32 s6, s6, 1
    s_cselect_b32 s6, 0, s6
    s_cbranch_scc1 P10x
    v_max_u32 v50, v46, v48
    v_max3_u32 v50, v50, v10, v11
    v_max3_u32 v50, v50, v12, v13
    v_max3_u32 v50, v50, v14, v15
    v_max3_u32 v50, v50, v16, v17
    v_max3_u32 v50, v50, v18, v19
    v_max3_u32 v50, v50, v20, v21
    v_max3_u32 v50, v50, v22, v23
    v_max3_u32 v50, v50, v24, v25
    v_max3_u32 v50, v50, v30, v31
    v_max3_u32 v50, v50, v32, v33
    v_max3_u32 v50, v50, v34, v35
    v_max3_u32 v50, v50, v36, v37
    v_max3_u32 v50, v50, v38, v39
    v_max3_u32 v50, v50, v40, v41
    v_max3_u32 v50, v50, v42, v43
    v_max3_u32 v50, v50, v44, v45
    v_cmp_eq_u32 vcc, -1, v50
    s_cbranch_vccnz P10
P10x:
P10d:
    v_add_f32 v10, v10, v14
    v_add_f32 v11, v11, v15
    v_add_f32_dpp v46, v46, v46 quad_perm:[1,0,3,2] row_mask:0xf bank_mask:0xf
    v_add_f32 v12, v12, v16
    v_add_f32_dpp v48, v48, v48 quad_perm:[1,0,3,2] row_mask:0xf bank_mask:0xf
    v_add_f32 v13, v13, v17
    v_add_f32_dpp v46, v46, v46 quad_perm:[2,3,0,1] row_mask:0xf bank_mask:0xf
    v_add_f32 v18, v18, v22
    v_add_f32_dpp v48, v48, v48 quad_perm:[2,3,0,1] row_mask:0xf bank_mask:0xf
    v_add_f32 v19, v19, v23
    v_add_f32_dpp v46, v46, v46 row_half_mirror row_mask:0xf bank_mask:0xf
    v_add_f32 v20, v20, v24
    v_add_f32_dpp v48, v48, v48 row_half_mirror row_mask:0xf bank_mask:0xf
    v_add_f32 v21, v21, v25
    v_mul_f32 v48, 0x3ae38e39, v48
    v_add_f32 v10, v10, v18
    v_mul_f32 v46, 0x3ae38e39, v46
    v_add_f32 v11, v11, v19
    v_fma_f32 v46, -v48, v48, v46
    v_add_f32 v12, v12, v20
    v_max_f32 v46, 0, v46
    v_add_f32 v13, v13, v21
    v_add_f32 v46, 0x3727c5ac, v46
    v_add_f32 v30, v30, v34
    v_rsq_f32 v46, v46
    v_add_f32 v31, v31, v35
    v_readfirstlane_b32 s0, v48
    v_add_f32 v32, v32, v36
    v_readfirstlane_b32 s1, v46
    v_add_f32 v33, v33, v37
    v_add_f32 v38, v38, v42
    v_add_f32 v39, v39, v43
    v_add_f32 v40, v40, v44
    v_add_f32 v41, v41, v45
    v_add_f32 v30, v30, v38
    v_add_f32 v31, v31, v39
    v_add_f32 v32, v32, v40
    v_add_f32 v33, v33, v41
    s_nop 0
    v_permlane32_swap_b32 v10, v11
    v_permlane32_swap_b32 v12, v13
    v_permlane32_swap_b32 v30, v31
    v_permlane32_swap_b32 v32, v33
    v_add_f32 v10, v10, v11
    v_add_f32 v11, v12, v13
    v_add_f32 v30, v30, v31
    v_add_f32 v31, v32, v33
    s_nop 1
    v_permlane16_swap_b32 v10, v11
    v_permlane16_swap_b32 v30, v31
    v_mov_b32 v6, v30
    v_mov_b32 v7, v31
    v_fma_f32 v10, -s0, v6, v10
    v_mul_f32 v10, s1, v10
    v_fma_f32 v11, -s0, v7, v11
    v_mul_f32 v11, s1, v11
    v_mul_f32 v12, v10, v10
    v_mov_b32 v13, 0xc0135761
    v_fmac_f32 v13, 0xbdd2d3e8, v12
    v_mul_f32 v13, v13, v10
    v_exp_f32 v13, v13
    v_mul_f32 v10, v10, v11
    v_add_f32 v13, 1.0, v13
    v_rcp_f32 v13, v13
    s_nop 0
    v_mul_f32 v50, v10, v13
    v_cvt_pk_bf16_f32 v50, v50, v50
    s_mov_b32 exec_lo, 0x1ff01ff
    s_mov_b32 exec_hi, 0x1ff01ff
    ds_write_b16 v51, v50
    s_mov_b64 exec, -1
    v_lshl_add_u32 v47, s3, 5, v55
    ds_read_b64_tr_b16 v[28:29], v47 offset:0
    ds_read_b64_tr_b16 v[30:31], v47 offset:2304
    ds_read_b64_tr_b16 v[32:33], v47 offset:4608
    ds_read_b64_tr_b16 v[34:35], v47 offset:6912
    ds_read_b64_tr_b16 v[36:37], v47 offset:9216
    ds_read_b64_tr_b16 v[38:39], v47 offset:11520
    ds_read_b64_tr_b16 v[40:41], v47 offset:13824
    ds_read_b64_tr_b16 v[42:43], v47 offset:16128
    ds_read_b64_tr_b16 v[44:45], v47 offset:18432
    s_waitcnt lgkmcnt(9)
    s_barrier
    ds_read2_b64 v[10:13], v5 offset0:0 offset1:4
    ds_read2_b64 v[14:17], v5 offset0:8 offset1:12
    ds_read2_b64 v[18:21], v5 offset0:16 offset1:20
    ds_read2_b64 v[22:25], v5 offset0:24 offset1:28
    ds_read_b64 v[26:27], v5 offset:256
    s_waitcnt lgkmcnt(0)
    v_mfma_f32_16x16x32_bf16 v[46:49], v[28:31], v[10:13], 0
    ds_read_b64_tr_b16 v[28:29], v55 offset:128
    ds_read_b64_tr_b16 v[30:31], v55 offset:2432
    v_mfma_f32_16x16x32_bf16 v[46:49], v[32:35], v[14:17], v[46:49]
    ds_read_b64_tr_b16 v[32:33], v55 offset:4736
    ds_read_b64_tr_b16 v[34:35], v55 offset:7040
    v_mfma_f32_16x16x32_bf16 v[46:49], v[36:39], v[18:21], v[46:49]
    ds_read_b64_tr_b16 v[36:37], v55 offset:9344
    ds_read_b64_tr_b16 v[38:39], v55 offset:11648
    v_mfma_f32_16x16x32_bf16 v[46:49], v[40:43], v[22:25], v[46:49]
    ds_read_b64_tr_b16 v[40:41], v55 offset:13952
    ds_read_b64_tr_b16 v[42:43], v55 offset:16256
    s_nop 6
    v_mfma_f32_16x16x16_bf16 v[46:49], v[44:45], v[26:27], v[46:49]
    ds_read_b64_tr_b16 v[44:45], v55 offset:18560
    s_waitcnt lgkmcnt(0)
    v_mfma_f32_16x16x32_bf16 v[50:53], v[28:31], v[10:13], 0
    v_mfma_f32_16x16x32_bf16 v[50:53], v[32:35], v[14:17], v[50:53]
    v_mfma_f32_16x16x32_bf16 v[50:53], v[36:39], v[18:21], v[50:53]
    v_mfma_f32_16x16x32_bf16 v[50:53], v[40:43], v[22:25], v[50:53]
    s_nop 6
    v_mfma_f32_16x16x16_bf16 v[50:53], v[44:45], v[26:27], v[50:53]
    s_nop 5
    s_mov_b32 vcc_lo, 0xc000c
    s_mov_b32 vcc_hi, 0xc000c
    v_cndmask_b32 v46, v46, v50, vcc
    v_cndmask_b32 v47, v47, v51, vcc
    v_cndmask_b32 v48, v48, v52, vcc
    v_cndmask_b32 v49, v49, v53, vcc
    buffer_store_dwordx4 v[46:49], v54, s[48:51], s64 offen sc1
    v_and_b32 v47, 15, v0
    v_bfe_u32 v44, v0, 3, 1
    v_mad_u32_u24 v46, v44, s3, v47
    v_lshlrev_b32 v46, 3, v46
    v_lshl_add_u32 v47, s3, 3, v47
    s_mul_i32 s7, s3, 7
    s_sub_u32 s7, 24, s7
    v_mad_u32_u24 v47, v44, s7, v47
    v_lshrrev_b32 v45, 5, v0
    v_lshlrev_b32 v45, 1, v45
    v_lshl_add_u32 v45, v47, 2, v45
    v_lshrrev_b32 v44, 4, v0
    v_lshl_add_u32 v46, v44, 12, v46
    s_mov_b32 vcc_lo, 0x1ff01ff
    s_mov_b32 vcc_hi, 0x1ff01ff
    v_bfrev_b32 v44, 1
    v_cndmask_b32 v46, v44, v46, vcc
    s_lshl_b32 s60, s5, 7
    s_add_u32 s60, s60, s3
    s_lshl_b32 s60, s60, 7
    s_add_u32 s60, s60, 2031616
    v_add_u32 v45, 156416, v45
    s_waitcnt vmcnt(0)
    buffer_load_dwordx2 v[10:11], v46, s[48:51], s60 offen offset:0 sc1
    buffer_load_dwordx2 v[12:13], v46, s[48:51], s60 offen offset:512 sc1
    buffer_load_dwordx2 v[14:15], v46, s[48:51], s60 offen offset:1024 sc1
    buffer_load_dwordx2 v[16:17], v46, s[48:51], s60 offen offset:1536 sc1
    buffer_load_dwordx2 v[18:19], v46, s[48:51], s60 offen offset:2048 sc1
    buffer_load_dwordx2 v[20:21], v46, s[48:51], s60 offen offset:2560 sc1
    buffer_load_dwordx2 v[22:23], v46, s[48:51], s60 offen offset:3072 sc1
    buffer_load_dwordx2 v[24:25], v46, s[48:51], s60 offen offset:3584 sc1
    v_and_b32 v48, 15, v0
    v_lshlrev_b32 v55, 1, v48
    s_mov_b32 s98, 0xa8888888
    v_lshrrev_b32_e64 v55, v55, s98
    v_and_b32 v55, 3, v55
    v_mul_u32_u24 v55, 160, v55
    v_lshrrev_b32 v49, 4, v0
    v_lshl_add_u32 v55, v49, 3, v55
    v_add_u32 v55, 156416, v55
    v_lshrrev_b32 v50, 1, v48
    v_and_b32 v52, 14, v48
    v_sub_u32 v48, v48, v52
    v_lshlrev_b32 v52, 31, v48
    v_lshl_add_u32 v52, v49, 4, v52
    v_lshl_add_u32 v52, v50, 6, v52
    v_lshrrev_b32 v48, 1, v50
    v_mul_u32_u24 v48, 384, v48
    v_add_u32 v52, v52, v48
    s_cmp_eq_u32 s3, 0
    s_cselect_b32 s98, 4, 2
    v_cmp_gt_u32 vcc, s98, v50
    v_or_b32 v48, 0x80000000, v52
    s_nop 0
    v_cndmask_b32 v52, v48, v52, vcc
    s_mul_i32 s64, s2, 640
    s_mul_i32 s98, s3, 128
    s_add_u32 s64, s64, s98
    s_add_u32 s64, s64, 524288
    v_lshrrev_b32 v54, 2, v0
    v_mul_u32_u24 v54, 256, v54
    v_and_b32 v48, 24, v1
    v_add_u32 v54, v54, v48
    v_bfe_u32 v48, v0, 2, 3
    s_lshl_b32 s99, s3, 1
    v_xor_b32 v48, s99, v48
    v_lshl_add_u32 v54, v48, 5, v54
    v_xor_b32 v51, 32, v54
    v_add_u32 v54, 0, v54
    v_add_u32 v51, 0, v51
    s_waitcnt vmcnt(0)
    v_max_u32 v44, v10, v11
    v_max3_u32 v44, v44, v12, v13
    v_max3_u32 v44, v44, v14, v15
    v_max3_u32 v44, v44, v16, v17
    v_max3_u32 v44, v44, v18, v19
    v_max3_u32 v44, v44, v20, v21
    v_max3_u32 v44, v44, v22, v23
    v_max3_u32 v44, v44, v24, v25
    v_cmp_eq_u32 vcc, -1, v44
    s_cbranch_vccz P11d
P11:
    buffer_load_dwordx2 v[10:11], v46, s[48:51], s60 offen offset:0 sc1
    buffer_load_dwordx2 v[12:13], v46, s[48:51], s60 offen offset:512 sc1
    buffer_load_dwordx2 v[14:15], v46, s[48:51], s60 offen offset:1024 sc1
    buffer_load_dwordx2 v[16:17], v46, s[48:51], s60 offen offset:1536 sc1
    buffer_load_dwordx2 v[18:19], v46, s[48:51], s60 offen offset:2048 sc1
    buffer_load_dwordx2 v[20:21], v46, s[48:51], s60 offen offset:2560 sc1
    buffer_load_dwordx2 v[22:23], v46, s[48:51], s60 offen offset:3072 sc1
    buffer_load_dwordx2 v[24:25], v46, s[48:51], s60 offen offset:3584 sc1
    s_waitcnt vmcnt(0)
    s_sub_u32 s6, s6, 1
    s_cselect_b32 s6, 0, s6
    s_cbranch_scc1 P11x
    v_max_u32 v44, v10, v11
    v_max3_u32 v44, v44, v12, v13
    v_max3_u32 v44, v44, v14, v15
    v_max3_u32 v44, v44, v16, v17
    v_max3_u32 v44, v44, v18, v19
    v_max3_u32 v44, v44, v20, v21
    v_max3_u32 v44, v44, v22, v23
    v_max3_u32 v44, v44, v24, v25
    v_cmp_eq_u32 vcc, -1, v44
    s_cbranch_vccnz P11
P11x:
P11d:
    v_add_f32 v10, v10, v12
    v_add_f32 v11, v11, v13
    v_add_f32 v14, v14, v16
    v_add_f32 v15, v15, v17
    v_add_f32 v18, v18, v20
    v_add_f32 v19, v19, v21
    v_add_f32 v22, v22, v24
    v_add_f32 v23, v23, v25
    v_add_f32 v10, v10, v14
    v_add_f32 v11, v11, v15
    v_add_f32 v18, v18, v22
    v_add_f32 v19, v19, v23
    v_add_f32 v10, v10, v18
    v_add_f32 v11, v11, v19
    v_and_b32 v47, 0xffff0000, v4
    s_nop 0
    v_permlane32_swap_b32 v10, v11
    v_add_f32 v26, v10, v11
    v_add_f32 v27, v10, v11
    s_nop 1
    v_permlane16_swap_b32 v26, v27
    s_mov_b32 exec_lo, 0x1ff
    s_mov_b32 exec_hi, 0x1ff
    v_add_f32 v26, v26, v27
    v_add_f32 v26, v26, v47
    v_cvt_pk_bf16_f32 v4, v26, v26
    ds_write_b16 v45, v4
    s_mov_b64 exec, -1
    ds_read_b64_tr_b16 v[20:21], v54 offset:0
    ds_read_b64_tr_b16 v[22:23], v54 offset:4096
    ds_read_b64_tr_b16 v[24:25], v54 offset:8192
    ds_read_b64_tr_b16 v[26:27], v54 offset:12288
    ds_read_b64_tr_b16 v[28:29], v54 offset:16384
    ds_read_b64_tr_b16 v[30:31], v51 offset:0
    ds_read_b64_tr_b16 v[32:33], v51 offset:4096
    ds_read_b64_tr_b16 v[34:35], v51 offset:8192
    ds_read_b64_tr_b16 v[36:37], v51 offset:12288
    ds_read_b64_tr_b16 v[38:39], v51 offset:16384
    s_waitcnt lgkmcnt(10)
    s_barrier
    ds_read2_b64 v[10:13], v55 offset0:0 offset1:4
    ds_read2_b64 v[14:17], v55 offset0:8 offset1:12
    ds_read_b64 v[18:19], v55 offset:128
    s_waitcnt lgkmcnt(0)
    v_mfma_f32_16x16x32_bf16 v[40:43], v[10:13], v[10:13], 0
    v_mfma_f32_16x16x32_bf16 v[44:47], v[20:23], v[10:13], 0
    v_mfma_f32_16x16x32_bf16 v[48:51], v[30:33], v[10:13], 0
    v_mfma_f32_16x16x32_bf16 v[40:43], v[14:17], v[14:17], v[40:43]
    v_mfma_f32_16x16x32_bf16 v[44:47], v[24:27], v[14:17], v[44:47]
    v_mfma_f32_16x16x32_bf16 v[48:51], v[34:37], v[14:17], v[48:51]
    s_nop 4
    v_mfma_f32_16x16x16_bf16 v[40:43], v[18:19], v[18:19], v[40:43]
    v_mfma_f32_16x16x16_bf16 v[44:47], v[28:29], v[18:19], v[44:47]
    v_mfma_f32_16x16x16_bf16 v[48:51], v[38:39], v[18:19], v[48:51]
    s_nop 5
    s_mov_b32 vcc_lo, 0x30003
    s_mov_b32 vcc_hi, 0x30003
    v_cndmask_b32 v40, v40, v44, vcc
    v_cndmask_b32 v41, v41, v45, vcc
    v_cndmask_b32 v42, v42, v46, vcc
    v_cndmask_b32 v43, v43, v47, vcc
    s_mov_b32 vcc_lo, 0xc000c
    s_mov_b32 vcc_hi, 0xc000c
    v_cndmask_b32 v40, v40, v48, vcc
    v_cndmask_b32 v41, v41, v49, vcc
    v_cndmask_b32 v42, v42, v50, vcc
    v_cndmask_b32 v43, v43, v51, vcc
    s_cmp_eq_u32 s97, 0
    s_cbranch_scc1 Y12
    buffer_store_dwordx4 v[40:43], v52, s[48:51], s64 offen
Y12d:
    v_lshrrev_b32 v46, 3, v0
    v_mul_u32_u24 v46, 640, v46
    v_and_b32 v45, 7, v0
    v_lshl_add_u32 v45, s3, 3, v45
    v_lshl_add_u32 v47, v45, 4, v46
    s_mul_i32 s60, s4, 5120
    s_add_u32 s60, s60, 524288
    v_mul_u32_u24 v46, 640, v0
    v_cmp_gt_u32 vcc, 8, v0
    v_or_b32 v44, 0x80000000, v46
    s_nop 0
    v_cndmask_b32 v46, v44, v46, vcc
    s_waitcnt vmcnt(0)
    buffer_load_dwordx4 v[18:21], v46, s[48:51], s60 offen offset:560 sc1
    buffer_load_dwordx4 v[10:13], v47, s[48:51], s60 offen offset:0 sc1
    v_lshrrev_b32 v5, 4, v0
    v_and_b32 v9, 3, v0
    v_lshl_add_u32 v5, v5, 2, v9
    v_lshlrev_b32 v5, 4, v5
    v_add_u32 v5, 162432, v5
    v_lshl_add_u32 v9, v1, 1, s62
    ds_read_b128 v[28:31], v9 offset:0
    ds_read_b128 v[52:55], v9 offset:1024
    ds_read_b128 v[32:35], v9 offset:2048
    ds_read_b128 v[40:43], v9 offset:3072
    ds_read_b128 v[36:39], v9 offset:4096
    v_lshrrev_b32 v44, 4, v0
    v_bfrev_b32 v44, v44
    v_lshrrev_b32 v44, 29, v44
    v_lshl_add_u32 v45, v45, 3, v44
    v_add_u32 v45, 162432, v45
    s_waitcnt vmcnt(0)
    v_max_u32 v44, v10, v11
    v_max3_u32 v44, v44, v12, v13
    v_max3_u32 v44, v44, v18, v20
    v_cmp_eq_u32 vcc, -1, v44
    s_cbranch_vccz P13d
P13:
    buffer_load_dwordx4 v[18:21], v46, s[48:51], s60 offen offset:560 sc1
    buffer_load_dwordx4 v[10:13], v47, s[48:51], s60 offen offset:0 sc1
    s_waitcnt vmcnt(0)
    s_sub_u32 s6, s6, 1
    s_cselect_b32 s6, 0, s6
    s_cbranch_scc1 P13x
    v_max_u32 v44, v10, v11
    v_max3_u32 v44, v44, v12, v13
    v_max3_u32 v44, v44, v18, v20
    v_cmp_eq_u32 vcc, -1, v44
    s_cbranch_vccnz P13
P13x:
P13d:
    s_waitcnt lgkmcnt(0)
    s_add_u32 s63, s101, 0
    s_and_b32 s63, s63, 0x1fffff
    s_bitset1_b32 s63, 26
    s_add_u32 m0, s62, 0
    s_nop 0
    buffer_load_dwordx4 v2, s[8:11], s63 offen offset:0 nt lds
    s_add_u32 m0, s62, 4294966272
    s_nop 0
    buffer_load_dwordx4 v2, s[8:11], s63 offen offset:2048 nt lds
    s_add_u32 s63, s101, 131072
    s_and_b32 s63, s63, 0x1fffff
    s_bitset1_b32 s63, 26
    s_add_u32 m0, s62, 2048
    s_nop 0
    buffer_load_dwordx4 v2, s[8:11], s63 offen offset:0 nt lds
    s_add_u32 m0, s62, 1024
    s_nop 0
    buffer_load_dwordx4 v2, s[8:11], s63 offen offset:2048 nt lds
    s_add_u32 s63, s101, 262144
    s_and_b32 s63, s63, 0x1fffff
    s_bitset1_b32 s63, 26
    s_add_u32 m0, s62, 4096
    s_nop 0
    buffer_load_dwordx4 v2, s[8:11], s63 offen offset:0 nt lds
    v_permlane32_swap_b32 v10, v11
    v_permlane32_swap_b32 v12, v13
    v_add_f32_dpp v18, v18, v18 quad_perm:[1,0,3,2] row_mask:0xf bank_mask:0xf
    v_add_f32 v10, v10, v11
    v_add_f32_dpp v20, v20, v20 quad_perm:[1,0,3,2] row_mask:0xf bank_mask:0xf
    v_add_f32 v11, v12, v13
    v_add_f32_dpp v18, v18, v18 quad_perm:[2,3,0,1] row_mask:0xf bank_mask:0xf
    v_add_f32_dpp v20, v20, v20 quad_perm:[2,3,0,1] row_mask:0xf bank_mask:0xf
    v_permlane16_swap_b32 v10, v11
    v_add_f32_dpp v18, v18, v18 row_half_mirror row_mask:0xf bank_mask:0xf
    v_add_f32 v10, v10, v11
    v_add_f32_dpp v20, v20, v20 row_half_mirror row_mask:0xf bank_mask:0xf
    v_mul_f32 v20, 0x3ae38e39, v20
    v_add_f32_dpp v10, v10, v10 row_ror:8 row_mask:0xf bank_mask:0xf
    v_mul_f32 v18, 0x3ae38e39, v18
    v_fma_f32 v18, -v20, v20, v18
    v_max_f32 v18, 0, v18
    v_add_f32 v18, 0x3727c5ac, v18
    v_rsq_f32 v18, v18
    v_readfirstlane_b32 s0, v20
    v_readfirstlane_b32 s1, v18
    s_nop 0
    v_fma_f32 v10, -s0, v8, v10
    v_mul_f32 v10, s1, v10
    v_cvt_pk_bf16_f32 v10, v10, v10
    ds_write_b16 v45, v10
    s_waitcnt lgkmcnt(0)
    s_barrier
    ds_read_b128 v[48:51], v5
    s_waitcnt lgkmcnt(0)
    v_cndmask_b32 v12, 0, v48, s[52:53]
    v_cndmask_b32 v13, 0, v49, s[52:53]
    v_cndmask_b32 v14, 0, v50, s[52:53]
    v_cndmask_b32 v15, 0, v51, s[52:53]
    v_cndmask_b32 v16, 0, v48, s[54:55]
    v_cndmask_b32 v17, 0, v49, s[54:55]
    v_cndmask_b32 v18, 0, v50, s[54:55]
    v_cndmask_b32 v19, 0, v51, s[54:55]
    s_waitcnt lgkmcnt(2)
    v_mfma_f32_16x16x32_bf16 v[44:47], v[28:31], v[12:15], 0
    v_cndmask_b32 v20, 0, v48, s[56:57]
    v_cndmask_b32 v21, 0, v49, s[56:57]
    v_cndmask_b32 v22, 0, v50, s[56:57]
    v_cndmask_b32 v23, 0, v51, s[56:57]
    v_mfma_f32_16x16x32_bf16 v[44:47], v[56:59], v[16:19], v[44:47]
    v_cndmask_b32 v24, 0, v48, s[58:59]
    v_cndmask_b32 v25, 0, v49, s[58:59]
    v_cndmask_b32 v26, 0, v50, s[58:59]
    v_cndmask_b32 v27, 0, v51, s[58:59]
    s_waitcnt lgkmcnt(2)
    v_mfma_f32_16x16x32_bf16 v[44:47], v[52:55], v[20:23], v[44:47]
    s_nop 0
    v_mfma_f32_16x16x32_bf16 v[44:47], v[60:63], v[24:27], v[44:47]
    s_add_u32 s63, s101, 0
    s_and_b32 s63, s63, 0x1fffff
    s_bitset1_b32 s63, 26
    buffer_load_dwordx4 v[56:59], v2, s[8:11], s63 offen offset:1024 nt
    buffer_load_dwordx4 v[60:63], v2, s[8:11], s63 offen offset:3072 nt
    s_waitcnt lgkmcnt(2)
    v_mfma_f32_16x16x32_bf16 v[48:51], v[32:35], v[12:15], 0
    ds_read_b128 v[32:35], v9 offset:5120
    v_mfma_f32_16x16x32_bf16 v[48:51], v[64:67], v[16:19], v[48:51]
    s_waitcnt lgkmcnt(2)
    v_mfma_f32_16x16x32_bf16 v[48:51], v[40:43], v[20:23], v[48:51]
    ds_read_b128 v[40:43], v9 offset:6144
    v_mfma_f32_16x16x32_bf16 v[48:51], v[68:71], v[24:27], v[48:51]
    s_add_u32 s63, s101, 131072
    s_and_b32 s63, s63, 0x1fffff
    s_bitset1_b32 s63, 26
    buffer_load_dwordx4 v[64:67], v2, s[8:11], s63 offen offset:1024 nt
    buffer_load_dwordx4 v[68:71], v2, s[8:11], s63 offen offset:3072 nt
    s_waitcnt lgkmcnt(2)
    v_mfma_f32_16x16x32_bf16 v[52:55], v[36:39], v[12:15], 0
    ds_read_b128 v[36:39], v9 offset:7168
    v_mov_b32_dpp v28, v44 quad_perm:[0,0,0,0] row_mask:0xf bank_mask:0xf
    v_mfma_f32_16x16x32_bf16 v[52:55], v[72:75], v[16:19], v[52:55]
    v_add_f32_dpp v28, v45, v28 quad_perm:[1,1,1,1] row_mask:0xf bank_mask:0xf
    s_waitcnt lgkmcnt(2)
    v_mfma_f32_16x16x32_bf16 v[52:55], v[32:35], v[20:23], v[52:55]
    ds_read_b128 v[32:35], v9 offset:8192
    v_add_f32_dpp v28, v46, v28 quad_perm:[2,2,2,2] row_mask:0xf bank_mask:0xf
    v_mfma_f32_16x16x32_bf16 v[52:55], v[76:79], v[24:27], v[52:55]
    v_add_f32_dpp v28, v47, v28 quad_perm:[3,3,3,3] row_mask:0xf bank_mask:0xf
    v_max_f32 v10, v28, v28
    s_add_u32 s63, s101, 262144
    s_and_b32 s63, s63, 0x1fffff
    s_bitset1_b32 s63, 26
    buffer_load_dwordx4 v[72:75], v2, s[8:11], s63 offen offset:1024 nt
    s_add_u32 m0, s62, 3072
    s_nop 0
    buffer_load_dwordx4 v2, s[8:11], s63 offen offset:2048 nt lds
    buffer_load_dwordx4 v[76:79], v2, s[8:11], s63 offen offset:3072 nt
    s_waitcnt lgkmcnt(2)
    v_mfma_f32_16x16x32_bf16 v[44:47], v[40:43], v[12:15], 0
    ds_read_b128 v[40:43], v9 offset:9216
    v_mov_b32_dpp v29, v48 quad_perm:[0,0,0,0] row_mask:0xf bank_mask:0xf
    v_mfma_f32_16x16x32_bf16 v[44:47], v[80:83], v[16:19], v[44:47]
    v_add_f32_dpp v29, v49, v29 quad_perm:[1,1,1,1] row_mask:0xf bank_mask:0xf
    s_waitcnt lgkmcnt(2)
    v_mfma_f32_16x16x32_bf16 v[44:47], v[36:39], v[20:23], v[44:47]
    ds_read_b128 v[36:39], v9 offset:10240
    v_add_f32_dpp v29, v50, v29 quad_perm:[2,2,2,2] row_mask:0xf bank_mask:0xf
    v_mfma_f32_16x16x32_bf16 v[44:47], v[84:87], v[24:27], v[44:47]
    v_add_f32_dpp v29, v51, v29 quad_perm:[3,3,3,3] row_mask:0xf bank_mask:0xf
    v_max_f32 v10, v10, v29
    s_add_u32 s63, s101, 393216
    s_and_b32 s63, s63, 0x1fffff
    s_bitset1_b32 s63, 26
    s_add_u32 m0, s62, 6144
    s_nop 0
    buffer_load_dwordx4 v2, s[8:11], s63 offen offset:0 nt lds
    buffer_load_dwordx4 v[80:83], v2, s[8:11], s63 offen offset:1024 nt
    s_add_u32 m0, s62, 5120
    s_nop 0
    buffer_load_dwordx4 v2, s[8:11], s63 offen offset:2048 nt lds
    buffer_load_dwordx4 v[84:87], v2, s[8:11], s63 offen offset:3072 nt
    s_waitcnt lgkmcnt(2)
    v_mfma_f32_16x16x32_bf16 v[48:51], v[32:35], v[12:15], 0
    ds_read_b128 v[32:35], v9 offset:11264
    v_mov_b32_dpp v30, v52 quad_perm:[0,0,0,0] row_mask:0xf bank_mask:0xf
    v_mfma_f32_16x16x32_bf16 v[48:51], v[88:91], v[16:19], v[48:51]
    v_add_f32_dpp v30, v53, v30 quad_perm:[1,1,1,1] row_mask:0xf bank_mask:0xf
    s_waitcnt lgkmcnt(2)
    v_mfma_f32_16x16x32_bf16 v[48:51], v[40:43], v[20:23], v[48:51]
    ds_read_b128 v[40:43], v9 offset:12288
    v_add_f32_dpp v30, v54, v30 quad_perm:[2,2,2,2] row_mask:0xf bank_mask:0xf
    v_mfma_f32_16x16x32_bf16 v[48:51], v[92:95], v[24:27], v[48:51]
    v_add_f32_dpp v30, v55, v30 quad_perm:[3,3,3,3] row_mask:0xf bank_mask:0xf
    v_max_f32 v10, v10, v30
    s_waitcnt lgkmcnt(2)
    v_mfma_f32_16x16x32_bf16 v[52:55], v[36:39], v[12:15], 0
    ds_read_b128 v[36:39], v9 offset:13312
    v_mov_b32_dpp v31, v44 quad_perm:[0,0,0,0] row_mask:0xf bank_mask:0xf
    v_mfma_f32_16x16x32_bf16 v[52:55], v[96:99], v[16:19], v[52:55]
    v_add_f32_dpp v31, v45, v31 quad_perm:[1,1,1,1] row_mask:0xf bank_mask:0xf
    s_waitcnt lgkmcnt(2)
    v_mfma_f32_16x16x32_bf16 v[52:55], v[32:35], v[20:23], v[52:55]
    v_add_f32_dpp v31, v46, v31 quad_perm:[2,2,2,2] row_mask:0xf bank_mask:0xf
    v_mfma_f32_16x16x32_bf16 v[52:55], v[100:103], v[24:27], v[52:55]
    v_add_f32_dpp v31, v47, v31 quad_perm:[3,3,3,3] row_mask:0xf bank_mask:0xf
    v_max_f32 v10, v10, v31
    s_waitcnt lgkmcnt(1)
    v_mfma_f32_16x16x32_bf16 v[44:47], v[40:43], v[12:15], 0
    v_mov_b32_dpp v32, v48 quad_perm:[0,0,0,0] row_mask:0xf bank_mask:0xf
    v_mfma_f32_16x16x32_bf16 v[44:47], v[104:107], v[16:19], v[44:47]
    v_add_f32_dpp v32, v49, v32 quad_perm:[1,1,1,1] row_mask:0xf bank_mask:0xf
    s_waitcnt lgkmcnt(0)
    v_mfma_f32_16x16x32_bf16 v[44:47], v[36:39], v[20:23], v[44:47]
    v_add_f32_dpp v32, v50, v32 quad_perm:[2,2,2,2] row_mask:0xf bank_mask:0xf
    v_mfma_f32_16x16x32_bf16 v[44:47], v[108:111], v[24:27], v[44:47]
    v_add_f32_dpp v32, v51, v32 quad_perm:[3,3,3,3] row_mask:0xf bank_mask:0xf
    v_max_f32 v10, v10, v32
    v_mfma_f32_16x16x32_bf16 v[48:51], v[112:115], v[12:15], 0
    v_mov_b32_dpp v33, v52 quad_perm:[0,0,0,0] row_mask:0xf bank_mask:0xf
    v_mfma_f32_16x16x32_bf16 v[48:51], v[116:119], v[16:19], v[48:51]
    v_add_f32_dpp v33, v53, v33 quad_perm:[1,1,1,1] row_mask:0xf bank_mask:0xf
    v_mfma_f32_16x16x32_bf16 v[48:51], v[120:123], v[20:23], v[48:51]
    v_add_f32_dpp v33, v54, v33 quad_perm:[2,2,2,2] row_mask:0xf bank_mask:0xf
    v_mfma_f32_16x16x32_bf16 v[48:51], v[124:127], v[24:27], v[48:51]
    v_add_f32_dpp v33, v55, v33 quad_perm:[3,3,3,3] row_mask:0xf bank_mask:0xf
    v_max_f32 v10, v10, v33
    v_mfma_f32_16x16x32_bf16 v[52:55], v[128:131], v[12:15], 0
    v_mov_b32_dpp v34, v44 quad_perm:[0,0,0,0] row_mask:0xf bank_mask:0xf
    v_mfma_f32_16x16x32_bf16 v[52:55], v[132:135], v[16:19], v[52:55]
    v_add_f32_dpp v34, v45, v34 quad_perm:[1,1,1,1] row_mask:0xf bank_mask:0xf
    v_mfma_f32_16x16x32_bf16 v[52:55], v[136:139], v[20:23], v[52:55]
    v_add_f32_dpp v34, v46, v34 quad_perm:[2,2,2,2] row_mask:0xf bank_mask:0xf
    v_mfma_f32_16x16x32_bf16 v[52:55], v[140:143], v[24:27], v[52:55]
    v_add_f32_dpp v34, v47, v34 quad_perm:[3,3,3,3] row_mask:0xf bank_mask:0xf
    v_max_f32 v10, v10, v34
    v_mfma_f32_16x16x32_bf16 v[44:47], v[144:147], v[12:15], 0
    v_mov_b32_dpp v35, v48 quad_perm:[0,0,0,0] row_mask:0xf bank_mask:0xf
    v_mfma_f32_16x16x32_bf16 v[44:47], v[148:151], v[16:19], v[44:47]
    v_add_f32_dpp v35, v49, v35 quad_perm:[1,1,1,1] row_mask:0xf bank_mask:0xf
    v_mfma_f32_16x16x32_bf16 v[44:47], v[152:155], v[20:23], v[44:47]
    v_add_f32_dpp v35, v50, v35 quad_perm:[2,2,2,2] row_mask:0xf bank_mask:0xf
    v_mfma_f32_16x16x32_bf16 v[44:47], v[156:159], v[24:27], v[44:47]
    v_add_f32_dpp v35, v51, v35 quad_perm:[3,3,3,3] row_mask:0xf bank_mask:0xf
    v_max_f32 v10, v10, v35
    v_mfma_f32_16x16x32_bf16 v[48:51], v[160:163], v[12:15], 0
    v_mov_b32_dpp v36, v52 quad_perm:[0,0,0,0] row_mask:0xf bank_mask:0xf
    v_mfma_f32_16x16x32_bf16 v[48:51], v[164:167], v[16:19], v[48:51]
    v_add_f32_dpp v36, v53, v36 quad_perm:[1,1,1,1] row_mask:0xf bank_mask:0xf
    v_mfma_f32_16x16x32_bf16 v[48:51], v[168:171], v[20:23], v[48:51]
    v_add_f32_dpp v36, v54, v36 quad_perm:[2,2,2,2] row_mask:0xf bank_mask:0xf
    v_mfma_f32_16x16x32_bf16 v[48:51], v[172:175], v[24:27], v[48:51]
    v_add_f32_dpp v36, v55, v36 quad_perm:[3,3,3,3] row_mask:0xf bank_mask:0xf
    v_max_f32 v10, v10, v36
    v_mfma_f32_16x16x32_bf16 v[52:55], v[176:179], v[12:15], 0
    v_mov_b32_dpp v37, v44 quad_perm:[0,0,0,0] row_mask:0xf bank_mask:0xf
    v_mfma_f32_16x16x32_bf16 v[52:55], v[180:183], v[16:19], v[52:55]
    v_add_f32_dpp v37, v45, v37 quad_perm:[1,1,1,1] row_mask:0xf bank_mask:0xf
    v_mfma_f32_16x16x32_bf16 v[52:55], v[184:187], v[20:23], v[52:55]
    v_add_f32_dpp v37, v46, v37 quad_perm:[2,2,2,2] row_mask:0xf bank_mask:0xf
    v_mfma_f32_16x16x32_bf16 v[52:55], v[188:191], v[24:27], v[52:55]
    v_add_f32_dpp v37, v47, v37 quad_perm:[3,3,3,3] row_mask:0xf bank_mask:0xf
    v_max_f32 v10, v10, v37
    v_mfma_f32_16x16x32_bf16 v[44:47], v[192:195], v[12:15], 0
    v_mov_b32_dpp v38, v48 quad_perm:[0,0,0,0] row_mask:0xf bank_mask:0xf
    v_mfma_f32_16x16x32_bf16 v[44:47], v[196:199], v[16:19], v[44:47]
    v_add_f32_dpp v38, v49, v38 quad_perm:[1,1,1,1] row_mask:0xf bank_mask:0xf
    v_mfma_f32_16x16x32_bf16 v[44:47], v[200:203], v[20:23], v[44:47]
    v_add_f32_dpp v38, v50, v38 quad_perm:[2,2,2,2] row_mask:0xf bank_mask:0xf
    v_mfma_f32_16x16x32_bf16 v[44:47], v[204:207], v[24:27], v[44:47]
    v_add_f32_dpp v38, v51, v38 quad_perm:[3,3,3,3] row_mask:0xf bank_mask:0xf
    v_max_f32 v10, v10, v38
    v_mfma_f32_16x16x32_bf16 v[48:51], v[208:211], v[12:15], 0
    v_mov_b32_dpp v39, v52 quad_perm:[0,0,0,0] row_mask:0xf bank_mask:0xf
    v_mfma_f32_16x16x32_bf16 v[48:51], v[212:215], v[16:19], v[48:51]
    v_add_f32_dpp v39, v53, v39 quad_perm:[1,1,1,1] row_mask:0xf bank_mask:0xf
    v_mfma_f32_16x16x32_bf16 v[48:51], v[216:219], v[20:23], v[48:51]
    v_add_f32_dpp v39, v54, v39 quad_perm:[2,2,2,2] row_mask:0xf bank_mask:0xf
    v_mfma_f32_16x16x32_bf16 v[48:51], v[220:223], v[24:27], v[48:51]
    v_add_f32_dpp v39, v55, v39 quad_perm:[3,3,3,3] row_mask:0xf bank_mask:0xf
    v_max_f32 v10, v10, v39
    v_mfma_f32_16x16x32_bf16 v[52:55], v[224:227], v[12:15], 0
    v_mov_b32_dpp v40, v44 quad_perm:[0,0,0,0] row_mask:0xf bank_mask:0xf
    v_mfma_f32_16x16x32_bf16 v[52:55], v[228:231], v[16:19], v[52:55]
    v_add_f32_dpp v40, v45, v40 quad_perm:[1,1,1,1] row_mask:0xf bank_mask:0xf
    v_mfma_f32_16x16x32_bf16 v[52:55], v[232:235], v[20:23], v[52:55]
    v_add_f32_dpp v40, v46, v40 quad_perm:[2,2,2,2] row_mask:0xf bank_mask:0xf
    v_mfma_f32_16x16x32_bf16 v[52:55], v[236:239], v[24:27], v[52:55]
    v_add_f32_dpp v40, v47, v40 quad_perm:[3,3,3,3] row_mask:0xf bank_mask:0xf
    v_max_f32 v10, v10, v40
    v_mfma_f32_16x16x32_bf16 v[44:47], v[240:243], v[12:15], 0
    v_mov_b32_dpp v41, v48 quad_perm:[0,0,0,0] row_mask:0xf bank_mask:0xf
    v_mfma_f32_16x16x32_bf16 v[44:47], v[244:247], v[16:19], v[44:47]
    v_add_f32_dpp v41, v49, v41 quad_perm:[1,1,1,1] row_mask:0xf bank_mask:0xf
    v_mfma_f32_16x16x32_bf16 v[44:47], v[248:251], v[20:23], v[44:47]
    v_add_f32_dpp v41, v50, v41 quad_perm:[2,2,2,2] row_mask:0xf bank_mask:0xf
    v_mfma_f32_16x16x32_bf16 v[44:47], v[252:255], v[24:27], v[44:47]
    v_add_f32_dpp v41, v51, v41 quad_perm:[3,3,3,3] row_mask:0xf bank_mask:0xf
    v_max_f32 v10, v10, v41
    v_mov_b32_dpp v42, v52 quad_perm:[0,0,0,0] row_mask:0xf bank_mask:0xf
    v_add_f32_dpp v42, v53, v42 quad_perm:[1,1,1,1] row_mask:0xf bank_mask:0xf
    v_add_f32_dpp v42, v54, v42 quad_perm:[2,2,2,2] row_mask:0xf bank_mask:0xf
    v_add_f32_dpp v42, v55, v42 quad_perm:[3,3,3,3] row_mask:0xf bank_mask:0xf
    v_max_f32 v10, v10, v42
    v_and_b32 v11, 1, v0
    v_lshlrev_b32 v11, 4, v11
    v_mov_b32 v48, 0xffff
    v_lshlrev_b32 v48, v11, v48
    v_mov_b32_dpp v43, v44 quad_perm:[0,0,0,0] row_mask:0xf bank_mask:0xf
    v_add_f32_dpp v43, v45, v43 quad_perm:[1,1,1,1] row_mask:0xf bank_mask:0xf
    v_add_f32_dpp v43, v46, v43 quad_perm:[2,2,2,2] row_mask:0xf bank_mask:0xf
    v_add_f32_dpp v43, v47, v43 quad_perm:[3,3,3,3] row_mask:0xf bank_mask:0xf
    v_max_f32 v10, v10, v43
    s_mov_b32 vcc_lo, 0x33333333
    s_mov_b32 vcc_hi, 0x33333333
    v_cndmask_b32 v44, 0, v48, vcc
    s_mov_b32 vcc_lo, 0xcccccccc
    s_mov_b32 vcc_hi, 0xcccccccc
    v_cndmask_b32 v45, 0, v48, vcc
    s_mov_b32 s7, 0x3e0293ee
    s_nop 1
    v_max_f32_dpp v10, v10, v10 row_ror:4 row_mask:0xf bank_mask:0xf
    s_nop 1
    v_max_f32_dpp v10, v10, v10 row_ror:8 row_mask:0xf bank_mask:0xf
    v_mov_b32 v11, v10
    s_nop 1
    v_permlane32_swap_b32 v10, v11
    v_max_f32 v10, v10, v11
    v_mov_b32 v11, v10
    s_nop 1
    v_permlane16_swap_b32 v10, v11
    v_max_f32 v10, v10, v11
    v_mul_f32 v10, s7, v10
    v_mov_b32 v11, 0
    v_fma_f32 v28, v28, s7, -v10
    v_fma_f32 v29, v29, s7, -v10
    v_exp_f32 v28, v28
    v_exp_f32 v29, v29
    v_add_f32 v11, v11, v28
    v_add_f32 v11, v11, v29
    v_cvt_pk_bf16_f32 v28, v28, v28
    v_cvt_pk_bf16_f32 v29, v29, v29
    v_and_b32 v48, v28, v44
    v_and_b32 v49, v28, v45
    s_nop 1
    v_mfma_f32_4x4x4_16b_bf16 v[12:15], v[48:49], a[0:1], 0 cbsz:2 abid:0
    v_and_b32 v50, v29, v44
    v_mfma_f32_4x4x4_16b_bf16 v[16:19], v[48:49], a[2:3], 0 cbsz:2 abid:0
    v_and_b32 v51, v29, v45
    v_mfma_f32_4x4x4_16b_bf16 v[20:23], v[48:49], a[4:5], 0 cbsz:2 abid:1
    v_fma_f32 v30, v30, s7, -v10
    v_mfma_f32_4x4x4_16b_bf16 v[24:27], v[48:49], a[6:7], 0 cbsz:2 abid:1
    v_exp_f32 v30, v30
    v_mfma_f32_4x4x4_16b_bf16 v[12:15], v[48:49], a[8:9], v[12:15] cbsz:2 abid:2
    v_add_f32 v11, v11, v30
    v_mfma_f32_4x4x4_16b_bf16 v[16:19], v[48:49], a[10:11], v[16:19] cbsz:2 abid:2
    v_cvt_pk_bf16_f32 v30, v30, v30
    v_mfma_f32_4x4x4_16b_bf16 v[20:23], v[48:49], a[12:13], v[20:23] cbsz:2 abid:3
    v_mfma_f32_4x4x4_16b_bf16 v[24:27], v[48:49], a[14:15], v[24:27] cbsz:2 abid:3
    s_add_u32 s63, s101, 524288
    s_and_b32 s63, s63, 0x1fffff
    s_bitset1_b32 s63, 26
    s_add_u32 m0, s62, 8192
    s_nop 0
    buffer_load_dwordx4 v2, s[8:11], s63 offen offset:0 nt lds
    v_mfma_f32_4x4x4_16b_bf16 v[12:15], v[50:51], a[16:17], v[12:15] cbsz:2 abid:0
    v_and_b32 v48, v30, v44
    v_mfma_f32_4x4x4_16b_bf16 v[16:19], v[50:51], a[18:19], v[16:19] cbsz:2 abid:0
    v_and_b32 v49, v30, v45
    v_mfma_f32_4x4x4_16b_bf16 v[20:23], v[50:51], a[20:21], v[20:23] cbsz:2 abid:1
    v_fma_f32 v31, v31, s7, -v10
    v_mfma_f32_4x4x4_16b_bf16 v[24:27], v[50:51], a[22:23], v[24:27] cbsz:2 abid:1
    v_exp_f32 v31, v31
    v_mfma_f32_4x4x4_16b_bf16 v[12:15], v[50:51], a[24:25], v[12:15] cbsz:2 abid:2
    v_add_f32 v11, v11, v31
    v_mfma_f32_4x4x4_16b_bf16 v[16:19], v[50:51], a[26:27], v[16:19] cbsz:2 abid:2
    v_cvt_pk_bf16_f32 v31, v31, v31
    v_mfma_f32_4x4x4_16b_bf16 v[20:23], v[50:51], a[28:29], v[20:23] cbsz:2 abid:3
    v_mfma_f32_4x4x4_16b_bf16 v[24:27], v[50:51], a[30:31], v[24:27] cbsz:2 abid:3
    buffer_load_dwordx4 v[88:91], v2, s[8:11], s63 offen offset:1024 nt
    v_mfma_f32_4x4x4_16b_bf16 v[12:15], v[48:49], a[32:33], v[12:15] cbsz:2 abid:0
    v_and_b32 v50, v31, v44
    v_mfma_f32_4x4x4_16b_bf16 v[16:19], v[48:49], a[34:35], v[16:19] cbsz:2 abid:0
    v_and_b32 v51, v31, v45
    v_mfma_f32_4x4x4_16b_bf16 v[20:23], v[48:49], a[36:37], v[20:23] cbsz:2 abid:1
    v_fma_f32 v32, v32, s7, -v10
    v_mfma_f32_4x4x4_16b_bf16 v[24:27], v[48:49], a[38:39], v[24:27] cbsz:2 abid:1
    v_exp_f32 v32, v32
    v_mfma_f32_4x4x4_16b_bf16 v[12:15], v[48:49], a[40:41], v[12:15] cbsz:2 abid:2
    v_add_f32 v11, v11, v32
    v_mfma_f32_4x4x4_16b_bf16 v[16:19], v[48:49], a[42:43], v[16:19] cbsz:2 abid:2
    v_cvt_pk_bf16_f32 v32, v32, v32
    v_mfma_f32_4x4x4_16b_bf16 v[20:23], v[48:49], a[44:45], v[20:23] cbsz:2 abid:3
    v_mfma_f32_4x4x4_16b_bf16 v[24:27], v[48:49], a[46:47], v[24:27] cbsz:2 abid:3
    s_add_u32 m0, s62, 7168
    s_nop 0
    buffer_load_dwordx4 v2, s[8:11], s63 offen offset:2048 nt lds
    v_mfma_f32_4x4x4_16b_bf16 v[12:15], v[50:51], a[48:49], v[12:15] cbsz:2 abid:0
    v_and_b32 v48, v32, v44
    v_mfma_f32_4x4x4_16b_bf16 v[16:19], v[50:51], a[50:51], v[16:19] cbsz:2 abid:0
    v_and_b32 v49, v32, v45
    v_mfma_f32_4x4x4_16b_bf16 v[20:23], v[50:51], a[52:53], v[20:23] cbsz:2 abid:1
    v_fma_f32 v33, v33, s7, -v10
    v_mfma_f32_4x4x4_16b_bf16 v[24:27], v[50:51], a[54:55], v[24:27] cbsz:2 abid:1
    v_exp_f32 v33, v33
    v_mfma_f32_4x4x4_16b_bf16 v[12:15], v[50:51], a[56:57], v[12:15] cbsz:2 abid:2
    v_add_f32 v11, v11, v33
    v_mfma_f32_4x4x4_16b_bf16 v[16:19], v[50:51], a[58:59], v[16:19] cbsz:2 abid:2
    v_cvt_pk_bf16_f32 v33, v33, v33
    v_mfma_f32_4x4x4_16b_bf16 v[20:23], v[50:51], a[60:61], v[20:23] cbsz:2 abid:3
    v_mfma_f32_4x4x4_16b_bf16 v[24:27], v[50:51], a[62:63], v[24:27] cbsz:2 abid:3
    v_mfma_f32_4x4x4_16b_bf16 v[12:15], v[48:49], a[64:65], v[12:15] cbsz:2 abid:0
    v_and_b32 v50, v33, v44
    v_mfma_f32_4x4x4_16b_bf16 v[16:19], v[48:49], a[66:67], v[16:19] cbsz:2 abid:0
    v_and_b32 v51, v33, v45
    v_mfma_f32_4x4x4_16b_bf16 v[20:23], v[48:49], a[68:69], v[20:23] cbsz:2 abid:1
    v_fma_f32 v34, v34, s7, -v10
    v_mfma_f32_4x4x4_16b_bf16 v[24:27], v[48:49], a[70:71], v[24:27] cbsz:2 abid:1
    v_exp_f32 v34, v34
    v_mfma_f32_4x4x4_16b_bf16 v[12:15], v[48:49], a[72:73], v[12:15] cbsz:2 abid:2
    v_add_f32 v11, v11, v34
    v_mfma_f32_4x4x4_16b_bf16 v[16:19], v[48:49], a[74:75], v[16:19] cbsz:2 abid:2
    v_cvt_pk_bf16_f32 v34, v34, v34
    v_mfma_f32_4x4x4_16b_bf16 v[20:23], v[48:49], a[76:77], v[20:23] cbsz:2 abid:3
    v_mfma_f32_4x4x4_16b_bf16 v[24:27], v[48:49], a[78:79], v[24:27] cbsz:2 abid:3
    buffer_load_dwordx4 v[92:95], v2, s[8:11], s63 offen offset:3072 nt
    v_mfma_f32_4x4x4_16b_bf16 v[12:15], v[50:51], a[80:81], v[12:15] cbsz:2 abid:0
    v_and_b32 v48, v34, v44
    v_mfma_f32_4x4x4_16b_bf16 v[16:19], v[50:51], a[82:83], v[16:19] cbsz:2 abid:0
    v_and_b32 v49, v34, v45
    v_mfma_f32_4x4x4_16b_bf16 v[20:23], v[50:51], a[84:85], v[20:23] cbsz:2 abid:1
    v_fma_f32 v35, v35, s7, -v10
    v_mfma_f32_4x4x4_16b_bf16 v[24:27], v[50:51], a[86:87], v[24:27] cbsz:2 abid:1
    v_exp_f32 v35, v35
    v_mfma_f32_4x4x4_16b_bf16 v[12:15], v[50:51], a[88:89], v[12:15] cbsz:2 abid:2
    v_add_f32 v11, v11, v35
    v_mfma_f32_4x4x4_16b_bf16 v[16:19], v[50:51], a[90:91], v[16:19] cbsz:2 abid:2
    v_cvt_pk_bf16_f32 v35, v35, v35
    v_mfma_f32_4x4x4_16b_bf16 v[20:23], v[50:51], a[92:93], v[20:23] cbsz:2 abid:3
    v_mfma_f32_4x4x4_16b_bf16 v[24:27], v[50:51], a[94:95], v[24:27] cbsz:2 abid:3
    s_add_u32 s63, s101, 655360
    s_and_b32 s63, s63, 0x1fffff
    s_bitset1_b32 s63, 26
    s_add_u32 m0, s62, 10240
    s_nop 0
    buffer_load_dwordx4 v2, s[8:11], s63 offen offset:0 nt lds
    v_mfma_f32_4x4x4_16b_bf16 v[12:15], v[48:49], a[96:97], v[12:15] cbsz:2 abid:0
    v_and_b32 v50, v35, v44
    v_mfma_f32_4x4x4_16b_bf16 v[16:19], v[48:49], a[98:99], v[16:19] cbsz:2 abid:0
    v_and_b32 v51, v35, v45
    v_mfma_f32_4x4x4_16b_bf16 v[20:23], v[48:49], a[100:101], v[20:23] cbsz:2 abid:1
    v_fma_f32 v36, v36, s7, -v10
    v_mfma_f32_4x4x4_16b_bf16 v[24:27], v[48:49], a[102:103], v[24:27] cbsz:2 abid:1
    v_exp_f32 v36, v36
    v_mfma_f32_4x4x4_16b_bf16 v[12:15], v[48:49], a[104:105], v[12:15] cbsz:2 abid:2
    v_add_f32 v11, v11, v36
    v_mfma_f32_4x4x4_16b_bf16 v[16:19], v[48:49], a[106:107], v[16:19] cbsz:2 abid:2
    v_cvt_pk_bf16_f32 v36, v36, v36
    v_mfma_f32_4x4x4_16b_bf16 v[20:23], v[48:49], a[108:109], v[20:23] cbsz:2 abid:3
    v_mfma_f32_4x4x4_16b_bf16 v[24:27], v[48:49], a[110:111], v[24:27] cbsz:2 abid:3
    buffer_load_dwordx4 v[96:99], v2, s[8:11], s63 offen offset:1024 nt
    v_mfma_f32_4x4x4_16b_bf16 v[12:15], v[50:51], a[112:113], v[12:15] cbsz:2 abid:0
    v_and_b32 v48, v36, v44
    v_mfma_f32_4x4x4_16b_bf16 v[16:19], v[50:51], a[114:115], v[16:19] cbsz:2 abid:0
    v_and_b32 v49, v36, v45
    v_mfma_f32_4x4x4_16b_bf16 v[20:23], v[50:51], a[116:117], v[20:23] cbsz:2 abid:1
    v_fma_f32 v37, v37, s7, -v10
    v_mfma_f32_4x4x4_16b_bf16 v[24:27], v[50:51], a[118:119], v[24:27] cbsz:2 abid:1
    v_exp_f32 v37, v37
    v_mfma_f32_4x4x4_16b_bf16 v[12:15], v[50:51], a[120:121], v[12:15] cbsz:2 abid:2
    v_add_f32 v11, v11, v37
    v_mfma_f32_4x4x4_16b_bf16 v[16:19], v[50:51], a[122:123], v[16:19] cbsz:2 abid:2
    v_cvt_pk_bf16_f32 v37, v37, v37
    v_mfma_f32_4x4x4_16b_bf16 v[20:23], v[50:51], a[124:125], v[20:23] cbsz:2 abid:3
    v_mfma_f32_4x4x4_16b_bf16 v[24:27], v[50:51], a[126:127], v[24:27] cbsz:2 abid:3
    v_mfma_f32_4x4x4_16b_bf16 v[12:15], v[48:49], a[128:129], v[12:15] cbsz:2 abid:0
    v_and_b32 v50, v37, v44
    v_mfma_f32_4x4x4_16b_bf16 v[16:19], v[48:49], a[130:131], v[16:19] cbsz:2 abid:0
    v_and_b32 v51, v37, v45
    v_mfma_f32_4x4x4_16b_bf16 v[20:23], v[48:49], a[132:133], v[20:23] cbsz:2 abid:1
    v_fma_f32 v38, v38, s7, -v10
    v_mfma_f32_4x4x4_16b_bf16 v[24:27], v[48:49], a[134:135], v[24:27] cbsz:2 abid:1
    v_exp_f32 v38, v38
    v_mfma_f32_4x4x4_16b_bf16 v[12:15], v[48:49], a[136:137], v[12:15] cbsz:2 abid:2
    v_add_f32 v11, v11, v38
    v_mfma_f32_4x4x4_16b_bf16 v[16:19], v[48:49], a[138:139], v[16:19] cbsz:2 abid:2
    v_cvt_pk_bf16_f32 v38, v38, v38
    v_mfma_f32_4x4x4_16b_bf16 v[20:23], v[48:49], a[140:141], v[20:23] cbsz:2 abid:3
    v_mfma_f32_4x4x4_16b_bf16 v[24:27], v[48:49], a[142:143], v[24:27] cbsz:2 abid:3
    s_add_u32 m0, s62, 9216
    s_nop 0
    buffer_load_dwordx4 v2, s[8:11], s63 offen offset:2048 nt lds
    v_mfma_f32_4x4x4_16b_bf16 v[12:15], v[50:51], a[144:145], v[12:15] cbsz:2 abid:0
    v_and_b32 v48, v38, v44
    v_mfma_f32_4x4x4_16b_bf16 v[16:19], v[50:51], a[146:147], v[16:19] cbsz:2 abid:0
    v_and_b32 v49, v38, v45
    v_mfma_f32_4x4x4_16b_bf16 v[20:23], v[50:51], a[148:149], v[20:23] cbsz:2 abid:1
    v_fma_f32 v39, v39, s7, -v10
    v_mfma_f32_4x4x4_16b_bf16 v[24:27], v[50:51], a[150:151], v[24:27] cbsz:2 abid:1
    v_exp_f32 v39, v39
    v_mfma_f32_4x4x4_16b_bf16 v[12:15], v[50:51], a[152:153], v[12:15] cbsz:2 abid:2
    v_add_f32 v11, v11, v39
    v_mfma_f32_4x4x4_16b_bf16 v[16:19], v[50:51], a[154:155], v[16:19] cbsz:2 abid:2
    v_cvt_pk_bf16_f32 v39, v39, v39
    v_mfma_f32_4x4x4_16b_bf16 v[20:23], v[50:51], a[156:157], v[20:23] cbsz:2 abid:3
    v_mfma_f32_4x4x4_16b_bf16 v[24:27], v[50:51], a[158:159], v[24:27] cbsz:2 abid:3
    buffer_load_dwordx4 v[100:103], v2, s[8:11], s63 offen offset:3072 nt
    v_mfma_f32_4x4x4_16b_bf16 v[12:15], v[48:49], a[160:161], v[12:15] cbsz:2 abid:0
    v_and_b32 v50, v39, v44
    v_mfma_f32_4x4x4_16b_bf16 v[16:19], v[48:49], a[162:163], v[16:19] cbsz:2 abid:0
    v_and_b32 v51, v39, v45
    v_mfma_f32_4x4x4_16b_bf16 v[20:23], v[48:49], a[164:165], v[20:23] cbsz:2 abid:1
    v_fma_f32 v40, v40, s7, -v10
    v_mfma_f32_4x4x4_16b_bf16 v[24:27], v[48:49], a[166:167], v[24:27] cbsz:2 abid:1
    v_exp_f32 v40, v40
    v_mfma_f32_4x4x4_16b_bf16 v[12:15], v[48:49], a[168:169], v[12:15] cbsz:2 abid:2
    v_add_f32 v11, v11, v40
    v_mfma_f32_4x4x4_16b_bf16 v[16:19], v[48:49], a[170:171], v[16:19] cbsz:2 abid:2
    v_cvt_pk_bf16_f32 v40, v40, v40
    v_mfma_f32_4x4x4_16b_bf16 v[20:23], v[48:49], a[172:173], v[20:23] cbsz:2 abid:3
    v_mfma_f32_4x4x4_16b_bf16 v[24:27], v[48:49], a[174:175], v[24:27] cbsz:2 abid:3
    s_add_u32 s63, s101, 786432
    s_and_b32 s63, s63, 0x1fffff
    s_bitset1_b32 s63, 26
    s_add_u32 m0, s62, 12288
    s_nop 0
    buffer_load_dwordx4 v2, s[8:11], s63 offen offset:0 nt lds
    v_mfma_f32_4x4x4_16b_bf16 v[12:15], v[50:51], a[176:177], v[12:15] cbsz:2 abid:0
    v_and_b32 v48, v40, v44
    v_mfma_f32_4x4x4_16b_bf16 v[16:19], v[50:51], a[178:179], v[16:19] cbsz:2 abid:0
    v_and_b32 v49, v40, v45
    v_mfma_f32_4x4x4_16b_bf16 v[20:23], v[50:51], a[180:181], v[20:23] cbsz:2 abid:1
    v_fma_f32 v41, v41, s7, -v10
    v_mfma_f32_4x4x4_16b_bf16 v[24:27], v[50:51], a[182:183], v[24:27] cbsz:2 abid:1
    v_exp_f32 v41, v41
    v_mfma_f32_4x4x4_16b_bf16 v[12:15], v[50:51], a[184:185], v[12:15] cbsz:2 abid:2
    v_add_f32 v11, v11, v41
    v_mfma_f32_4x4x4_16b_bf16 v[16:19], v[50:51], a[186:187], v[16:19] cbsz:2 abid:2
    v_cvt_pk_bf16_f32 v41, v41, v41
    v_mfma_f32_4x4x4_16b_bf16 v[20:23], v[50:51], a[188:189], v[20:23] cbsz:2 abid:3
    v_mfma_f32_4x4x4_16b_bf16 v[24:27], v[50:51], a[190:191], v[24:27] cbsz:2 abid:3
    v_mfma_f32_4x4x4_16b_bf16 v[12:15], v[48:49], a[192:193], v[12:15] cbsz:2 abid:0
    v_and_b32 v50, v41, v44
    v_mfma_f32_4x4x4_16b_bf16 v[16:19], v[48:49], a[194:195], v[16:19] cbsz:2 abid:0
    v_and_b32 v51, v41, v45
    v_mfma_f32_4x4x4_16b_bf16 v[20:23], v[48:49], a[196:197], v[20:23] cbsz:2 abid:1
    v_fma_f32 v42, v42, s7, -v10
    v_mfma_f32_4x4x4_16b_bf16 v[24:27], v[48:49], a[198:199], v[24:27] cbsz:2 abid:1
    v_exp_f32 v42, v42
    v_mfma_f32_4x4x4_16b_bf16 v[12:15], v[48:49], a[200:201], v[12:15] cbsz:2 abid:2
    v_add_f32 v11, v11, v42
    v_mfma_f32_4x4x4_16b_bf16 v[16:19], v[48:49], a[202:203], v[16:19] cbsz:2 abid:2
    v_cvt_pk_bf16_f32 v42, v42, v42
    v_mfma_f32_4x4x4_16b_bf16 v[20:23], v[48:49], a[204:205], v[20:23] cbsz:2 abid:3
    v_mfma_f32_4x4x4_16b_bf16 v[24:27], v[48:49], a[206:207], v[24:27] cbsz:2 abid:3
    buffer_load_dwordx4 v[104:107], v2, s[8:11], s63 offen offset:1024 nt
    v_mfma_f32_4x4x4_16b_bf16 v[12:15], v[50:51], a[208:209], v[12:15] cbsz:2 abid:0
    v_and_b32 v48, v42, v44
    v_mfma_f32_4x4x4_16b_bf16 v[16:19], v[50:51], a[210:211], v[16:19] cbsz:2 abid:0
    v_and_b32 v49, v42, v45
    v_mfma_f32_4x4x4_16b_bf16 v[20:23], v[50:51], a[212:213], v[20:23] cbsz:2 abid:1
    v_fma_f32 v43, v43, s7, -v10
    v_mfma_f32_4x4x4_16b_bf16 v[24:27], v[50:51], a[214:215], v[24:27] cbsz:2 abid:1
    v_exp_f32 v43, v43
    v_mfma_f32_4x4x4_16b_bf16 v[12:15], v[50:51], a[216:217], v[12:15] cbsz:2 abid:2
    v_add_f32 v11, v11, v43
    v_mfma_f32_4x4x4_16b_bf16 v[16:19], v[50:51], a[218:219], v[16:19] cbsz:2 abid:2
    v_cvt_pk_bf16_f32 v43, v43, v43
    v_mfma_f32_4x4x4_16b_bf16 v[20:23], v[50:51], a[220:221], v[20:23] cbsz:2 abid:3
    v_mfma_f32_4x4x4_16b_bf16 v[24:27], v[50:51], a[222:223], v[24:27] cbsz:2 abid:3
    s_add_u32 m0, s62, 11264
    s_nop 0
    buffer_load_dwordx4 v2, s[8:11], s63 offen offset:2048 nt lds
    s_mov_b32 s60, 158080
    s_mov_b32 s61, 162304
    v_mfma_f32_4x4x4_16b_bf16 v[12:15], v[48:49], a[224:225], v[12:15] cbsz:2 abid:0
    v_and_b32 v50, v43, v44
    v_mfma_f32_4x4x4_16b_bf16 v[16:19], v[48:49], a[226:227], v[16:19] cbsz:2 abid:0
    v_and_b32 v51, v43, v45
    v_mfma_f32_4x4x4_16b_bf16 v[20:23], v[48:49], a[228:229], v[20:23] cbsz:2 abid:1
    v_lshrrev_b32 v52, 5, v0
    v_mfma_f32_4x4x4_16b_bf16 v[24:27], v[48:49], a[230:231], v[24:27] cbsz:2 abid:1
    v_lshl_add_u32 v52, s3, 1, v52
    v_mfma_f32_4x4x4_16b_bf16 v[12:15], v[48:49], a[232:233], v[12:15] cbsz:2 abid:2
    v_mul_u32_u24 v52, 528, v52
    v_mfma_f32_4x4x4_16b_bf16 v[16:19], v[48:49], a[234:235], v[16:19] cbsz:2 abid:2
    v_and_b32 v5, 15, v0
    v_mfma_f32_4x4x4_16b_bf16 v[20:23], v[48:49], a[236:237], v[20:23] cbsz:2 abid:3
    v_lshl_add_u32 v52, v5, 5, v52
    v_mfma_f32_4x4x4_16b_bf16 v[24:27], v[48:49], a[238:239], v[24:27] cbsz:2 abid:3
    v_and_b32 v5, 16, v0
    buffer_load_dwordx4 v[108:111], v2, s[8:11], s63 offen offset:3072 nt
    v_mfma_f32_4x4x4_16b_bf16 v[12:15], v[50:51], a[240:241], v[12:15] cbsz:2 abid:0
    v_add3_u32 v52, v52, v5, s60
    v_mfma_f32_4x4x4_16b_bf16 v[16:19], v[50:51], a[242:243], v[16:19] cbsz:2 abid:0
    v_lshrrev_b32 v54, 3, v0
    v_mfma_f32_4x4x4_16b_bf16 v[20:23], v[50:51], a[244:245], v[20:23] cbsz:2 abid:1
    v_lshl_add_u32 v54, s3, 3, v54
    v_mfma_f32_4x4x4_16b_bf16 v[24:27], v[50:51], a[246:247], v[24:27] cbsz:2 abid:1
    v_lshlrev_b32 v54, 4, v54
    v_mfma_f32_4x4x4_16b_bf16 v[12:15], v[50:51], a[248:249], v[12:15] cbsz:2 abid:2
    v_and_b32 v5, 7, v0
    v_mfma_f32_4x4x4_16b_bf16 v[16:19], v[50:51], a[250:251], v[16:19] cbsz:2 abid:2
    v_mul_u32_u24 v55, 528, v5
    v_mfma_f32_4x4x4_16b_bf16 v[20:23], v[50:51], a[252:253], v[20:23] cbsz:2 abid:3
    v_add3_u32 v55, v55, v54, s60
    v_mfma_f32_4x4x4_16b_bf16 v[24:27], v[50:51], a[254:255], v[24:27] cbsz:2 abid:3
    v_and_b32 v5, 6, v0
    v_lshl_add_u32 v5, v5, 2, s61
    s_nop 1
    v_add_f32_dpp v11, v11, v11 row_ror:4 row_mask:0xf bank_mask:0xf
    s_nop 1
    v_add_f32_dpp v11, v11, v11 row_ror:8 row_mask:0xf bank_mask:0xf
    v_mov_b32 v28, v11
    s_nop 1
    v_permlane32_swap_b32 v11, v28
    v_add_f32 v11, v11, v28
    v_mov_b32 v28, v11
    s_nop 1
    v_permlane16_swap_b32 v11, v28
    v_add_f32 v11, v11, v28
    s_lshl_b32 s60, s3, 3
    s_add_u32 s60, s60, s61
    v_mov_b32 v28, s60
    v_add_f32 v12, v12, v20
    v_add_f32 v13, v13, v21
    v_add_f32 v14, v14, v22
    v_add_f32 v15, v15, v23
    v_add_f32 v16, v16, v24
    v_add_f32 v17, v17, v25
    v_add_f32 v18, v18, v26
    v_add_f32 v19, v19, v27
    v_permlane16_swap_b32 v12, v16
    v_permlane16_swap_b32 v13, v17
    v_permlane16_swap_b32 v14, v18
    v_permlane16_swap_b32 v15, v19
    v_add_f32 v12, v12, v16
    v_add_f32 v13, v13, v17
    v_add_f32 v14, v14, v18
    v_add_f32 v15, v15, v19
    ds_write_b128 v52, v[12:15]
    ds_write_b64 v28, v[10:11]
    s_mov_b32 vcc_lo, 0x1010101
    s_mov_b32 vcc_hi, 0x1010101
    v_bfrev_b32 v23, 1
    v_cndmask_b32 v54, v23, v54, vcc
    v_or_b32 v24, s3, v0
    v_cmp_eq_u32 vcc, 0, v24
    s_mul_i32 s64, s2, 640
    s_add_u32 s64, s64, 1179648
    v_cndmask_b32 v23, v23, v24, vcc
    s_waitcnt lgkmcnt(0)
    s_barrier
    ds_read_b64 v[16:17], v5
    ds_read_b128 v[12:15], v55
    s_waitcnt lgkmcnt(1)
    v_max_f32_dpp v10, v16, v16 quad_perm:[2,3,0,1] row_mask:0xf bank_mask:0xf
    s_nop 1
    v_max_f32_dpp v10, v10, v10 row_half_mirror row_mask:0xf bank_mask:0xf
    v_sub_f32 v16, v16, v10
    v_exp_f32 v16, v16
    s_waitcnt lgkmcnt(0)
    v_mul_f32 v11, v17, v16
    v_mul_f32 v12, v12, v16
    v_mul_f32 v13, v13, v16
    v_mul_f32 v14, v14, v16
    v_mul_f32 v15, v15, v16
    v_add_f32_dpp v12, v12, v12 quad_perm:[1,0,3,2] row_mask:0xf bank_mask:0xf
    v_add_f32_dpp v13, v13, v13 quad_perm:[1,0,3,2] row_mask:0xf bank_mask:0xf
    v_add_f32_dpp v14, v14, v14 quad_perm:[1,0,3,2] row_mask:0xf bank_mask:0xf
    v_add_f32_dpp v15, v15, v15 quad_perm:[1,0,3,2] row_mask:0xf bank_mask:0xf
    v_add_f32_dpp v11, v11, v11 quad_perm:[2,3,0,1] row_mask:0xf bank_mask:0xf
    v_add_f32_dpp v12, v12, v12 quad_perm:[2,3,0,1] row_mask:0xf bank_mask:0xf
    v_add_f32_dpp v13, v13, v13 quad_perm:[2,3,0,1] row_mask:0xf bank_mask:0xf
    v_add_f32_dpp v14, v14, v14 quad_perm:[2,3,0,1] row_mask:0xf bank_mask:0xf
    v_add_f32_dpp v15, v15, v15 quad_perm:[2,3,0,1] row_mask:0xf bank_mask:0xf
    v_add_f32_dpp v11, v11, v11 row_half_mirror row_mask:0xf bank_mask:0xf
    v_add_f32_dpp v12, v12, v12 row_half_mirror row_mask:0xf bank_mask:0xf
    v_add_f32_dpp v13, v13, v13 row_half_mirror row_mask:0xf bank_mask:0xf
    v_add_f32_dpp v14, v14, v14 row_half_mirror row_mask:0xf bank_mask:0xf
    v_add_f32_dpp v15, v15, v15 row_half_mirror row_mask:0xf bank_mask:0xf
    s_cmp_eq_u32 s97, 0
    s_cbranch_scc1 Y14
    buffer_store_dwordx4 v[12:15], v54, s[48:51], s64 offen
    buffer_store_dwordx2 v[10:11], v23, s[48:51], s64 offen offset:512
Y14d:
    s_waitcnt vmcnt(14)
    s_add_u32 s63, s101, 917504
    s_and_b32 s63, s63, 0x1fffff
    s_bitset1_b32 s63, 26
    buffer_load_dwordx4 v[112:115], v2, s[8:11], s63 offen offset:0 nt
    buffer_load_dwordx4 v[116:119], v2, s[8:11], s63 offen offset:1024 nt
    s_waitcnt vmcnt(14)
    buffer_load_dwordx4 v[120:123], v2, s[8:11], s63 offen offset:2048 nt
    buffer_load_dwordx4 v[124:127], v2, s[8:11], s63 offen offset:3072 nt
    s_waitcnt vmcnt(14)
    s_add_u32 s63, s101, 1048576
    s_and_b32 s63, s63, 0x1fffff
    s_bitset1_b32 s63, 26
    buffer_load_dwordx4 v[128:131], v2, s[8:11], s63 offen offset:0 nt
    buffer_load_dwordx4 v[132:135], v2, s[8:11], s63 offen offset:1024 nt
    s_waitcnt vmcnt(14)
    buffer_load_dwordx4 v[136:139], v2, s[8:11], s63 offen offset:2048 nt
    buffer_load_dwordx4 v[140:143], v2, s[8:11], s63 offen offset:3072 nt
    v_and_b32 v50, 1, v0
    v_lshlrev_b32 v54, 31, v50
    v_and_b32 v50, 2, v0
    v_lshl_add_u32 v54, v50, 5, v54
    v_and_b32 v50, 48, v0
    v_add_u32 v54, v54, v50
    s_mov_b32 vcc_lo, 0xf000f
    s_mov_b32 vcc_hi, 0xf000f
    v_bfrev_b32 v50, 1
    v_cndmask_b32 v54, v50, v54, vcc
    s_lshl_b32 s64, s5, 5
    s_add_u32 s64, s64, s4
    s_lshl_b32 s64, s64, 2
    s_add_u32 s64, s64, s3
    s_lshl_b32 s64, s64, 7
    s_add_u32 s64, s64, 1769472
    v_lshrrev_b32 v55, 2, v0
    v_mul_u32_u24 v55, 144, v55
    v_and_b32 v50, 24, v1
    v_add_u32 v55, v55, v50
    v_add_u32 v55, 117248, v55
    v_and_b32 v5, 1, v0
    v_mul_u32_u24 v5, 256, v5
    v_lshrrev_b32 v50, 4, v0
    v_lshl_add_u32 v5, v50, 3, v5
    v_add_u32 v5, 156928, v5
    v_and_b32 v47, 31, v0
    v_lshl_add_u32 v47, s3, 5, v47
    v_lshrrev_b32 v44, 5, v0
    v_lshlrev_b32 v45, 7, v44
    v_add_lshl_u32 v45, v45, v47, 1
    v_add_u32 v45, 156928, v45
    v_lshlrev_b32 v44, 31, v44
    v_lshl_add_u32 v47, v47, 2, v44
    v_and_b32 v46, 7, v0
    v_mul_u32_u24 v46, 640, v46
    v_add_u32 v46, v46, v44
    s_mov_b32 vcc_lo, 0xff00ff
    s_mov_b32 vcc_hi, 0xff00ff
    v_bfrev_b32 v44, 1
    v_cndmask_b32 v46, v44, v46, vcc
    s_mul_i32 s60, s4, 5120
    s_add_u32 s60, s60, 1179648
    s_add_u32 s61, s60, 2560
    buffer_load_dwordx2 v[18:19], v46, s[48:51], s60 offen offset:512 sc1
    buffer_load_dword v10, v47, s[48:51], s60 offen offset:0 sc1
    buffer_load_dword v11, v47, s[48:51], s60 offen offset:640 sc1
    buffer_load_dword v12, v47, s[48:51], s60 offen offset:1280 sc1
    buffer_load_dword v13, v47, s[48:51], s60 offen offset:1920 sc1
    buffer_load_dword v14, v47, s[48:51], s61 offen offset:0 sc1
    buffer_load_dword v15, v47, s[48:51], s61 offen offset:640 sc1
    buffer_load_dword v16, v47, s[48:51], s61 offen offset:1280 sc1
    buffer_load_dword v17, v47, s[48:51], s61 offen offset:1920 sc1
    s_waitcnt vmcnt(14)
    s_add_u32 s63, s101, 1179648
    s_and_b32 s63, s63, 0x1fffff
    s_bitset1_b32 s63, 26
    buffer_load_dwordx4 v[144:147], v2, s[8:11], s63 offen offset:0 nt
    buffer_load_dwordx4 v[148:151], v2, s[8:11], s63 offen offset:1024 nt
    s_waitcnt vmcnt(14)
    buffer_load_dwordx4 v[152:155], v2, s[8:11], s63 offen offset:2048 nt
    buffer_load_dwordx4 v[156:159], v2, s[8:11], s63 offen offset:3072 nt
    s_waitcnt vmcnt(14)
    s_add_u32 s63, s101, 1310720
    s_and_b32 s63, s63, 0x1fffff
    s_bitset1_b32 s63, 26
    buffer_load_dwordx4 v[160:163], v2, s[8:11], s63 offen offset:0 nt
    buffer_load_dwordx4 v[164:167], v2, s[8:11], s63 offen offset:1024 nt
    s_waitcnt vmcnt(14)
    buffer_load_dwordx4 v[168:171], v2, s[8:11], s63 offen offset:2048 nt
    buffer_load_dwordx4 v[172:175], v2, s[8:11], s63 offen offset:3072 nt
    s_waitcnt vmcnt(14)
    s_add_u32 s63, s101, 1441792
    s_and_b32 s63, s63, 0x1fffff
    s_bitset1_b32 s63, 26
    buffer_load_dwordx4 v[176:179], v2, s[8:11], s63 offen offset:0 nt
    buffer_load_dwordx4 v[180:183], v2, s[8:11], s63 offen offset:1024 nt
    s_waitcnt vmcnt(14)
    buffer_load_dwordx4 v[184:187], v2, s[8:11], s63 offen offset:2048 nt
    buffer_load_dwordx4 v[188:191], v2, s[8:11], s63 offen offset:3072 nt
    s_waitcnt vmcnt(14)
    s_add_u32 s63, s101, 1572864
    s_and_b32 s63, s63, 0x1fffff
    s_bitset1_b32 s63, 26
    buffer_load_dwordx4 v[192:195], v2, s[8:11], s63 offen offset:0 nt
    buffer_load_dwordx4 v[196:199], v2, s[8:11], s63 offen offset:1024 nt
    s_waitcnt vmcnt(14)
    v_max_u32 v44, v10, v11
    v_max3_u32 v44, v44, v12, v13
    v_max3_u32 v44, v44, v14, v15
    v_max3_u32 v44, v44, v16, v17
    v_max3_u32 v44, v44, v18, v19
    v_cmp_eq_u32 vcc, -1, v44
    s_cbranch_vccz P15d
P15:
    buffer_load_dwordx2 v[18:19], v46, s[48:51], s60 offen offset:512 sc1
    buffer_load_dword v10, v47, s[48:51], s60 offen offset:0 sc1
    buffer_load_dword v11, v47, s[48:51], s60 offen offset:640 sc1
    buffer_load_dword v12, v47, s[48:51], s60 offen offset:1280 sc1
    buffer_load_dword v13, v47, s[48:51], s60 offen offset:1920 sc1
    buffer_load_dword v14, v47, s[48:51], s61 offen offset:0 sc1
    buffer_load_dword v15, v47, s[48:51], s61 offen offset:640 sc1
    buffer_load_dword v16, v47, s[48:51], s61 offen offset:1280 sc1
    buffer_load_dword v17, v47, s[48:51], s61 offen offset:1920 sc1
    s_waitcnt vmcnt(0)
    s_sub_u32 s6, s6, 1
    s_cselect_b32 s6, 0, s6
    s_cbranch_scc1 P15x
    v_max_u32 v44, v10, v11
    v_max3_u32 v44, v44, v12, v13
    v_max3_u32 v44, v44, v14, v15
    v_max3_u32 v44, v44, v16, v17
    v_max3_u32 v44, v44, v18, v19
    v_cmp_eq_u32 vcc, -1, v44
    s_cbranch_vccnz P15
P15x:
P15d:
    v_max_f32_dpp v20, v18, v18 quad_perm:[1,0,3,2] row_mask:0xf bank_mask:0xf
    s_nop 1
    v_max_f32_dpp v20, v20, v20 quad_perm:[2,3,0,1] row_mask:0xf bank_mask:0xf
    s_nop 1
    v_max_f32_dpp v20, v20, v20 row_half_mirror row_mask:0xf bank_mask:0xf
    v_sub_f32 v18, v18, v20
    v_exp_f32 v18, v18
    s_nop 0
    v_mul_f32 v19, v19, v18
    s_nop 0
    v_mul_f32_dpp v44, v18, v10 row_newbcast:0 row_mask:0xf bank_mask:0xf
    v_add_f32_dpp v19, v19, v19 quad_perm:[1,0,3,2] row_mask:0xf bank_mask:0xf
    v_fmac_f32_dpp v44, v18, v11 row_newbcast:1 row_mask:0xf bank_mask:0xf
    v_fmac_f32_dpp v44, v18, v12 row_newbcast:2 row_mask:0xf bank_mask:0xf
    v_add_f32_dpp v19, v19, v19 quad_perm:[2,3,0,1] row_mask:0xf bank_mask:0xf
    v_fmac_f32_dpp v44, v18, v13 row_newbcast:3 row_mask:0xf bank_mask:0xf
    v_fmac_f32_dpp v44, v18, v14 row_newbcast:4 row_mask:0xf bank_mask:0xf
    v_add_f32_dpp v19, v19, v19 row_half_mirror row_mask:0xf bank_mask:0xf
    v_fmac_f32_dpp v44, v18, v15 row_newbcast:5 row_mask:0xf bank_mask:0xf
    v_fmac_f32_dpp v44, v18, v16 row_newbcast:6 row_mask:0xf bank_mask:0xf
    v_rcp_f32 v19, v19
    v_fmac_f32_dpp v44, v18, v17 row_newbcast:7 row_mask:0xf bank_mask:0xf
    s_nop 0
    v_mul_f32_dpp v44, v19, v44 row_newbcast:0 row_mask:0xf bank_mask:0xf
    v_cvt_pk_bf16_f32 v44, v44, v44
    ds_write_b16 v45, v44
    v_lshl_add_u32 v47, s3, 5, v55
    ds_read_b64_tr_b16 v[28:29], v47 offset:0
    ds_read_b64_tr_b16 v[30:31], v47 offset:2304
    ds_read_b64_tr_b16 v[32:33], v47 offset:4608
    ds_read_b64_tr_b16 v[34:35], v47 offset:6912
    ds_read_b64_tr_b16 v[36:37], v47 offset:9216
    ds_read_b64_tr_b16 v[38:39], v47 offset:11520
    ds_read_b64_tr_b16 v[40:41], v47 offset:13824
    ds_read_b64_tr_b16 v[42:43], v47 offset:16128
    s_waitcnt lgkmcnt(8)
    s_barrier
    ds_read2_b64 v[10:13], v5 offset0:0 offset1:4
    ds_read2_b64 v[14:17], v5 offset0:8 offset1:12
    ds_read2_b64 v[18:21], v5 offset0:16 offset1:20
    ds_read2_b64 v[22:25], v5 offset0:24 offset1:28
    s_waitcnt lgkmcnt(0)
    v_mfma_f32_16x16x32_bf16 v[46:49], v[28:31], v[10:13], 0
    ds_read_b64_tr_b16 v[28:29], v55 offset:128
    ds_read_b64_tr_b16 v[30:31], v55 offset:2432
    v_mfma_f32_16x16x32_bf16 v[46:49], v[32:35], v[14:17], v[46:49]
    ds_read_b64_tr_b16 v[32:33], v55 offset:4736
    ds_read_b64_tr_b16 v[34:35], v55 offset:7040
    v_mfma_f32_16x16x32_bf16 v[46:49], v[36:39], v[18:21], v[46:49]
    ds_read_b64_tr_b16 v[36:37], v55 offset:9344
    ds_read_b64_tr_b16 v[38:39], v55 offset:11648
    v_mfma_f32_16x16x32_bf16 v[46:49], v[40:43], v[22:25], v[46:49]
    ds_read_b64_tr_b16 v[40:41], v55 offset:13952
    ds_read_b64_tr_b16 v[42:43], v55 offset:16256
    s_waitcnt lgkmcnt(0)
    v_mfma_f32_16x16x32_bf16 v[50:53], v[28:31], v[10:13], 0
    v_mfma_f32_16x16x32_bf16 v[50:53], v[32:35], v[14:17], v[50:53]
    v_mfma_f32_16x16x32_bf16 v[50:53], v[36:39], v[18:21], v[50:53]
    v_mfma_f32_16x16x32_bf16 v[50:53], v[40:43], v[22:25], v[50:53]
    s_nop 5
    s_mov_b32 vcc_lo, 0xc000c
    s_mov_b32 vcc_hi, 0xc000c
    v_cndmask_b32 v46, v46, v50, vcc
    v_cndmask_b32 v47, v47, v51, vcc
    v_cndmask_b32 v48, v48, v52, vcc
    v_cndmask_b32 v49, v49, v53, vcc
    buffer_store_dwordx4 v[46:49], v54, s[48:51], s64 offen sc1
    s_waitcnt vmcnt(14)
    buffer_load_dwordx4 v[200:203], v2, s[8:11], s63 offen offset:2048 nt
    buffer_load_dwordx4 v[204:207], v2, s[8:11], s63 offen offset:3072 nt
    s_waitcnt vmcnt(14)
    s_add_u32 s63, s101, 1703936
    s_and_b32 s63, s63, 0x1fffff
    s_bitset1_b32 s63, 26
    buffer_load_dwordx4 v[208:211], v2, s[8:11], s63 offen offset:0 nt
    buffer_load_dwordx4 v[212:215], v2, s[8:11], s63 offen offset:1024 nt
    s_waitcnt vmcnt(14)
    buffer_load_dwordx4 v[216:219], v2, s[8:11], s63 offen offset:2048 nt
    buffer_load_dwordx4 v[220:223], v2, s[8:11], s63 offen offset:3072 nt
    s_waitcnt vmcnt(14)
    s_add_u32 s63, s101, 1835008
    s_and_b32 s63, s63, 0x1fffff
    s_bitset1_b32 s63, 26
    buffer_load_dwordx4 v[224:227], v2, s[8:11], s63 offen offset:0 nt
    buffer_load_dwordx4 v[228:231], v2, s[8:11], s63 offen offset:1024 nt
    s_waitcnt vmcnt(14)
    buffer_load_dwordx4 v[232:235], v2, s[8:11], s63 offen offset:2048 nt
    buffer_load_dwordx4 v[236:239], v2, s[8:11], s63 offen offset:3072 nt
    s_waitcnt vmcnt(14)
    s_add_u32 s63, s101, 1966080
    s_and_b32 s63, s63, 0x1fffff
    s_bitset1_b32 s63, 26
    buffer_load_dwordx4 v[240:243], v2, s[8:11], s63 offen offset:0 nt
    buffer_load_dwordx4 v[244:247], v2, s[8:11], s63 offen offset:1024 nt
    s_waitcnt vmcnt(14)
    buffer_load_dwordx4 v[248:251], v2, s[8:11], s63 offen offset:2048 nt
    buffer_load_dwordx4 v[252:255], v2, s[8:11], s63 offen offset:3072 nt
    v_and_b32 v48, 15, v0
    v_lshlrev_b32 v55, 1, v48
    s_mov_b32 s98, 0xa8888888
    v_lshrrev_b32_e64 v55, v55, s98
    v_and_b32 v55, 3, v55
    v_mul_u32_u24 v55, 160, v55
    v_lshrrev_b32 v49, 4, v0
    v_lshl_add_u32 v55, v49, 3, v55
    v_add_u32 v55, 156416, v55
    v_lshrrev_b32 v50, 1, v48
    v_and_b32 v52, 14, v48
    v_sub_u32 v48, v48, v52
    v_lshlrev_b32 v52, 31, v48
    v_lshl_add_u32 v52, v49, 4, v52
    v_lshl_add_u32 v52, v50, 6, v52
    s_mov_b32 s98, 6
    v_cmp_gt_u32 vcc, s98, v50
    v_or_b32 v48, 0x80000000, v52
    s_nop 0
    v_cndmask_b32 v52, v48, v52, vcc
    s_mul_i32 s64, s2, 1536
    s_mul_i32 s98, s3, 384
    s_add_u32 s64, s64, s98
    s_add_u32 s64, s64, 3735552
    v_lshrrev_b32 v54, 2, v0
    v_mul_u32_u24 v54, 288, v54
    v_and_b32 v48, 24, v1
    v_add_u32 v54, v54, v48
    s_lshr_b32 s98, s3, 1
    s_mul_i32 s98, s98, 20736
    s_and_b32 s99, s3, 1
    s_lshl_b32 s99, s99, 7
    s_add_u32 s98, s98, s99
    s_add_u32 s98, s98, 75776
    v_add_u32 v54, s98, v54
    v_and_b32 v47, 15, v0
    v_bfe_u32 v44, v0, 3, 1
    v_mad_u32_u24 v46, v44, s3, v47
    v_lshlrev_b32 v46, 3, v46
    v_lshl_add_u32 v47, s3, 3, v47
    s_mul_i32 s7, s3, 7
    s_sub_u32 s7, 24, s7
    v_mad_u32_u24 v47, v44, s7, v47
    v_lshrrev_b32 v45, 5, v0
    v_lshlrev_b32 v45, 1, v45
    v_lshl_add_u32 v45, v47, 2, v45
    v_lshrrev_b32 v44, 4, v0
    v_lshl_add_u32 v46, v44, 12, v46
    s_mov_b32 vcc_lo, 0x1ff01ff
    s_mov_b32 vcc_hi, 0x1ff01ff
    v_bfrev_b32 v44, 1
    v_cndmask_b32 v46, v44, v46, vcc
    s_lshl_b32 s60, s5, 7
    s_add_u32 s60, s60, s3
    s_lshl_b32 s60, s60, 7
    s_add_u32 s60, s60, 1769472
    v_add_u32 v45, 156416, v45
    buffer_load_dwordx2 v[10:11], v46, s[48:51], s60 offen offset:0 sc1
    buffer_load_dwordx2 v[12:13], v46, s[48:51], s60 offen offset:512 sc1
    buffer_load_dwordx2 v[14:15], v46, s[48:51], s60 offen offset:1024 sc1
    buffer_load_dwordx2 v[16:17], v46, s[48:51], s60 offen offset:1536 sc1
    buffer_load_dwordx2 v[18:19], v46, s[48:51], s60 offen offset:2048 sc1
    buffer_load_dwordx2 v[20:21], v46, s[48:51], s60 offen offset:2560 sc1
    buffer_load_dwordx2 v[22:23], v46, s[48:51], s60 offen offset:3072 sc1
    buffer_load_dwordx2 v[24:25], v46, s[48:51], s60 offen offset:3584 sc1
    s_waitcnt vmcnt(14)
    s_add_u32 s63, s101, 0
    s_and_b32 s63, s63, 0x1fffff
    s_bitset1_b32 s63, 26
    buffer_load_dwordx4 a[0:3], v3, s[12:15], s63 offen offset:0 nt
    buffer_load_dwordx4 a[4:7], v3, s[12:15], s63 offen offset:1024 nt
    s_waitcnt vmcnt(14)
    buffer_load_dwordx4 a[8:11], v3, s[12:15], s63 offen offset:2048 nt
    buffer_load_dwordx4 a[12:15], v3, s[12:15], s63 offen offset:3072 nt
    s_waitcnt vmcnt(14)
    s_add_u32 s63, s101, 131072
    s_and_b32 s63, s63, 0x1fffff
    s_bitset1_b32 s63, 26
    buffer_load_dwordx4 a[16:19], v3, s[12:15], s63 offen offset:0 nt
    buffer_load_dwordx4 a[20:23], v3, s[12:15], s63 offen offset:1024 nt
    s_waitcnt vmcnt(14)
    buffer_load_dwordx4 a[24:27], v3, s[12:15], s63 offen offset:2048 nt
    buffer_load_dwordx4 a[28:31], v3, s[12:15], s63 offen offset:3072 nt
    s_waitcnt vmcnt(14)
    s_add_u32 s63, s101, 262144
    s_and_b32 s63, s63, 0x1fffff
    s_bitset1_b32 s63, 26
    buffer_load_dwordx4 a[32:35], v3, s[12:15], s63 offen offset:0 nt
    buffer_load_dwordx4 a[36:39], v3, s[12:15], s63 offen offset:1024 nt
    s_waitcnt vmcnt(14)
    buffer_load_dwordx4 a[40:43], v3, s[12:15], s63 offen offset:2048 nt
    buffer_load_dwordx4 a[44:47], v3, s[12:15], s63 offen offset:3072 nt
    s_waitcnt vmcnt(14)
    s_add_u32 s63, s101, 393216
    s_and_b32 s63, s63, 0x1fffff
    s_bitset1_b32 s63, 26
    buffer_load_dwordx4 a[48:51], v3, s[12:15], s63 offen offset:0 nt
    buffer_load_dwordx4 a[52:55], v3, s[12:15], s63 offen offset:1024 nt
    s_waitcnt vmcnt(14)
    v_max_u32 v44, v10, v11
    v_max3_u32 v44, v44, v12, v13
    v_max3_u32 v44, v44, v14, v15
    v_max3_u32 v44, v44, v16, v17
    v_max3_u32 v44, v44, v18, v19
    v_max3_u32 v44, v44, v20, v21
    v_max3_u32 v44, v44, v22, v23
    v_max3_u32 v44, v44, v24, v25
    v_cmp_eq_u32 vcc, -1, v44
    s_cbranch_vccz P16d
P16:
    buffer_load_dwordx2 v[10:11], v46, s[48:51], s60 offen offset:0 sc1
    buffer_load_dwordx2 v[12:13], v46, s[48:51], s60 offen offset:512 sc1
    buffer_load_dwordx2 v[14:15], v46, s[48:51], s60 offen offset:1024 sc1
    buffer_load_dwordx2 v[16:17], v46, s[48:51], s60 offen offset:1536 sc1
    buffer_load_dwordx2 v[18:19], v46, s[48:51], s60 offen offset:2048 sc1
    buffer_load_dwordx2 v[20:21], v46, s[48:51], s60 offen offset:2560 sc1
    buffer_load_dwordx2 v[22:23], v46, s[48:51], s60 offen offset:3072 sc1
    buffer_load_dwordx2 v[24:25], v46, s[48:51], s60 offen offset:3584 sc1
    s_waitcnt vmcnt(0)
    s_sub_u32 s6, s6, 1
    s_cselect_b32 s6, 0, s6
    s_cbranch_scc1 P16x
    v_max_u32 v44, v10, v11
    v_max3_u32 v44, v44, v12, v13
    v_max3_u32 v44, v44, v14, v15
    v_max3_u32 v44, v44, v16, v17
    v_max3_u32 v44, v44, v18, v19
    v_max3_u32 v44, v44, v20, v21
    v_max3_u32 v44, v44, v22, v23
    v_max3_u32 v44, v44, v24, v25
    v_cmp_eq_u32 vcc, -1, v44
    s_cbranch_vccnz P16
P16x:
P16d:
    v_add_f32 v10, v10, v12
    v_add_f32 v11, v11, v13
    v_add_f32 v14, v14, v16
    v_add_f32 v15, v15, v17
    v_add_f32 v18, v18, v20
    v_add_f32 v19, v19, v21
    v_add_f32 v22, v22, v24
    v_add_f32 v23, v23, v25
    v_add_f32 v10, v10, v14
    v_add_f32 v11, v11, v15
    v_add_f32 v18, v18, v22
    v_add_f32 v19, v19, v23
    v_add_f32 v10, v10, v18
    v_add_f32 v11, v11, v19
    v_and_b32 v47, 0xffff0000, v4
    s_nop 0
    v_permlane32_swap_b32 v10, v11
    v_add_f32 v26, v10, v11
    v_add_f32 v27, v10, v11
    s_nop 1
    v_permlane16_swap_b32 v26, v27
    s_mov_b32 exec_lo, 0x1ff
    s_mov_b32 exec_hi, 0x1ff
    v_add_f32 v26, v26, v27
    v_add_f32 v26, v26, v47
    v_cvt_pk_bf16_f32 v4, v26, v26
    ds_write_b16 v45, v4
    s_mov_b64 exec, -1
    ds_read_b64_tr_b16 v[20:21], v54 offset:0
    ds_read_b64_tr_b16 v[22:23], v54 offset:4608
    ds_read_b64_tr_b16 v[24:25], v54 offset:9216
    ds_read_b64_tr_b16 v[26:27], v54 offset:13824
    ds_read_b64_tr_b16 v[28:29], v54 offset:18432
    ds_read_b64_tr_b16 v[30:31], v54 offset:32
    ds_read_b64_tr_b16 v[32:33], v54 offset:4640
    ds_read_b64_tr_b16 v[34:35], v54 offset:9248
    ds_read_b64_tr_b16 v[36:37], v54 offset:13856
    ds_read_b64_tr_b16 v[38:39], v54 offset:18464
    s_waitcnt lgkmcnt(10)
    s_barrier
    ds_read2_b64 v[10:13], v55 offset0:0 offset1:4
    ds_read2_b64 v[14:17], v55 offset0:8 offset1:12
    ds_read_b64 v[18:19], v55 offset:128
    s_waitcnt lgkmcnt(0)
    v_mfma_f32_16x16x32_bf16 v[40:43], v[10:13], v[10:13], 0
    v_mfma_f32_16x16x32_bf16 v[44:47], v[20:23], v[10:13], 0
    v_mfma_f32_16x16x32_bf16 v[48:51], v[30:33], v[10:13], 0
    v_mfma_f32_16x16x32_bf16 v[40:43], v[14:17], v[14:17], v[40:43]
    v_mfma_f32_16x16x32_bf16 v[44:47], v[24:27], v[14:17], v[44:47]
    v_mfma_f32_16x16x32_bf16 v[48:51], v[34:37], v[14:17], v[48:51]
    s_nop 4
    v_mfma_f32_16x16x16_bf16 v[40:43], v[18:19], v[18:19], v[40:43]
    v_mfma_f32_16x16x16_bf16 v[44:47], v[28:29], v[18:19], v[44:47]
    v_mfma_f32_16x16x16_bf16 v[48:51], v[38:39], v[18:19], v[48:51]
    ds_read_b64_tr_b16 v[20:21], v54 offset:64
    ds_read_b64_tr_b16 v[22:23], v54 offset:4672
    ds_read_b64_tr_b16 v[24:25], v54 offset:9280
    ds_read_b64_tr_b16 v[26:27], v54 offset:13888
    ds_read_b64_tr_b16 v[28:29], v54 offset:18496
    ds_read_b64_tr_b16 v[30:31], v54 offset:96
    ds_read_b64_tr_b16 v[32:33], v54 offset:4704
    ds_read_b64_tr_b16 v[34:35], v54 offset:9312
    ds_read_b64_tr_b16 v[36:37], v54 offset:13920
    ds_read_b64_tr_b16 v[38:39], v54 offset:18528
    s_mov_b32 vcc_lo, 0x30003
    s_mov_b32 vcc_hi, 0x30003
    v_cndmask_b32 v40, v40, v44, vcc
    v_cndmask_b32 v41, v41, v45, vcc
    v_cndmask_b32 v42, v42, v46, vcc
    v_cndmask_b32 v43, v43, v47, vcc
    s_mov_b32 vcc_lo, 0xc000c
    s_mov_b32 vcc_hi, 0xc000c
    v_cndmask_b32 v40, v40, v48, vcc
    v_cndmask_b32 v41, v41, v49, vcc
    v_cndmask_b32 v42, v42, v50, vcc
    v_cndmask_b32 v43, v43, v51, vcc
    s_waitcnt lgkmcnt(0)
    v_mfma_f32_16x16x32_bf16 v[44:47], v[20:23], v[10:13], 0
    v_mfma_f32_16x16x32_bf16 v[48:51], v[30:33], v[10:13], 0
    v_mfma_f32_16x16x32_bf16 v[44:47], v[24:27], v[14:17], v[44:47]
    v_mfma_f32_16x16x32_bf16 v[48:51], v[34:37], v[14:17], v[48:51]
    s_nop 5
    v_mfma_f32_16x16x16_bf16 v[44:47], v[28:29], v[18:19], v[44:47]
    v_mfma_f32_16x16x16_bf16 v[48:51], v[38:39], v[18:19], v[48:51]
    ds_read_b64_tr_b16 v[20:21], v54 offset:128
    ds_read_b64_tr_b16 v[22:23], v54 offset:4736
    ds_read_b64_tr_b16 v[24:25], v54 offset:9344
    ds_read_b64_tr_b16 v[26:27], v54 offset:13952
    ds_read_b64_tr_b16 v[28:29], v54 offset:18560
    s_nop 0
    s_mov_b32 vcc_lo, 0x300030
    s_mov_b32 vcc_hi, 0x300030
    v_cndmask_b32 v40, v40, v44, vcc
    v_cndmask_b32 v41, v41, v45, vcc
    v_cndmask_b32 v42, v42, v46, vcc
    v_cndmask_b32 v43, v43, v47, vcc
    s_mov_b32 vcc_lo, 0xc000c0
    s_mov_b32 vcc_hi, 0xc000c0
    v_cndmask_b32 v40, v40, v48, vcc
    v_cndmask_b32 v41, v41, v49, vcc
    v_cndmask_b32 v42, v42, v50, vcc
    v_cndmask_b32 v43, v43, v51, vcc
    s_waitcnt lgkmcnt(0)
    v_mfma_f32_16x16x32_bf16 v[44:47], v[20:23], v[10:13], 0
    v_mfma_f32_16x16x32_bf16 v[44:47], v[24:27], v[14:17], v[44:47]
    s_nop 6
    v_mfma_f32_16x16x16_bf16 v[44:47], v[28:29], v[18:19], v[44:47]
    s_nop 5
    s_mov_b32 vcc_lo, 0x3000300
    s_mov_b32 vcc_hi, 0x3000300
    v_cndmask_b32 v40, v40, v44, vcc
    v_cndmask_b32 v41, v41, v45, vcc
    v_cndmask_b32 v42, v42, v46, vcc
    v_cndmask_b32 v43, v43, v47, vcc
    s_cmp_eq_u32 s97, 0
    s_cbranch_scc1 Y17
    buffer_store_dwordx4 v[40:43], v52, s[48:51], s64 offen
Y17d:
    s_waitcnt vmcnt(14)
    buffer_load_dwordx4 a[56:59], v3, s[12:15], s63 offen offset:2048 nt
    buffer_load_dwordx4 a[60:63], v3, s[12:15], s63 offen offset:3072 nt
    s_waitcnt vmcnt(14)
    s_add_u32 s63, s101, 524288
    s_and_b32 s63, s63, 0x1fffff
    s_bitset1_b32 s63, 26
    buffer_load_dwordx4 a[64:67], v3, s[12:15], s63 offen offset:0 nt
    buffer_load_dwordx4 a[68:71], v3, s[12:15], s63 offen offset:1024 nt
    s_waitcnt vmcnt(14)
    buffer_load_dwordx4 a[72:75], v3, s[12:15], s63 offen offset:2048 nt
    buffer_load_dwordx4 a[76:79], v3, s[12:15], s63 offen offset:3072 nt
    s_waitcnt vmcnt(14)
    s_add_u32 s63, s101, 655360
    s_and_b32 s63, s63, 0x1fffff
    s_bitset1_b32 s63, 26
    buffer_load_dwordx4 a[80:83], v3, s[12:15], s63 offen offset:0 nt
    buffer_load_dwordx4 a[84:87], v3, s[12:15], s63 offen offset:1024 nt
    s_waitcnt vmcnt(14)
    buffer_load_dwordx4 a[88:91], v3, s[12:15], s63 offen offset:2048 nt
    buffer_load_dwordx4 a[92:95], v3, s[12:15], s63 offen offset:3072 nt
    s_waitcnt vmcnt(14)
    s_add_u32 s63, s101, 786432
    s_and_b32 s63, s63, 0x1fffff
    s_bitset1_b32 s63, 26
    buffer_load_dwordx4 a[96:99], v3, s[12:15], s63 offen offset:0 nt
    buffer_load_dwordx4 a[100:103], v3, s[12:15], s63 offen offset:1024 nt
    v_and_b32 v50, 1, v0
    v_lshlrev_b32 v54, 31, v50
    v_and_b32 v50, 2, v0
    v_lshl_add_u32 v54, v50, 5, v54
    v_and_b32 v50, 48, v0
    v_add_u32 v54, v54, v50
    s_mov_b32 vcc_lo, 0xf000f
    s_mov_b32 vcc_hi, 0xf000f
    v_bfrev_b32 v50, 1
    v_cndmask_b32 v54, v50, v54, vcc
    s_lshl_b32 s64, s5, 5
    s_add_u32 s64, s64, s4
    s_lshl_b32 s64, s64, 2
    s_add_u32 s64, s64, s3
    s_lshl_b32 s64, s64, 7
    s_add_u32 s64, s64, 2293760
    v_lshrrev_b32 v55, 2, v0
    v_mul_u32_u24 v55, 144, v55
    v_and_b32 v50, 24, v1
    v_add_u32 v55, v55, v50
    v_add_u32 v55, 135680, v55
    v_and_b32 v5, 1, v0
    v_mul_u32_u24 v5, 288, v5
    v_lshrrev_b32 v50, 4, v0
    v_lshl_add_u32 v5, v50, 3, v5
    v_add_u32 v5, 157440, v5
    v_and_b32 v51, 15, v0
    s_mul_i32 s7, s3, 9
    v_add_u32 v51, s7, v51
    v_cmp_lt_u32 vcc, 19, v51
    v_lshrrev_b32 v53, 4, v0
    v_mul_u32_u24 v52, 768, v53
    v_lshl_add_u32 v52, v51, 4, v52
    v_add_u32 v50, 128, v52
    v_cndmask_b32 v52, v52, v50, vcc
    s_mov_b32 vcc_lo, 0x1ff01ff
    s_mov_b32 vcc_hi, 0x1ff01ff
    v_bfrev_b32 v50, 1
    v_cndmask_b32 v52, v50, v52, vcc
    v_bfrev_b32 v53, v53
    v_lshrrev_b32 v53, 29, v53
    v_lshl_add_u32 v51, v51, 3, v53
    v_add_u32 v51, 157440, v51
    v_mul_u32_u24 v53, 1536, v0
    v_cmp_gt_u32 vcc, 8, v0
    v_or_b32 v50, 0x80000000, v53
    s_nop 0
    v_cndmask_b32 v53, v50, v53, vcc
    s_mul_i32 s7, s4, 12288
    s_add_u32 s60, s7, 3735552
    s_add_u32 s61, s7, 3741696
    buffer_load_dwordx4 v[46:49], v53, s[48:51], s60 offen offset:368 sc1
    buffer_load_dwordx4 v[10:13], v52, s[48:51], s60 offen offset:0 sc1
    buffer_load_dwordx4 v[14:17], v52, s[48:51], s60 offen offset:3072 sc1
    buffer_load_dwordx4 v[18:21], v52, s[48:51], s61 offen offset:0 sc1
    buffer_load_dwordx4 v[22:25], v52, s[48:51], s61 offen offset:3072 sc1
    s_waitcnt vmcnt(14)
    buffer_load_dwordx4 a[104:107], v3, s[12:15], s63 offen offset:2048 nt
    buffer_load_dwordx4 a[108:111], v3, s[12:15], s63 offen offset:3072 nt
    s_waitcnt vmcnt(14)
    s_add_u32 s63, s101, 917504
    s_and_b32 s63, s63, 0x1fffff
    s_bitset1_b32 s63, 26
    buffer_load_dwordx4 a[112:115], v3, s[12:15], s63 offen offset:0 nt
    buffer_load_dwordx4 a[116:119], v3, s[12:15], s63 offen offset:1024 nt
    s_waitcnt vmcnt(14)
    buffer_load_dwordx4 a[120:123], v3, s[12:15], s63 offen offset:2048 nt
    buffer_load_dwordx4 a[124:127], v3, s[12:15], s63 offen offset:3072 nt
    s_waitcnt vmcnt(14)
    s_add_u32 s63, s101, 1048576
    s_and_b32 s63, s63, 0x1fffff
    s_bitset1_b32 s63, 26
    buffer_load_dwordx4 a[128:131], v3, s[12:15], s63 offen offset:0 nt
    buffer_load_dwordx4 a[132:135], v3, s[12:15], s63 offen offset:1024 nt
    s_waitcnt vmcnt(14)
    buffer_load_dwordx4 a[136:139], v3, s[12:15], s63 offen offset:2048 nt
    buffer_load_dwordx4 a[140:143], v3, s[12:15], s63 offen offset:3072 nt
    s_waitcnt vmcnt(14)
    s_add_u32 s63, s101, 1179648
    s_and_b32 s63, s63, 0x1fffff
    s_bitset1_b32 s63, 26
    buffer_load_dwordx4 a[144:147], v3, s[12:15], s63 offen offset:0 nt
    buffer_load_dwordx4 a[148:151], v3, s[12:15], s63 offen offset:1024 nt
    s_waitcnt vmcnt(14)
    buffer_load_dwordx4 a[152:155], v3, s[12:15], s63 offen offset:2048 nt
    buffer_load_dwordx4 a[156:159], v3, s[12:15], s63 offen offset:3072 nt
    s_waitcnt vmcnt(14)
    v_max_u32 v50, v46, v48
    v_max3_u32 v50, v50, v10, v11
    v_max3_u32 v50, v50, v12, v13
    v_max3_u32 v50, v50, v14, v15
    v_max3_u32 v50, v50, v16, v17
    v_max3_u32 v50, v50, v18, v19
    v_max3_u32 v50, v50, v20, v21
    v_max3_u32 v50, v50, v22, v23
    v_max3_u32 v50, v50, v24, v25
    v_cmp_eq_u32 vcc, -1, v50
    s_cbranch_vccz P18d
P18:
    buffer_load_dwordx4 v[46:49], v53, s[48:51], s60 offen offset:368 sc1
    buffer_load_dwordx4 v[10:13], v52, s[48:51], s60 offen offset:0 sc1
    buffer_load_dwordx4 v[14:17], v52, s[48:51], s60 offen offset:3072 sc1
    buffer_load_dwordx4 v[18:21], v52, s[48:51], s61 offen offset:0 sc1
    buffer_load_dwordx4 v[22:25], v52, s[48:51], s61 offen offset:3072 sc1
    s_waitcnt vmcnt(0)
    s_sub_u32 s6, s6, 1
    s_cselect_b32 s6, 0, s6
    s_cbranch_scc1 P18x
    v_max_u32 v50, v46, v48
    v_max3_u32 v50, v50, v10, v11
    v_max3_u32 v50, v50, v12, v13
    v_max3_u32 v50, v50, v14, v15
    v_max3_u32 v50, v50, v16, v17
    v_max3_u32 v50, v50, v18, v19
    v_max3_u32 v50, v50, v20, v21
    v_max3_u32 v50, v50, v22, v23
    v_max3_u32 v50, v50, v24, v25
    v_cmp_eq_u32 vcc, -1, v50
    s_cbranch_vccnz P18
P18x:
P18d:
    v_add_f32 v10, v10, v14
    v_add_f32 v11, v11, v15
    v_add_f32_dpp v46, v46, v46 quad_perm:[1,0,3,2] row_mask:0xf bank_mask:0xf
    v_add_f32 v12, v12, v16
    v_add_f32_dpp v48, v48, v48 quad_perm:[1,0,3,2] row_mask:0xf bank_mask:0xf
    v_add_f32 v13, v13, v17
    v_add_f32_dpp v46, v46, v46 quad_perm:[2,3,0,1] row_mask:0xf bank_mask:0xf
    v_add_f32 v18, v18, v22
    v_add_f32_dpp v48, v48, v48 quad_perm:[2,3,0,1] row_mask:0xf bank_mask:0xf
    v_add_f32 v19, v19, v23
    v_add_f32_dpp v46, v46, v46 row_half_mirror row_mask:0xf bank_mask:0xf
    v_add_f32 v20, v20, v24
    v_add_f32_dpp v48, v48, v48 row_half_mirror row_mask:0xf bank_mask:0xf
    v_add_f32 v21, v21, v25
    v_mul_f32 v48, 0x3ae38e39, v48
    v_add_f32 v10, v10, v18
    v_mul_f32 v46, 0x3ae38e39, v46
    v_add_f32 v11, v11, v19
    v_fma_f32 v46, -v48, v48, v46
    v_add_f32 v12, v12, v20
    v_max_f32 v46, 0, v46
    v_add_f32 v13, v13, v21
    v_add_f32 v46, 0x3727c5ac, v46
    v_permlane32_swap_b32 v10, v11
    v_rsq_f32 v46, v46
    v_permlane32_swap_b32 v12, v13
    v_readfirstlane_b32 s0, v48
    v_add_f32 v10, v10, v11
    v_readfirstlane_b32 s1, v46
    v_add_f32 v11, v12, v13
    s_nop 1
    v_permlane16_swap_b32 v10, v11
    v_fma_f32 v10, -s0, v6, v10
    v_mul_f32 v10, s1, v10
    v_fma_f32 v11, -s0, v7, v11
    v_mul_f32 v11, s1, v11
    v_mul_f32 v12, v10, v10
    v_mov_b32 v13, 0xc0135761
    v_fmac_f32 v13, 0xbdd2d3e8, v12
    v_mul_f32 v13, v13, v10
    v_exp_f32 v13, v13
    v_mul_f32 v10, v10, v11
    v_add_f32 v13, 1.0, v13
    v_rcp_f32 v13, v13
    s_nop 0
    v_mul_f32 v50, v10, v13
    v_cvt_pk_bf16_f32 v50, v50, v50
    s_mov_b32 exec_lo, 0x1ff01ff
    s_mov_b32 exec_hi, 0x1ff01ff
    ds_write_b16 v51, v50
    s_mov_b64 exec, -1
    v_lshl_add_u32 v47, s3, 5, v55
    ds_read_b64_tr_b16 v[28:29], v47 offset:0
    ds_read_b64_tr_b16 v[30:31], v47 offset:2304
    ds_read_b64_tr_b16 v[32:33], v47 offset:4608
    ds_read_b64_tr_b16 v[34:35], v47 offset:6912
    ds_read_b64_tr_b16 v[36:37], v47 offset:9216
    ds_read_b64_tr_b16 v[38:39], v47 offset:11520
    ds_read_b64_tr_b16 v[40:41], v47 offset:13824
    ds_read_b64_tr_b16 v[42:43], v47 offset:16128
    ds_read_b64_tr_b16 v[44:45], v47 offset:18432
    s_waitcnt lgkmcnt(9)
    s_barrier
    ds_read2_b64 v[10:13], v5 offset0:0 offset1:4
    ds_read2_b64 v[14:17], v5 offset0:8 offset1:12
    ds_read2_b64 v[18:21], v5 offset0:16 offset1:20
    ds_read2_b64 v[22:25], v5 offset0:24 offset1:28
    ds_read_b64 v[26:27], v5 offset:256
    s_waitcnt lgkmcnt(0)
    v_mfma_f32_16x16x32_bf16 v[46:49], v[28:31], v[10:13], 0
    ds_read_b64_tr_b16 v[28:29], v55 offset:128
    ds_read_b64_tr_b16 v[30:31], v55 offset:2432
    v_mfma_f32_16x16x32_bf16 v[46:49], v[32:35], v[14:17], v[46:49]
    ds_read_b64_tr_b16 v[32:33], v55 offset:4736
    ds_read_b64_tr_b16 v[34:35], v55 offset:7040
    v_mfma_f32_16x16x32_bf16 v[46:49], v[36:39], v[18:21], v[46:49]
    ds_read_b64_tr_b16 v[36:37], v55 offset:9344
    ds_read_b64_tr_b16 v[38:39], v55 offset:11648
    v_mfma_f32_16x16x32_bf16 v[46:49], v[40:43], v[22:25], v[46:49]
    ds_read_b64_tr_b16 v[40:41], v55 offset:13952
    ds_read_b64_tr_b16 v[42:43], v55 offset:16256
    s_nop 6
    v_mfma_f32_16x16x16_bf16 v[46:49], v[44:45], v[26:27], v[46:49]
    ds_read_b64_tr_b16 v[44:45], v55 offset:18560
    s_waitcnt lgkmcnt(0)
    v_mfma_f32_16x16x32_bf16 v[50:53], v[28:31], v[10:13], 0
    v_mfma_f32_16x16x32_bf16 v[50:53], v[32:35], v[14:17], v[50:53]
    v_mfma_f32_16x16x32_bf16 v[50:53], v[36:39], v[18:21], v[50:53]
    v_mfma_f32_16x16x32_bf16 v[50:53], v[40:43], v[22:25], v[50:53]
    s_nop 6
    v_mfma_f32_16x16x16_bf16 v[50:53], v[44:45], v[26:27], v[50:53]
    s_nop 5
    s_mov_b32 vcc_lo, 0xc000c
    s_mov_b32 vcc_hi, 0xc000c
    v_cndmask_b32 v46, v46, v50, vcc
    v_cndmask_b32 v47, v47, v51, vcc
    v_cndmask_b32 v48, v48, v52, vcc
    v_cndmask_b32 v49, v49, v53, vcc
    buffer_store_dwordx4 v[46:49], v54, s[48:51], s64 offen sc1
    s_waitcnt vmcnt(14)
    s_add_u32 s63, s101, 1310720
    s_and_b32 s63, s63, 0x1fffff
    s_bitset1_b32 s63, 26
    buffer_load_dwordx4 a[160:163], v3, s[12:15], s63 offen offset:0 nt
    buffer_load_dwordx4 a[164:167], v3, s[12:15], s63 offen offset:1024 nt
    s_waitcnt vmcnt(14)
    buffer_load_dwordx4 a[168:171], v3, s[12:15], s63 offen offset:2048 nt
    buffer_load_dwordx4 a[172:175], v3, s[12:15], s63 offen offset:3072 nt
    s_getpc_b64 s[98:99]
C19:
    s_add_u32 s98, s98, L_b-C19
    s_addc_u32 s99, s99, 0
    v_lshl_add_u32 v48, s3, 6, v0
    v_lshlrev_b32 v48, 6, v48
    v_min_u32 v50, L_end-L_b, v48
    v_mov_b32 v51, s99
    v_add_co_u32 v50, vcc, s98, v50
    s_nop 1
    v_addc_co_u32 v51, vcc, 0, v51, vcc
    global_load_dword v5, v[50:51], off
    v_add_u32 v48, 0x4000, v48
    v_min_u32 v50, L_end-L_b, v48
    v_mov_b32 v51, s99
    v_add_co_u32 v50, vcc, s98, v50
    s_nop 1
    v_addc_co_u32 v51, vcc, 0, v51, vcc
    global_load_dword v5, v[50:51], off
    v_add_u32 v48, 0x4000, v48
L_b:
    s_waitcnt vmcnt(61)
    v_lshrrev_b32 v10, 4, v0
    v_and_b32 v9, 3, v0
    v_lshl_add_u32 v10, v10, 2, v9
    v_lshlrev_b32 v10, 4, v10
    v_add_u32 v10, 162688, v10
    v_lshl_add_u32 v9, v1, 1, s62
    ds_read_b128 v[28:31], v9 offset:0
    ds_read_b128 v[52:55], v9 offset:1024
    ds_read_b128 v[32:35], v9 offset:2048
    ds_read_b128 v[40:43], v9 offset:3072
    ds_read_b128 v[36:39], v9 offset:4096
    ds_read_b128 v[48:51], v10
    s_waitcnt lgkmcnt(0)
    v_cndmask_b32 v12, 0, v48, s[52:53]
    v_cndmask_b32 v13, 0, v49, s[52:53]
    v_cndmask_b32 v14, 0, v50, s[52:53]
    v_cndmask_b32 v15, 0, v51, s[52:53]
    v_cndmask_b32 v16, 0, v48, s[54:55]
    v_cndmask_b32 v17, 0, v49, s[54:55]
    v_cndmask_b32 v18, 0, v50, s[54:55]
    v_cndmask_b32 v19, 0, v51, s[54:55]
    s_waitcnt lgkmcnt(2)
    v_mfma_f32_16x16x32_bf16 v[44:47], v[28:31], v[12:15], 0
    v_cndmask_b32 v20, 0, v48, s[56:57]
    v_cndmask_b32 v21, 0, v49, s[56:57]
    v_cndmask_b32 v22, 0, v50, s[56:57]
    v_cndmask_b32 v23, 0, v51, s[56:57]
    v_mfma_f32_16x16x32_bf16 v[44:47], v[56:59], v[16:19], v[44:47]
    v_cndmask_b32 v24, 0, v48, s[58:59]
    v_cndmask_b32 v25, 0, v49, s[58:59]
    v_cndmask_b32 v26, 0, v50, s[58:59]
    v_cndmask_b32 v27, 0, v51, s[58:59]
    s_waitcnt lgkmcnt(2)
    v_mfma_f32_16x16x32_bf16 v[44:47], v[52:55], v[20:23], v[44:47]
    s_nop 0
    v_mfma_f32_16x16x32_bf16 v[44:47], v[60:63], v[24:27], v[44:47]
    s_waitcnt lgkmcnt(2)
    v_mfma_f32_16x16x32_bf16 v[48:51], v[32:35], v[12:15], 0
    ds_read_b128 v[32:35], v9 offset:5120
    v_mfma_f32_16x16x32_bf16 v[48:51], v[64:67], v[16:19], v[48:51]
    s_waitcnt lgkmcnt(2)
    v_mfma_f32_16x16x32_bf16 v[48:51], v[40:43], v[20:23], v[48:51]
    ds_read_b128 v[40:43], v9 offset:6144
    v_mfma_f32_16x16x32_bf16 v[48:51], v[68:71], v[24:27], v[48:51]
    s_add_u32 s63, s101, 1441792
    s_and_b32 s63, s63, 0x1fffff
    s_bitset1_b32 s63, 26
    buffer_load_dwordx4 a[176:179], v3, s[12:15], s63 offen offset:0 nt
    s_waitcnt lgkmcnt(2)
    v_mfma_f32_16x16x32_bf16 v[52:55], v[36:39], v[12:15], 0
    ds_read_b128 v[36:39], v9 offset:7168
    v_mov_b32_dpp v28, v44 quad_perm:[0,0,0,0] row_mask:0xf bank_mask:0xf
    v_mfma_f32_16x16x32_bf16 v[52:55], v[72:75], v[16:19], v[52:55]
    v_add_f32_dpp v28, v45, v28 quad_perm:[1,1,1,1] row_mask:0xf bank_mask:0xf
    s_waitcnt lgkmcnt(2)
    v_mfma_f32_16x16x32_bf16 v[52:55], v[32:35], v[20:23], v[52:55]
    ds_read_b128 v[32:35], v9 offset:8192
    v_add_f32_dpp v28, v46, v28 quad_perm:[2,2,2,2] row_mask:0xf bank_mask:0xf
    v_mfma_f32_16x16x32_bf16 v[52:55], v[76:79], v[24:27], v[52:55]
    v_add_f32_dpp v28, v47, v28 quad_perm:[3,3,3,3] row_mask:0xf bank_mask:0xf
    v_max_f32 v10, v28, v28
    s_waitcnt lgkmcnt(2)
    v_mfma_f32_16x16x32_bf16 v[44:47], v[40:43], v[12:15], 0
    ds_read_b128 v[40:43], v9 offset:9216
    v_mov_b32_dpp v29, v48 quad_perm:[0,0,0,0] row_mask:0xf bank_mask:0xf
    v_mfma_f32_16x16x32_bf16 v[44:47], v[80:83], v[16:19], v[44:47]
    v_add_f32_dpp v29, v49, v29 quad_perm:[1,1,1,1] row_mask:0xf bank_mask:0xf
    s_waitcnt lgkmcnt(2)
    v_mfma_f32_16x16x32_bf16 v[44:47], v[36:39], v[20:23], v[44:47]
    ds_read_b128 v[36:39], v9 offset:10240
    v_add_f32_dpp v29, v50, v29 quad_perm:[2,2,2,2] row_mask:0xf bank_mask:0xf
    v_mfma_f32_16x16x32_bf16 v[44:47], v[84:87], v[24:27], v[44:47]
    v_add_f32_dpp v29, v51, v29 quad_perm:[3,3,3,3] row_mask:0xf bank_mask:0xf
    v_max_f32 v10, v10, v29
    buffer_load_dwordx4 a[180:183], v3, s[12:15], s63 offen offset:1024 nt
    s_waitcnt lgkmcnt(2)
    v_mfma_f32_16x16x32_bf16 v[48:51], v[32:35], v[12:15], 0
    ds_read_b128 v[32:35], v9 offset:11264
    v_mov_b32_dpp v30, v52 quad_perm:[0,0,0,0] row_mask:0xf bank_mask:0xf
    v_mfma_f32_16x16x32_bf16 v[48:51], v[88:91], v[16:19], v[48:51]
    v_add_f32_dpp v30, v53, v30 quad_perm:[1,1,1,1] row_mask:0xf bank_mask:0xf
    s_waitcnt lgkmcnt(2)
    v_mfma_f32_16x16x32_bf16 v[48:51], v[40:43], v[20:23], v[48:51]
    ds_read_b128 v[40:43], v9 offset:12288
    v_add_f32_dpp v30, v54, v30 quad_perm:[2,2,2,2] row_mask:0xf bank_mask:0xf
    v_mfma_f32_16x16x32_bf16 v[48:51], v[92:95], v[24:27], v[48:51]
    v_add_f32_dpp v30, v55, v30 quad_perm:[3,3,3,3] row_mask:0xf bank_mask:0xf
    v_max_f32 v10, v10, v30
    s_waitcnt lgkmcnt(2)
    v_mfma_f32_16x16x32_bf16 v[52:55], v[36:39], v[12:15], 0
    ds_read_b128 v[36:39], v9 offset:13312
    v_mov_b32_dpp v31, v44 quad_perm:[0,0,0,0] row_mask:0xf bank_mask:0xf
    v_mfma_f32_16x16x32_bf16 v[52:55], v[96:99], v[16:19], v[52:55]
    v_add_f32_dpp v31, v45, v31 quad_perm:[1,1,1,1] row_mask:0xf bank_mask:0xf
    s_waitcnt lgkmcnt(2)
    v_mfma_f32_16x16x32_bf16 v[52:55], v[32:35], v[20:23], v[52:55]
    v_add_f32_dpp v31, v46, v31 quad_perm:[2,2,2,2] row_mask:0xf bank_mask:0xf
    v_mfma_f32_16x16x32_bf16 v[52:55], v[100:103], v[24:27], v[52:55]
    v_add_f32_dpp v31, v47, v31 quad_perm:[3,3,3,3] row_mask:0xf bank_mask:0xf
    v_max_f32 v10, v10, v31
    buffer_load_dwordx4 a[184:187], v3, s[12:15], s63 offen offset:2048 nt
    s_waitcnt lgkmcnt(1)
    v_mfma_f32_16x16x32_bf16 v[44:47], v[40:43], v[12:15], 0
    v_mov_b32_dpp v32, v48 quad_perm:[0,0,0,0] row_mask:0xf bank_mask:0xf
    v_mfma_f32_16x16x32_bf16 v[44:47], v[104:107], v[16:19], v[44:47]
    v_add_f32_dpp v32, v49, v32 quad_perm:[1,1,1,1] row_mask:0xf bank_mask:0xf
    s_waitcnt lgkmcnt(0)
    v_mfma_f32_16x16x32_bf16 v[44:47], v[36:39], v[20:23], v[44:47]
    v_add_f32_dpp v32, v50, v32 quad_perm:[2,2,2,2] row_mask:0xf bank_mask:0xf
    v_mfma_f32_16x16x32_bf16 v[44:47], v[108:111], v[24:27], v[44:47]
    v_add_f32_dpp v32, v51, v32 quad_perm:[3,3,3,3] row_mask:0xf bank_mask:0xf
    v_max_f32 v10, v10, v32
    v_mfma_f32_16x16x32_bf16 v[48:51], v[112:115], v[12:15], 0
    v_mov_b32_dpp v33, v52 quad_perm:[0,0,0,0] row_mask:0xf bank_mask:0xf
    v_mfma_f32_16x16x32_bf16 v[48:51], v[116:119], v[16:19], v[48:51]
    v_add_f32_dpp v33, v53, v33 quad_perm:[1,1,1,1] row_mask:0xf bank_mask:0xf
    v_mfma_f32_16x16x32_bf16 v[48:51], v[120:123], v[20:23], v[48:51]
    v_add_f32_dpp v33, v54, v33 quad_perm:[2,2,2,2] row_mask:0xf bank_mask:0xf
    v_mfma_f32_16x16x32_bf16 v[48:51], v[124:127], v[24:27], v[48:51]
    v_add_f32_dpp v33, v55, v33 quad_perm:[3,3,3,3] row_mask:0xf bank_mask:0xf
    v_max_f32 v10, v10, v33
    buffer_load_dwordx4 a[188:191], v3, s[12:15], s63 offen offset:3072 nt
    v_mfma_f32_16x16x32_bf16 v[52:55], v[128:131], v[12:15], 0
    v_mov_b32_dpp v34, v44 quad_perm:[0,0,0,0] row_mask:0xf bank_mask:0xf
    v_mfma_f32_16x16x32_bf16 v[52:55], v[132:135], v[16:19], v[52:55]
    v_add_f32_dpp v34, v45, v34 quad_perm:[1,1,1,1] row_mask:0xf bank_mask:0xf
    v_mfma_f32_16x16x32_bf16 v[52:55], v[136:139], v[20:23], v[52:55]
    v_add_f32_dpp v34, v46, v34 quad_perm:[2,2,2,2] row_mask:0xf bank_mask:0xf
    v_mfma_f32_16x16x32_bf16 v[52:55], v[140:143], v[24:27], v[52:55]
    v_add_f32_dpp v34, v47, v34 quad_perm:[3,3,3,3] row_mask:0xf bank_mask:0xf
    v_max_f32 v10, v10, v34
    v_mfma_f32_16x16x32_bf16 v[44:47], v[144:147], v[12:15], 0
    v_mov_b32_dpp v35, v48 quad_perm:[0,0,0,0] row_mask:0xf bank_mask:0xf
    v_mfma_f32_16x16x32_bf16 v[44:47], v[148:151], v[16:19], v[44:47]
    v_add_f32_dpp v35, v49, v35 quad_perm:[1,1,1,1] row_mask:0xf bank_mask:0xf
    v_mfma_f32_16x16x32_bf16 v[44:47], v[152:155], v[20:23], v[44:47]
    v_add_f32_dpp v35, v50, v35 quad_perm:[2,2,2,2] row_mask:0xf bank_mask:0xf
    v_mfma_f32_16x16x32_bf16 v[44:47], v[156:159], v[24:27], v[44:47]
    v_add_f32_dpp v35, v51, v35 quad_perm:[3,3,3,3] row_mask:0xf bank_mask:0xf
    v_max_f32 v10, v10, v35
    s_add_u32 s63, s101, 1572864
    s_and_b32 s63, s63, 0x1fffff
    s_bitset1_b32 s63, 26
    buffer_load_dwordx4 a[192:195], v3, s[12:15], s63 offen offset:0 nt
    v_mfma_f32_16x16x32_bf16 v[48:51], v[160:163], v[12:15], 0
    v_mov_b32_dpp v36, v52 quad_perm:[0,0,0,0] row_mask:0xf bank_mask:0xf
    v_mfma_f32_16x16x32_bf16 v[48:51], v[164:167], v[16:19], v[48:51]
    v_add_f32_dpp v36, v53, v36 quad_perm:[1,1,1,1] row_mask:0xf bank_mask:0xf
    v_mfma_f32_16x16x32_bf16 v[48:51], v[168:171], v[20:23], v[48:51]
    v_add_f32_dpp v36, v54, v36 quad_perm:[2,2,2,2] row_mask:0xf bank_mask:0xf
    v_mfma_f32_16x16x32_bf16 v[48:51], v[172:175], v[24:27], v[48:51]
    v_add_f32_dpp v36, v55, v36 quad_perm:[3,3,3,3] row_mask:0xf bank_mask:0xf
    v_max_f32 v10, v10, v36
    v_mfma_f32_16x16x32_bf16 v[52:55], v[176:179], v[12:15], 0
    v_mov_b32_dpp v37, v44 quad_perm:[0,0,0,0] row_mask:0xf bank_mask:0xf
    v_mfma_f32_16x16x32_bf16 v[52:55], v[180:183], v[16:19], v[52:55]
    v_add_f32_dpp v37, v45, v37 quad_perm:[1,1,1,1] row_mask:0xf bank_mask:0xf
    v_mfma_f32_16x16x32_bf16 v[52:55], v[184:187], v[20:23], v[52:55]
    v_add_f32_dpp v37, v46, v37 quad_perm:[2,2,2,2] row_mask:0xf bank_mask:0xf
    v_mfma_f32_16x16x32_bf16 v[52:55], v[188:191], v[24:27], v[52:55]
    v_add_f32_dpp v37, v47, v37 quad_perm:[3,3,3,3] row_mask:0xf bank_mask:0xf
    v_max_f32 v10, v10, v37
    buffer_load_dwordx4 a[196:199], v3, s[12:15], s63 offen offset:1024 nt
    v_mfma_f32_16x16x32_bf16 v[44:47], v[192:195], v[12:15], 0
    v_mov_b32_dpp v38, v48 quad_perm:[0,0,0,0] row_mask:0xf bank_mask:0xf
    v_mfma_f32_16x16x32_bf16 v[44:47], v[196:199], v[16:19], v[44:47]
    v_add_f32_dpp v38, v49, v38 quad_perm:[1,1,1,1] row_mask:0xf bank_mask:0xf
    v_mfma_f32_16x16x32_bf16 v[44:47], v[200:203], v[20:23], v[44:47]
    v_add_f32_dpp v38, v50, v38 quad_perm:[2,2,2,2] row_mask:0xf bank_mask:0xf
    v_mfma_f32_16x16x32_bf16 v[44:47], v[204:207], v[24:27], v[44:47]
    v_add_f32_dpp v38, v51, v38 quad_perm:[3,3,3,3] row_mask:0xf bank_mask:0xf
    v_max_f32 v10, v10, v38
    v_mfma_f32_16x16x32_bf16 v[48:51], v[208:211], v[12:15], 0
    v_mov_b32_dpp v39, v52 quad_perm:[0,0,0,0] row_mask:0xf bank_mask:0xf
    v_mfma_f32_16x16x32_bf16 v[48:51], v[212:215], v[16:19], v[48:51]
    v_add_f32_dpp v39, v53, v39 quad_perm:[1,1,1,1] row_mask:0xf bank_mask:0xf
    v_mfma_f32_16x16x32_bf16 v[48:51], v[216:219], v[20:23], v[48:51]
    v_add_f32_dpp v39, v54, v39 quad_perm:[2,2,2,2] row_mask:0xf bank_mask:0xf
    v_mfma_f32_16x16x32_bf16 v[48:51], v[220:223], v[24:27], v[48:51]
    v_add_f32_dpp v39, v55, v39 quad_perm:[3,3,3,3] row_mask:0xf bank_mask:0xf
    v_max_f32 v10, v10, v39
    buffer_load_dwordx4 a[200:203], v3, s[12:15], s63 offen offset:2048 nt
    v_mfma_f32_16x16x32_bf16 v[52:55], v[224:227], v[12:15], 0
    v_mov_b32_dpp v40, v44 quad_perm:[0,0,0,0] row_mask:0xf bank_mask:0xf
    v_mfma_f32_16x16x32_bf16 v[52:55], v[228:231], v[16:19], v[52:55]
    v_add_f32_dpp v40, v45, v40 quad_perm:[1,1,1,1] row_mask:0xf bank_mask:0xf
    v_mfma_f32_16x16x32_bf16 v[52:55], v[232:235], v[20:23], v[52:55]
    v_add_f32_dpp v40, v46, v40 quad_perm:[2,2,2,2] row_mask:0xf bank_mask:0xf
    v_mfma_f32_16x16x32_bf16 v[52:55], v[236:239], v[24:27], v[52:55]
    v_add_f32_dpp v40, v47, v40 quad_perm:[3,3,3,3] row_mask:0xf bank_mask:0xf
    v_max_f32 v10, v10, v40
    v_mfma_f32_16x16x32_bf16 v[44:47], v[240:243], v[12:15], 0
    v_mov_b32_dpp v41, v48 quad_perm:[0,0,0,0] row_mask:0xf bank_mask:0xf
    v_mfma_f32_16x16x32_bf16 v[44:47], v[244:247], v[16:19], v[44:47]
    v_add_f32_dpp v41, v49, v41 quad_perm:[1,1,1,1] row_mask:0xf bank_mask:0xf
    v_mfma_f32_16x16x32_bf16 v[44:47], v[248:251], v[20:23], v[44:47]
    v_add_f32_dpp v41, v50, v41 quad_perm:[2,2,2,2] row_mask:0xf bank_mask:0xf
    v_mfma_f32_16x16x32_bf16 v[44:47], v[252:255], v[24:27], v[44:47]
    v_add_f32_dpp v41, v51, v41 quad_perm:[3,3,3,3] row_mask:0xf bank_mask:0xf
    v_max_f32 v10, v10, v41
    buffer_load_dwordx4 a[204:207], v3, s[12:15], s63 offen offset:3072 nt
    v_mov_b32_dpp v42, v52 quad_perm:[0,0,0,0] row_mask:0xf bank_mask:0xf
    v_add_f32_dpp v42, v53, v42 quad_perm:[1,1,1,1] row_mask:0xf bank_mask:0xf
    v_add_f32_dpp v42, v54, v42 quad_perm:[2,2,2,2] row_mask:0xf bank_mask:0xf
    v_add_f32_dpp v42, v55, v42 quad_perm:[3,3,3,3] row_mask:0xf bank_mask:0xf
    v_max_f32 v10, v10, v42
    v_and_b32 v11, 1, v0
    v_lshlrev_b32 v11, 4, v11
    v_mov_b32 v48, 0xffff
    v_lshlrev_b32 v48, v11, v48
    v_mov_b32_dpp v43, v44 quad_perm:[0,0,0,0] row_mask:0xf bank_mask:0xf
    v_add_f32_dpp v43, v45, v43 quad_perm:[1,1,1,1] row_mask:0xf bank_mask:0xf
    v_add_f32_dpp v43, v46, v43 quad_perm:[2,2,2,2] row_mask:0xf bank_mask:0xf
    v_add_f32_dpp v43, v47, v43 quad_perm:[3,3,3,3] row_mask:0xf bank_mask:0xf
    v_max_f32 v10, v10, v43
    s_mov_b32 vcc_lo, 0x33333333
    s_mov_b32 vcc_hi, 0x33333333
    v_cndmask_b32 v44, 0, v48, vcc
    s_mov_b32 vcc_lo, 0xcccccccc
    s_mov_b32 vcc_hi, 0xcccccccc
    v_cndmask_b32 v45, 0, v48, vcc
    s_mov_b32 s7, 0x3e0293ee
    s_nop 1
    v_max_f32_dpp v10, v10, v10 row_ror:4 row_mask:0xf bank_mask:0xf
    s_nop 1
    v_max_f32_dpp v10, v10, v10 row_ror:8 row_mask:0xf bank_mask:0xf
    v_mov_b32 v11, v10
    s_nop 1
    v_permlane32_swap_b32 v10, v11
    v_max_f32 v10, v10, v11
    v_mov_b32 v11, v10
    s_nop 1
    v_permlane16_swap_b32 v10, v11
    v_max_f32 v10, v10, v11
    v_mul_f32 v10, s7, v10
    v_mov_b32 v11, 0
    v_fma_f32 v28, v28, s7, -v10
    v_fma_f32 v29, v29, s7, -v10
    v_exp_f32 v28, v28
    v_exp_f32 v29, v29
    v_add_f32 v11, v11, v28
    v_add_f32 v11, v11, v29
    v_cvt_pk_bf16_f32 v28, v28, v28
    v_cvt_pk_bf16_f32 v29, v29, v29
    v_and_b32 v48, v28, v44
    v_and_b32 v49, v28, v45
    s_nop 1
    s_waitcnt vmcnt(57)
    v_mfma_f32_4x4x4_16b_bf16 v[12:15], v[48:49], a[0:1], 0 cbsz:2 abid:0
    v_and_b32 v50, v29, v44
    v_mfma_f32_4x4x4_16b_bf16 v[16:19], v[48:49], a[2:3], 0 cbsz:2 abid:0
    v_and_b32 v51, v29, v45
    v_mfma_f32_4x4x4_16b_bf16 v[20:23], v[48:49], a[4:5], 0 cbsz:2 abid:1
    v_fma_f32 v30, v30, s7, -v10
    v_mfma_f32_4x4x4_16b_bf16 v[24:27], v[48:49], a[6:7], 0 cbsz:2 abid:1
    v_exp_f32 v30, v30
    v_mfma_f32_4x4x4_16b_bf16 v[12:15], v[48:49], a[8:9], v[12:15] cbsz:2 abid:2
    v_add_f32 v11, v11, v30
    v_mfma_f32_4x4x4_16b_bf16 v[16:19], v[48:49], a[10:11], v[16:19] cbsz:2 abid:2
    v_cvt_pk_bf16_f32 v30, v30, v30
    v_mfma_f32_4x4x4_16b_bf16 v[20:23], v[48:49], a[12:13], v[20:23] cbsz:2 abid:3
    v_mfma_f32_4x4x4_16b_bf16 v[24:27], v[48:49], a[14:15], v[24:27] cbsz:2 abid:3
    s_waitcnt vmcnt(53)
    v_mfma_f32_4x4x4_16b_bf16 v[12:15], v[50:51], a[16:17], v[12:15] cbsz:2 abid:0
    v_and_b32 v48, v30, v44
    v_mfma_f32_4x4x4_16b_bf16 v[16:19], v[50:51], a[18:19], v[16:19] cbsz:2 abid:0
    v_and_b32 v49, v30, v45
    v_mfma_f32_4x4x4_16b_bf16 v[20:23], v[50:51], a[20:21], v[20:23] cbsz:2 abid:1
    v_fma_f32 v31, v31, s7, -v10
    v_mfma_f32_4x4x4_16b_bf16 v[24:27], v[50:51], a[22:23], v[24:27] cbsz:2 abid:1
    v_exp_f32 v31, v31
    v_mfma_f32_4x4x4_16b_bf16 v[12:15], v[50:51], a[24:25], v[12:15] cbsz:2 abid:2
    v_add_f32 v11, v11, v31
    v_mfma_f32_4x4x4_16b_bf16 v[16:19], v[50:51], a[26:27], v[16:19] cbsz:2 abid:2
    v_cvt_pk_bf16_f32 v31, v31, v31
    v_mfma_f32_4x4x4_16b_bf16 v[20:23], v[50:51], a[28:29], v[20:23] cbsz:2 abid:3
    v_mfma_f32_4x4x4_16b_bf16 v[24:27], v[50:51], a[30:31], v[24:27] cbsz:2 abid:3
    s_waitcnt vmcnt(49)
    v_mfma_f32_4x4x4_16b_bf16 v[12:15], v[48:49], a[32:33], v[12:15] cbsz:2 abid:0
    v_and_b32 v50, v31, v44
    v_mfma_f32_4x4x4_16b_bf16 v[16:19], v[48:49], a[34:35], v[16:19] cbsz:2 abid:0
    v_and_b32 v51, v31, v45
    v_mfma_f32_4x4x4_16b_bf16 v[20:23], v[48:49], a[36:37], v[20:23] cbsz:2 abid:1
    v_fma_f32 v32, v32, s7, -v10
    v_mfma_f32_4x4x4_16b_bf16 v[24:27], v[48:49], a[38:39], v[24:27] cbsz:2 abid:1
    v_exp_f32 v32, v32
    v_mfma_f32_4x4x4_16b_bf16 v[12:15], v[48:49], a[40:41], v[12:15] cbsz:2 abid:2
    v_add_f32 v11, v11, v32
    v_mfma_f32_4x4x4_16b_bf16 v[16:19], v[48:49], a[42:43], v[16:19] cbsz:2 abid:2
    v_cvt_pk_bf16_f32 v32, v32, v32
    v_mfma_f32_4x4x4_16b_bf16 v[20:23], v[48:49], a[44:45], v[20:23] cbsz:2 abid:3
    v_mfma_f32_4x4x4_16b_bf16 v[24:27], v[48:49], a[46:47], v[24:27] cbsz:2 abid:3
    s_waitcnt vmcnt(44)
    v_mfma_f32_4x4x4_16b_bf16 v[12:15], v[50:51], a[48:49], v[12:15] cbsz:2 abid:0
    v_and_b32 v48, v32, v44
    v_mfma_f32_4x4x4_16b_bf16 v[16:19], v[50:51], a[50:51], v[16:19] cbsz:2 abid:0
    v_and_b32 v49, v32, v45
    v_mfma_f32_4x4x4_16b_bf16 v[20:23], v[50:51], a[52:53], v[20:23] cbsz:2 abid:1
    v_fma_f32 v33, v33, s7, -v10
    v_mfma_f32_4x4x4_16b_bf16 v[24:27], v[50:51], a[54:55], v[24:27] cbsz:2 abid:1
    v_exp_f32 v33, v33
    v_mfma_f32_4x4x4_16b_bf16 v[12:15], v[50:51], a[56:57], v[12:15] cbsz:2 abid:2
    v_add_f32 v11, v11, v33
    v_mfma_f32_4x4x4_16b_bf16 v[16:19], v[50:51], a[58:59], v[16:19] cbsz:2 abid:2
    v_cvt_pk_bf16_f32 v33, v33, v33
    v_mfma_f32_4x4x4_16b_bf16 v[20:23], v[50:51], a[60:61], v[20:23] cbsz:2 abid:3
    v_mfma_f32_4x4x4_16b_bf16 v[24:27], v[50:51], a[62:63], v[24:27] cbsz:2 abid:3
    s_waitcnt vmcnt(40)
    v_mfma_f32_4x4x4_16b_bf16 v[12:15], v[48:49], a[64:65], v[12:15] cbsz:2 abid:0
    v_and_b32 v50, v33, v44
    v_mfma_f32_4x4x4_16b_bf16 v[16:19], v[48:49], a[66:67], v[16:19] cbsz:2 abid:0
    v_and_b32 v51, v33, v45
    v_mfma_f32_4x4x4_16b_bf16 v[20:23], v[48:49], a[68:69], v[20:23] cbsz:2 abid:1
    v_fma_f32 v34, v34, s7, -v10
    v_mfma_f32_4x4x4_16b_bf16 v[24:27], v[48:49], a[70:71], v[24:27] cbsz:2 abid:1
    v_exp_f32 v34, v34
    v_mfma_f32_4x4x4_16b_bf16 v[12:15], v[48:49], a[72:73], v[12:15] cbsz:2 abid:2
    v_add_f32 v11, v11, v34
    v_mfma_f32_4x4x4_16b_bf16 v[16:19], v[48:49], a[74:75], v[16:19] cbsz:2 abid:2
    v_cvt_pk_bf16_f32 v34, v34, v34
    v_mfma_f32_4x4x4_16b_bf16 v[20:23], v[48:49], a[76:77], v[20:23] cbsz:2 abid:3
    v_mfma_f32_4x4x4_16b_bf16 v[24:27], v[48:49], a[78:79], v[24:27] cbsz:2 abid:3
    s_waitcnt vmcnt(36)
    v_mfma_f32_4x4x4_16b_bf16 v[12:15], v[50:51], a[80:81], v[12:15] cbsz:2 abid:0
    v_and_b32 v48, v34, v44
    v_mfma_f32_4x4x4_16b_bf16 v[16:19], v[50:51], a[82:83], v[16:19] cbsz:2 abid:0
    v_and_b32 v49, v34, v45
    v_mfma_f32_4x4x4_16b_bf16 v[20:23], v[50:51], a[84:85], v[20:23] cbsz:2 abid:1
    v_fma_f32 v35, v35, s7, -v10
    v_mfma_f32_4x4x4_16b_bf16 v[24:27], v[50:51], a[86:87], v[24:27] cbsz:2 abid:1
    v_exp_f32 v35, v35
    v_mfma_f32_4x4x4_16b_bf16 v[12:15], v[50:51], a[88:89], v[12:15] cbsz:2 abid:2
    v_add_f32 v11, v11, v35
    v_mfma_f32_4x4x4_16b_bf16 v[16:19], v[50:51], a[90:91], v[16:19] cbsz:2 abid:2
    v_cvt_pk_bf16_f32 v35, v35, v35
    v_mfma_f32_4x4x4_16b_bf16 v[20:23], v[50:51], a[92:93], v[20:23] cbsz:2 abid:3
    v_mfma_f32_4x4x4_16b_bf16 v[24:27], v[50:51], a[94:95], v[24:27] cbsz:2 abid:3
    s_waitcnt vmcnt(27)
    v_mfma_f32_4x4x4_16b_bf16 v[12:15], v[48:49], a[96:97], v[12:15] cbsz:2 abid:0
    v_and_b32 v50, v35, v44
    v_mfma_f32_4x4x4_16b_bf16 v[16:19], v[48:49], a[98:99], v[16:19] cbsz:2 abid:0
    v_and_b32 v51, v35, v45
    v_mfma_f32_4x4x4_16b_bf16 v[20:23], v[48:49], a[100:101], v[20:23] cbsz:2 abid:1
    v_fma_f32 v36, v36, s7, -v10
    v_mfma_f32_4x4x4_16b_bf16 v[24:27], v[48:49], a[102:103], v[24:27] cbsz:2 abid:1
    v_exp_f32 v36, v36
    v_mfma_f32_4x4x4_16b_bf16 v[12:15], v[48:49], a[104:105], v[12:15] cbsz:2 abid:2
    v_add_f32 v11, v11, v36
    v_mfma_f32_4x4x4_16b_bf16 v[16:19], v[48:49], a[106:107], v[16:19] cbsz:2 abid:2
    v_cvt_pk_bf16_f32 v36, v36, v36
    v_mfma_f32_4x4x4_16b_bf16 v[20:23], v[48:49], a[108:109], v[20:23] cbsz:2 abid:3
    v_mfma_f32_4x4x4_16b_bf16 v[24:27], v[48:49], a[110:111], v[24:27] cbsz:2 abid:3
    s_waitcnt vmcnt(23)
    v_mfma_f32_4x4x4_16b_bf16 v[12:15], v[50:51], a[112:113], v[12:15] cbsz:2 abid:0
    v_and_b32 v48, v36, v44
    v_mfma_f32_4x4x4_16b_bf16 v[16:19], v[50:51], a[114:115], v[16:19] cbsz:2 abid:0
    v_and_b32 v49, v36, v45
    v_mfma_f32_4x4x4_16b_bf16 v[20:23], v[50:51], a[116:117], v[20:23] cbsz:2 abid:1
    v_fma_f32 v37, v37, s7, -v10
    v_mfma_f32_4x4x4_16b_bf16 v[24:27], v[50:51], a[118:119], v[24:27] cbsz:2 abid:1
    v_exp_f32 v37, v37
    v_mfma_f32_4x4x4_16b_bf16 v[12:15], v[50:51], a[120:121], v[12:15] cbsz:2 abid:2
    v_add_f32 v11, v11, v37
    v_mfma_f32_4x4x4_16b_bf16 v[16:19], v[50:51], a[122:123], v[16:19] cbsz:2 abid:2
    v_cvt_pk_bf16_f32 v37, v37, v37
    v_mfma_f32_4x4x4_16b_bf16 v[20:23], v[50:51], a[124:125], v[20:23] cbsz:2 abid:3
    v_mfma_f32_4x4x4_16b_bf16 v[24:27], v[50:51], a[126:127], v[24:27] cbsz:2 abid:3
    s_waitcnt vmcnt(19)
    v_mfma_f32_4x4x4_16b_bf16 v[12:15], v[48:49], a[128:129], v[12:15] cbsz:2 abid:0
    v_and_b32 v50, v37, v44
    v_mfma_f32_4x4x4_16b_bf16 v[16:19], v[48:49], a[130:131], v[16:19] cbsz:2 abid:0
    v_and_b32 v51, v37, v45
    v_mfma_f32_4x4x4_16b_bf16 v[20:23], v[48:49], a[132:133], v[20:23] cbsz:2 abid:1
    v_fma_f32 v38, v38, s7, -v10
    v_mfma_f32_4x4x4_16b_bf16 v[24:27], v[48:49], a[134:135], v[24:27] cbsz:2 abid:1
    v_exp_f32 v38, v38
    v_mfma_f32_4x4x4_16b_bf16 v[12:15], v[48:49], a[136:137], v[12:15] cbsz:2 abid:2
    v_add_f32 v11, v11, v38
    v_mfma_f32_4x4x4_16b_bf16 v[16:19], v[48:49], a[138:139], v[16:19] cbsz:2 abid:2
    v_cvt_pk_bf16_f32 v38, v38, v38
    v_mfma_f32_4x4x4_16b_bf16 v[20:23], v[48:49], a[140:141], v[20:23] cbsz:2 abid:3
    v_mfma_f32_4x4x4_16b_bf16 v[24:27], v[48:49], a[142:143], v[24:27] cbsz:2 abid:3
    s_add_u32 s63, s101, 1703936
    s_and_b32 s63, s63, 0x1fffff
    s_bitset1_b32 s63, 26
    buffer_load_dwordx4 a[208:211], v3, s[12:15], s63 offen offset:0 nt
    buffer_load_dwordx4 a[212:215], v3, s[12:15], s63 offen offset:1024 nt
    buffer_load_dwordx4 a[216:219], v3, s[12:15], s63 offen offset:2048 nt
    buffer_load_dwordx4 a[220:223], v3, s[12:15], s63 offen offset:3072 nt
    s_waitcnt vmcnt(19)
    v_mfma_f32_4x4x4_16b_bf16 v[12:15], v[50:51], a[144:145], v[12:15] cbsz:2 abid:0
    v_and_b32 v48, v38, v44
    v_mfma_f32_4x4x4_16b_bf16 v[16:19], v[50:51], a[146:147], v[16:19] cbsz:2 abid:0
    v_and_b32 v49, v38, v45
    v_mfma_f32_4x4x4_16b_bf16 v[20:23], v[50:51], a[148:149], v[20:23] cbsz:2 abid:1
    v_fma_f32 v39, v39, s7, -v10
    v_mfma_f32_4x4x4_16b_bf16 v[24:27], v[50:51], a[150:151], v[24:27] cbsz:2 abid:1
    v_exp_f32 v39, v39
    v_mfma_f32_4x4x4_16b_bf16 v[12:15], v[50:51], a[152:153], v[12:15] cbsz:2 abid:2
    v_add_f32 v11, v11, v39
    v_mfma_f32_4x4x4_16b_bf16 v[16:19], v[50:51], a[154:155], v[16:19] cbsz:2 abid:2
    v_cvt_pk_bf16_f32 v39, v39, v39
    v_mfma_f32_4x4x4_16b_bf16 v[20:23], v[50:51], a[156:157], v[20:23] cbsz:2 abid:3
    v_mfma_f32_4x4x4_16b_bf16 v[24:27], v[50:51], a[158:159], v[24:27] cbsz:2 abid:3
    s_add_u32 s63, s101, 1835008
    s_and_b32 s63, s63, 0x1fffff
    s_bitset1_b32 s63, 26
    buffer_load_dwordx4 a[224:227], v3, s[12:15], s63 offen offset:0 nt
    buffer_load_dwordx4 a[228:231], v3, s[12:15], s63 offen offset:1024 nt
    buffer_load_dwordx4 a[232:235], v3, s[12:15], s63 offen offset:2048 nt
    buffer_load_dwordx4 a[236:239], v3, s[12:15], s63 offen offset:3072 nt
    s_waitcnt vmcnt(18)
    v_mfma_f32_4x4x4_16b_bf16 v[12:15], v[48:49], a[160:161], v[12:15] cbsz:2 abid:0
    v_and_b32 v50, v39, v44
    v_mfma_f32_4x4x4_16b_bf16 v[16:19], v[48:49], a[162:163], v[16:19] cbsz:2 abid:0
    v_and_b32 v51, v39, v45
    v_mfma_f32_4x4x4_16b_bf16 v[20:23], v[48:49], a[164:165], v[20:23] cbsz:2 abid:1
    v_fma_f32 v40, v40, s7, -v10
    v_mfma_f32_4x4x4_16b_bf16 v[24:27], v[48:49], a[166:167], v[24:27] cbsz:2 abid:1
    v_exp_f32 v40, v40
    v_mfma_f32_4x4x4_16b_bf16 v[12:15], v[48:49], a[168:169], v[12:15] cbsz:2 abid:2
    v_add_f32 v11, v11, v40
    v_mfma_f32_4x4x4_16b_bf16 v[16:19], v[48:49], a[170:171], v[16:19] cbsz:2 abid:2
    v_cvt_pk_bf16_f32 v40, v40, v40
    v_mfma_f32_4x4x4_16b_bf16 v[20:23], v[48:49], a[172:173], v[20:23] cbsz:2 abid:3
    v_mfma_f32_4x4x4_16b_bf16 v[24:27], v[48:49], a[174:175], v[24:27] cbsz:2 abid:3
    s_add_u32 s63, s101, 1966080
    s_and_b32 s63, s63, 0x1fffff
    s_bitset1_b32 s63, 26
    buffer_load_dwordx4 a[240:243], v3, s[12:15], s63 offen offset:0 nt
    buffer_load_dwordx4 a[244:247], v3, s[12:15], s63 offen offset:1024 nt
    buffer_load_dwordx4 a[248:251], v3, s[12:15], s63 offen offset:2048 nt
    buffer_load_dwordx4 a[252:255], v3, s[12:15], s63 offen offset:3072 nt
    s_waitcnt vmcnt(16)
    v_mfma_f32_4x4x4_16b_bf16 v[12:15], v[50:51], a[176:177], v[12:15] cbsz:2 abid:0
    v_and_b32 v48, v40, v44
    v_mfma_f32_4x4x4_16b_bf16 v[16:19], v[50:51], a[178:179], v[16:19] cbsz:2 abid:0
    v_and_b32 v49, v40, v45
    v_mfma_f32_4x4x4_16b_bf16 v[20:23], v[50:51], a[180:181], v[20:23] cbsz:2 abid:1
    v_fma_f32 v41, v41, s7, -v10
    v_mfma_f32_4x4x4_16b_bf16 v[24:27], v[50:51], a[182:183], v[24:27] cbsz:2 abid:1
    v_exp_f32 v41, v41
    v_mfma_f32_4x4x4_16b_bf16 v[12:15], v[50:51], a[184:185], v[12:15] cbsz:2 abid:2
    v_add_f32 v11, v11, v41
    v_mfma_f32_4x4x4_16b_bf16 v[16:19], v[50:51], a[186:187], v[16:19] cbsz:2 abid:2
    v_cvt_pk_bf16_f32 v41, v41, v41
    v_mfma_f32_4x4x4_16b_bf16 v[20:23], v[50:51], a[188:189], v[20:23] cbsz:2 abid:3
    v_mfma_f32_4x4x4_16b_bf16 v[24:27], v[50:51], a[190:191], v[24:27] cbsz:2 abid:3
    s_waitcnt vmcnt(12)
    v_mfma_f32_4x4x4_16b_bf16 v[12:15], v[48:49], a[192:193], v[12:15] cbsz:2 abid:0
    v_and_b32 v50, v41, v44
    v_mfma_f32_4x4x4_16b_bf16 v[16:19], v[48:49], a[194:195], v[16:19] cbsz:2 abid:0
    v_and_b32 v51, v41, v45
    v_mfma_f32_4x4x4_16b_bf16 v[20:23], v[48:49], a[196:197], v[20:23] cbsz:2 abid:1
    v_fma_f32 v42, v42, s7, -v10
    v_mfma_f32_4x4x4_16b_bf16 v[24:27], v[48:49], a[198:199], v[24:27] cbsz:2 abid:1
    v_exp_f32 v42, v42
    v_mfma_f32_4x4x4_16b_bf16 v[12:15], v[48:49], a[200:201], v[12:15] cbsz:2 abid:2
    v_add_f32 v11, v11, v42
    v_mfma_f32_4x4x4_16b_bf16 v[16:19], v[48:49], a[202:203], v[16:19] cbsz:2 abid:2
    v_cvt_pk_bf16_f32 v42, v42, v42
    v_mfma_f32_4x4x4_16b_bf16 v[20:23], v[48:49], a[204:205], v[20:23] cbsz:2 abid:3
    v_mfma_f32_4x4x4_16b_bf16 v[24:27], v[48:49], a[206:207], v[24:27] cbsz:2 abid:3
    s_waitcnt vmcnt(8)
    v_mfma_f32_4x4x4_16b_bf16 v[12:15], v[50:51], a[208:209], v[12:15] cbsz:2 abid:0
    v_and_b32 v48, v42, v44
    v_mfma_f32_4x4x4_16b_bf16 v[16:19], v[50:51], a[210:211], v[16:19] cbsz:2 abid:0
    v_and_b32 v49, v42, v45
    v_mfma_f32_4x4x4_16b_bf16 v[20:23], v[50:51], a[212:213], v[20:23] cbsz:2 abid:1
    v_fma_f32 v43, v43, s7, -v10
    v_mfma_f32_4x4x4_16b_bf16 v[24:27], v[50:51], a[214:215], v[24:27] cbsz:2 abid:1
    v_exp_f32 v43, v43
    v_mfma_f32_4x4x4_16b_bf16 v[12:15], v[50:51], a[216:217], v[12:15] cbsz:2 abid:2
    v_add_f32 v11, v11, v43
    v_mfma_f32_4x4x4_16b_bf16 v[16:19], v[50:51], a[218:219], v[16:19] cbsz:2 abid:2
    v_cvt_pk_bf16_f32 v43, v43, v43
    v_mfma_f32_4x4x4_16b_bf16 v[20:23], v[50:51], a[220:221], v[20:23] cbsz:2 abid:3
    v_mfma_f32_4x4x4_16b_bf16 v[24:27], v[50:51], a[222:223], v[24:27] cbsz:2 abid:3
    s_mov_b32 s60, 158080
    s_mov_b32 s61, 162304
    s_waitcnt vmcnt(4)
    v_mfma_f32_4x4x4_16b_bf16 v[12:15], v[48:49], a[224:225], v[12:15] cbsz:2 abid:0
    v_and_b32 v50, v43, v44
    v_mfma_f32_4x4x4_16b_bf16 v[16:19], v[48:49], a[226:227], v[16:19] cbsz:2 abid:0
    v_and_b32 v51, v43, v45
    v_mfma_f32_4x4x4_16b_bf16 v[20:23], v[48:49], a[228:229], v[20:23] cbsz:2 abid:1
    v_lshrrev_b32 v52, 5, v0
    v_mfma_f32_4x4x4_16b_bf16 v[24:27], v[48:49], a[230:231], v[24:27] cbsz:2 abid:1
    v_lshl_add_u32 v52, s3, 1, v52
    v_mfma_f32_4x4x4_16b_bf16 v[12:15], v[48:49], a[232:233], v[12:15] cbsz:2 abid:2
    v_mul_u32_u24 v52, 528, v52
    v_mfma_f32_4x4x4_16b_bf16 v[16:19], v[48:49], a[234:235], v[16:19] cbsz:2 abid:2
    v_and_b32 v5, 15, v0
    v_mfma_f32_4x4x4_16b_bf16 v[20:23], v[48:49], a[236:237], v[20:23] cbsz:2 abid:3
    v_lshl_add_u32 v52, v5, 5, v52
    v_mfma_f32_4x4x4_16b_bf16 v[24:27], v[48:49], a[238:239], v[24:27] cbsz:2 abid:3
    v_and_b32 v5, 16, v0
    s_waitcnt vmcnt(0)
    v_mfma_f32_4x4x4_16b_bf16 v[12:15], v[50:51], a[240:241], v[12:15] cbsz:2 abid:0
    v_add3_u32 v52, v52, v5, s60
    v_mfma_f32_4x4x4_16b_bf16 v[16:19], v[50:51], a[242:243], v[16:19] cbsz:2 abid:0
    v_lshrrev_b32 v54, 3, v0
    v_mfma_f32_4x4x4_16b_bf16 v[20:23], v[50:51], a[244:245], v[20:23] cbsz:2 abid:1
    v_lshl_add_u32 v54, s3, 3, v54
    v_mfma_f32_4x4x4_16b_bf16 v[24:27], v[50:51], a[246:247], v[24:27] cbsz:2 abid:1
    v_lshlrev_b32 v54, 4, v54
    v_mfma_f32_4x4x4_16b_bf16 v[12:15], v[50:51], a[248:249], v[12:15] cbsz:2 abid:2
    v_and_b32 v5, 7, v0
    v_mfma_f32_4x4x4_16b_bf16 v[16:19], v[50:51], a[250:251], v[16:19] cbsz:2 abid:2
    v_mul_u32_u24 v55, 528, v5
    v_mfma_f32_4x4x4_16b_bf16 v[20:23], v[50:51], a[252:253], v[20:23] cbsz:2 abid:3
    v_add3_u32 v55, v55, v54, s60
    v_mfma_f32_4x4x4_16b_bf16 v[24:27], v[50:51], a[254:255], v[24:27] cbsz:2 abid:3
    v_and_b32 v5, 6, v0
    v_lshl_add_u32 v5, v5, 2, s61
    s_nop 1
    v_add_f32_dpp v11, v11, v11 row_ror:4 row_mask:0xf bank_mask:0xf
    s_nop 1
    v_add_f32_dpp v11, v11, v11 row_ror:8 row_mask:0xf bank_mask:0xf
    v_mov_b32 v28, v11
    s_nop 1
    v_permlane32_swap_b32 v11, v28
    v_add_f32 v11, v11, v28
    v_mov_b32 v28, v11
    s_nop 1
    v_permlane16_swap_b32 v11, v28
    v_add_f32 v11, v11, v28
    s_lshl_b32 s60, s3, 3
    s_add_u32 s60, s60, s61
    v_mov_b32 v28, s60
    v_add_f32 v12, v12, v20
    v_add_f32 v13, v13, v21
    v_add_f32 v14, v14, v22
    v_add_f32 v15, v15, v23
    v_add_f32 v16, v16, v24
    v_add_f32 v17, v17, v25
    v_add_f32 v18, v18, v26
    v_add_f32 v19, v19, v27
    v_permlane16_swap_b32 v12, v16
    v_permlane16_swap_b32 v13, v17
    v_permlane16_swap_b32 v14, v18
    v_permlane16_swap_b32 v15, v19
    v_add_f32 v12, v12, v16
    v_add_f32 v13, v13, v17
    v_add_f32 v14, v14, v18
    v_add_f32 v15, v15, v19
    ds_write_b128 v52, v[12:15]
    ds_write_b64 v28, v[10:11]
    s_mov_b32 vcc_lo, 0x1010101
    s_mov_b32 vcc_hi, 0x1010101
    v_bfrev_b32 v23, 1
    v_cndmask_b32 v54, v23, v54, vcc
    v_or_b32 v24, s3, v0
    v_cmp_eq_u32 vcc, 0, v24
    s_mul_i32 s64, s2, 640
    s_add_u32 s64, s64, 1015808
    v_cndmask_b32 v23, v23, v24, vcc
    s_waitcnt lgkmcnt(0)
    s_barrier
    ds_read_b64 v[16:17], v5
    ds_read_b128 v[12:15], v55
    s_waitcnt lgkmcnt(1)
    v_max_f32_dpp v10, v16, v16 quad_perm:[2,3,0,1] row_mask:0xf bank_mask:0xf
    s_nop 1
    v_max_f32_dpp v10, v10, v10 row_half_mirror row_mask:0xf bank_mask:0xf
    v_sub_f32 v16, v16, v10
    v_exp_f32 v16, v16
    s_waitcnt lgkmcnt(0)
    v_mul_f32 v11, v17, v16
    v_mul_f32 v12, v12, v16
    v_mul_f32 v13, v13, v16
    v_mul_f32 v14, v14, v16
    v_mul_f32 v15, v15, v16
    v_add_f32_dpp v12, v12, v12 quad_perm:[1,0,3,2] row_mask:0xf bank_mask:0xf
    v_add_f32_dpp v13, v13, v13 quad_perm:[1,0,3,2] row_mask:0xf bank_mask:0xf
    v_add_f32_dpp v14, v14, v14 quad_perm:[1,0,3,2] row_mask:0xf bank_mask:0xf
    v_add_f32_dpp v15, v15, v15 quad_perm:[1,0,3,2] row_mask:0xf bank_mask:0xf
    v_add_f32_dpp v11, v11, v11 quad_perm:[2,3,0,1] row_mask:0xf bank_mask:0xf
    v_add_f32_dpp v12, v12, v12 quad_perm:[2,3,0,1] row_mask:0xf bank_mask:0xf
    v_add_f32_dpp v13, v13, v13 quad_perm:[2,3,0,1] row_mask:0xf bank_mask:0xf
    v_add_f32_dpp v14, v14, v14 quad_perm:[2,3,0,1] row_mask:0xf bank_mask:0xf
    v_add_f32_dpp v15, v15, v15 quad_perm:[2,3,0,1] row_mask:0xf bank_mask:0xf
    v_add_f32_dpp v11, v11, v11 row_half_mirror row_mask:0xf bank_mask:0xf
    v_add_f32_dpp v12, v12, v12 row_half_mirror row_mask:0xf bank_mask:0xf
    v_add_f32_dpp v13, v13, v13 row_half_mirror row_mask:0xf bank_mask:0xf
    v_add_f32_dpp v14, v14, v14 row_half_mirror row_mask:0xf bank_mask:0xf
    v_add_f32_dpp v15, v15, v15 row_half_mirror row_mask:0xf bank_mask:0xf
    s_cmp_eq_u32 s97, 0
    s_cbranch_scc1 Y20
    buffer_store_dwordx4 v[12:15], v54, s[48:51], s64 offen
    buffer_store_dwordx2 v[10:11], v23, s[48:51], s64 offen offset:512
Y20d:
    v_and_b32 v47, 31, v0
    v_lshl_add_u32 v47, s3, 5, v47
    v_lshrrev_b32 v44, 5, v0
    v_lshlrev_b32 v45, 7, v44
    v_add_lshl_u32 v45, v45, v47, 1
    v_add_u32 v45, 156928, v45
    v_lshlrev_b32 v44, 31, v44
    v_lshl_add_u32 v47, v47, 2, v44
    v_and_b32 v46, 7, v0
    v_mul_u32_u24 v46, 640, v46
    v_add_u32 v46, v46, v44
    s_mov_b32 vcc_lo, 0xff00ff
    s_mov_b32 vcc_hi, 0xff00ff
    v_bfrev_b32 v44, 1
    v_cndmask_b32 v46, v44, v46, vcc
    s_mul_i32 s60, s4, 5120
    s_add_u32 s60, s60, 1015808
    s_add_u32 s61, s60, 2560
    s_waitcnt vmcnt(0)
    buffer_load_dwordx2 v[18:19], v46, s[48:51], s60 offen offset:512 sc1
    buffer_load_dword v10, v47, s[48:51], s60 offen offset:0 sc1
    buffer_load_dword v11, v47, s[48:51], s60 offen offset:640 sc1
    buffer_load_dword v12, v47, s[48:51], s60 offen offset:1280 sc1
    buffer_load_dword v13, v47, s[48:51], s60 offen offset:1920 sc1
    buffer_load_dword v14, v47, s[48:51], s61 offen offset:0 sc1
    buffer_load_dword v15, v47, s[48:51], s61 offen offset:640 sc1
    buffer_load_dword v16, v47, s[48:51], s61 offen offset:1280 sc1
    buffer_load_dword v17, v47, s[48:51], s61 offen offset:1920 sc1
    v_and_b32 v50, 1, v0
    v_lshlrev_b32 v54, 31, v50
    v_and_b32 v50, 2, v0
    v_lshl_add_u32 v54, v50, 5, v54
    v_and_b32 v50, 48, v0
    v_add_u32 v54, v54, v50
    s_mov_b32 vcc_lo, 0xf000f
    s_mov_b32 vcc_hi, 0xf000f
    v_bfrev_b32 v50, 1
    v_cndmask_b32 v54, v50, v54, vcc
    s_lshl_b32 s64, s5, 5
    s_add_u32 s64, s64, s4
    s_lshl_b32 s64, s64, 2
    s_add_u32 s64, s64, s3
    s_lshl_b32 s64, s64, 7
    s_add_u32 s64, s64, 1638400
    v_lshrrev_b32 v55, 2, v0
    v_mul_u32_u24 v55, 144, v55
    v_and_b32 v50, 24, v1
    v_add_u32 v55, v55, v50
    v_add_u32 v55, 117248, v55
    v_and_b32 v5, 1, v0
    v_mul_u32_u24 v5, 256, v5
    v_lshrrev_b32 v50, 4, v0
    v_lshl_add_u32 v5, v50, 3, v5
    v_add_u32 v5, 156928, v5
    s_waitcnt vmcnt(0)
    v_max_u32 v44, v10, v11
    v_max3_u32 v44, v44, v12, v13
    v_max3_u32 v44, v44, v14, v15
    v_max3_u32 v44, v44, v16, v17
    v_max3_u32 v44, v44, v18, v19
    v_cmp_eq_u32 vcc, -1, v44
    s_cbranch_vccz P21d
P21:
    buffer_load_dwordx2 v[18:19], v46, s[48:51], s60 offen offset:512 sc1
    buffer_load_dword v10, v47, s[48:51], s60 offen offset:0 sc1
    buffer_load_dword v11, v47, s[48:51], s60 offen offset:640 sc1
    buffer_load_dword v12, v47, s[48:51], s60 offen offset:1280 sc1
    buffer_load_dword v13, v47, s[48:51], s60 offen offset:1920 sc1
    buffer_load_dword v14, v47, s[48:51], s61 offen offset:0 sc1
    buffer_load_dword v15, v47, s[48:51], s61 offen offset:640 sc1
    buffer_load_dword v16, v47, s[48:51], s61 offen offset:1280 sc1
    buffer_load_dword v17, v47, s[48:51], s61 offen offset:1920 sc1
    s_waitcnt vmcnt(0)
    s_sub_u32 s6, s6, 1
    s_cselect_b32 s6, 0, s6
    s_cbranch_scc1 P21x
    v_max_u32 v44, v10, v11
    v_max3_u32 v44, v44, v12, v13
    v_max3_u32 v44, v44, v14, v15
    v_max3_u32 v44, v44, v16, v17
    v_max3_u32 v44, v44, v18, v19
    v_cmp_eq_u32 vcc, -1, v44
    s_cbranch_vccnz P21
P21x:
P21d:
    v_max_f32_dpp v20, v18, v18 quad_perm:[1,0,3,2] row_mask:0xf bank_mask:0xf
    s_nop 1
    v_max_f32_dpp v20, v20, v20 quad_perm:[2,3,0,1] row_mask:0xf bank_mask:0xf
    s_nop 1
    v_max_f32_dpp v20, v20, v20 row_half_mirror row_mask:0xf bank_mask:0xf
    v_sub_f32 v18, v18, v20
    v_exp_f32 v18, v18
    s_nop 0
    v_mul_f32 v19, v19, v18
    s_nop 0
    v_mul_f32_dpp v44, v18, v10 row_newbcast:0 row_mask:0xf bank_mask:0xf
    v_add_f32_dpp v19, v19, v19 quad_perm:[1,0,3,2] row_mask:0xf bank_mask:0xf
    v_fmac_f32_dpp v44, v18, v11 row_newbcast:1 row_mask:0xf bank_mask:0xf
    v_fmac_f32_dpp v44, v18, v12 row_newbcast:2 row_mask:0xf bank_mask:0xf
    v_add_f32_dpp v19, v19, v19 quad_perm:[2,3,0,1] row_mask:0xf bank_mask:0xf
    v_fmac_f32_dpp v44, v18, v13 row_newbcast:3 row_mask:0xf bank_mask:0xf
    v_fmac_f32_dpp v44, v18, v14 row_newbcast:4 row_mask:0xf bank_mask:0xf
    v_add_f32_dpp v19, v19, v19 row_half_mirror row_mask:0xf bank_mask:0xf
    v_fmac_f32_dpp v44, v18, v15 row_newbcast:5 row_mask:0xf bank_mask:0xf
    v_fmac_f32_dpp v44, v18, v16 row_newbcast:6 row_mask:0xf bank_mask:0xf
    v_rcp_f32 v19, v19
    v_fmac_f32_dpp v44, v18, v17 row_newbcast:7 row_mask:0xf bank_mask:0xf
    s_nop 0
    v_mul_f32_dpp v44, v19, v44 row_newbcast:0 row_mask:0xf bank_mask:0xf
    v_cvt_pk_bf16_f32 v44, v44, v44
    ds_write_b16 v45, v44
    v_lshl_add_u32 v47, s3, 5, v55
    ds_read_b64_tr_b16 v[28:29], v47 offset:0
    ds_read_b64_tr_b16 v[30:31], v47 offset:2304
    ds_read_b64_tr_b16 v[32:33], v47 offset:4608
    ds_read_b64_tr_b16 v[34:35], v47 offset:6912
    ds_read_b64_tr_b16 v[36:37], v47 offset:9216
    ds_read_b64_tr_b16 v[38:39], v47 offset:11520
    ds_read_b64_tr_b16 v[40:41], v47 offset:13824
    ds_read_b64_tr_b16 v[42:43], v47 offset:16128
    s_waitcnt lgkmcnt(8)
    s_barrier
    ds_read2_b64 v[10:13], v5 offset0:0 offset1:4
    ds_read2_b64 v[14:17], v5 offset0:8 offset1:12
    ds_read2_b64 v[18:21], v5 offset0:16 offset1:20
    ds_read2_b64 v[22:25], v5 offset0:24 offset1:28
    s_waitcnt lgkmcnt(0)
    v_mfma_f32_16x16x32_bf16 v[46:49], v[28:31], v[10:13], 0
    ds_read_b64_tr_b16 v[28:29], v55 offset:128
    ds_read_b64_tr_b16 v[30:31], v55 offset:2432
    v_mfma_f32_16x16x32_bf16 v[46:49], v[32:35], v[14:17], v[46:49]
    ds_read_b64_tr_b16 v[32:33], v55 offset:4736
    ds_read_b64_tr_b16 v[34:35], v55 offset:7040
    v_mfma_f32_16x16x32_bf16 v[46:49], v[36:39], v[18:21], v[46:49]
    ds_read_b64_tr_b16 v[36:37], v55 offset:9344
    ds_read_b64_tr_b16 v[38:39], v55 offset:11648
    v_mfma_f32_16x16x32_bf16 v[46:49], v[40:43], v[22:25], v[46:49]
    ds_read_b64_tr_b16 v[40:41], v55 offset:13952
    ds_read_b64_tr_b16 v[42:43], v55 offset:16256
    s_waitcnt lgkmcnt(0)
    v_mfma_f32_16x16x32_bf16 v[50:53], v[28:31], v[10:13], 0
    v_mfma_f32_16x16x32_bf16 v[50:53], v[32:35], v[14:17], v[50:53]
    v_mfma_f32_16x16x32_bf16 v[50:53], v[36:39], v[18:21], v[50:53]
    v_mfma_f32_16x16x32_bf16 v[50:53], v[40:43], v[22:25], v[50:53]
    s_nop 5
    s_mov_b32 vcc_lo, 0xc000c
    s_mov_b32 vcc_hi, 0xc000c
    v_cndmask_b32 v46, v46, v50, vcc
    v_cndmask_b32 v47, v47, v51, vcc
    v_cndmask_b32 v48, v48, v52, vcc
    v_cndmask_b32 v49, v49, v53, vcc
    buffer_store_dwordx4 v[46:49], v54, s[48:51], s64 offen sc1
    v_and_b32 v47, 15, v0
    v_bfe_u32 v44, v0, 3, 1
    v_mad_u32_u24 v46, v44, s3, v47
    v_lshlrev_b32 v46, 3, v46
    v_lshl_add_u32 v47, s3, 3, v47
    s_mul_i32 s7, s3, 7
    s_sub_u32 s7, 24, s7
    v_mad_u32_u24 v47, v44, s7, v47
    v_lshrrev_b32 v45, 5, v0
    v_lshlrev_b32 v45, 1, v45
    v_lshl_add_u32 v45, v47, 2, v45
    v_lshrrev_b32 v44, 4, v0
    v_lshl_add_u32 v46, v44, 12, v46
    s_mov_b32 vcc_lo, 0x1ff01ff
    s_mov_b32 vcc_hi, 0x1ff01ff
    v_bfrev_b32 v44, 1
    v_cndmask_b32 v46, v44, v46, vcc
    s_lshl_b32 s60, s5, 7
    s_add_u32 s60, s60, s3
    s_lshl_b32 s60, s60, 7
    s_add_u32 s60, s60, 1638400
    v_add_u32 v45, 156416, v45
    s_waitcnt vmcnt(0)
    buffer_load_dwordx2 v[10:11], v46, s[48:51], s60 offen offset:0 sc1
    buffer_load_dwordx2 v[12:13], v46, s[48:51], s60 offen offset:512 sc1
    buffer_load_dwordx2 v[14:15], v46, s[48:51], s60 offen offset:1024 sc1
    buffer_load_dwordx2 v[16:17], v46, s[48:51], s60 offen offset:1536 sc1
    buffer_load_dwordx2 v[18:19], v46, s[48:51], s60 offen offset:2048 sc1
    buffer_load_dwordx2 v[20:21], v46, s[48:51], s60 offen offset:2560 sc1
    buffer_load_dwordx2 v[22:23], v46, s[48:51], s60 offen offset:3072 sc1
    buffer_load_dwordx2 v[24:25], v46, s[48:51], s60 offen offset:3584 sc1
    v_and_b32 v48, 15, v0
    v_lshlrev_b32 v55, 1, v48
    s_mov_b32 s98, 0xa8888888
    v_lshrrev_b32_e64 v55, v55, s98
    v_and_b32 v55, 3, v55
    v_mul_u32_u24 v55, 160, v55
    v_lshrrev_b32 v49, 4, v0
    v_lshl_add_u32 v55, v49, 3, v55
    v_add_u32 v55, 156416, v55
    v_lshrrev_b32 v50, 1, v48
    v_and_b32 v52, 14, v48
    v_sub_u32 v48, v48, v52
    v_lshlrev_b32 v52, 31, v48
    v_lshl_add_u32 v52, v49, 4, v52
    v_lshl_add_u32 v52, v50, 6, v52
    s_mov_b32 s98, 6
    v_cmp_gt_u32 vcc, s98, v50
    v_or_b32 v48, 0x80000000, v52
    s_nop 0
    v_cndmask_b32 v52, v48, v52, vcc
    s_mul_i32 s64, s2, 1536
    s_mul_i32 s98, s3, 384
    s_add_u32 s64, s64, s98
    s_add_u32 s64, s64, 3342336
    v_lshrrev_b32 v54, 2, v0
    v_mul_u32_u24 v54, 288, v54
    v_and_b32 v48, 24, v1
    v_add_u32 v54, v54, v48
    s_lshr_b32 s98, s3, 1
    s_mul_i32 s98, s98, 20736
    s_and_b32 s99, s3, 1
    s_lshl_b32 s99, s99, 7
    s_add_u32 s98, s98, s99
    s_add_u32 s98, s98, 75776
    v_add_u32 v54, s98, v54
    v_lshl_add_u32 v26, s3, 6, v0
    v_bfrev_b32 v47, 1
    v_cmp_gt_u32 vcc, 5, v26
    v_lshlrev_b32 v27, 7, v26
    s_mul_i32 s98, s2, 640
    v_cndmask_b32 v27, v47, v27, vcc
    s_add_u32 s98, s98, 688128
    buffer_load_dword v53, v27, s[48:51], s98 offen sc1
    v_cmp_gt_u32 vcc, 12, v26
    v_lshlrev_b32 v27, 7, v26
    s_mul_i32 s98, s2, 1536
    v_cndmask_b32 v27, v47, v27, vcc
    s_add_u32 s98, s98, 3342336
    buffer_load_dword v53, v27, s[48:51], s98 offen sc1
    v_cmp_gt_u32 vcc, 5, v26
    v_lshlrev_b32 v27, 7, v26
    s_mul_i32 s98, s2, 640
    v_cndmask_b32 v27, v47, v27, vcc
    s_add_u32 s98, s98, 1343488
    buffer_load_dword v53, v27, s[48:51], s98 offen sc1
    v_cmp_gt_u32 vcc, 12, v26
    v_lshlrev_b32 v27, 7, v26
    s_mul_i32 s98, s2, 1536
    v_cndmask_b32 v27, v47, v27, vcc
    s_add_u32 s98, s98, 4128768
    buffer_load_dword v53, v27, s[48:51], s98 offen sc1
    s_waitcnt vmcnt(4)
    v_max_u32 v44, v10, v11
    v_max3_u32 v44, v44, v12, v13
    v_max3_u32 v44, v44, v14, v15
    v_max3_u32 v44, v44, v16, v17
    v_max3_u32 v44, v44, v18, v19
    v_max3_u32 v44, v44, v20, v21
    v_max3_u32 v44, v44, v22, v23
    v_max3_u32 v44, v44, v24, v25
    v_cmp_eq_u32 vcc, -1, v44
    s_cbranch_vccz P22d
P22:
    buffer_load_dwordx2 v[10:11], v46, s[48:51], s60 offen offset:0 sc1
    buffer_load_dwordx2 v[12:13], v46, s[48:51], s60 offen offset:512 sc1
    buffer_load_dwordx2 v[14:15], v46, s[48:51], s60 offen offset:1024 sc1
    buffer_load_dwordx2 v[16:17], v46, s[48:51], s60 offen offset:1536 sc1
    buffer_load_dwordx2 v[18:19], v46, s[48:51], s60 offen offset:2048 sc1
    buffer_load_dwordx2 v[20:21], v46, s[48:51], s60 offen offset:2560 sc1
    buffer_load_dwordx2 v[22:23], v46, s[48:51], s60 offen offset:3072 sc1
    buffer_load_dwordx2 v[24:25], v46, s[48:51], s60 offen offset:3584 sc1
    s_waitcnt vmcnt(0)
    s_sub_u32 s6, s6, 1
    s_cselect_b32 s6, 0, s6
    s_cbranch_scc1 P22x
    v_max_u32 v44, v10, v11
    v_max3_u32 v44, v44, v12, v13
    v_max3_u32 v44, v44, v14, v15
    v_max3_u32 v44, v44, v16, v17
    v_max3_u32 v44, v44, v18, v19
    v_max3_u32 v44, v44, v20, v21
    v_max3_u32 v44, v44, v22, v23
    v_max3_u32 v44, v44, v24, v25
    v_cmp_eq_u32 vcc, -1, v44
    s_cbranch_vccnz P22
P22x:
P22d:
    v_add_f32 v10, v10, v12
    v_add_f32 v11, v11, v13
    v_add_f32 v14, v14, v16
    v_add_f32 v15, v15, v17
    v_add_f32 v18, v18, v20
    v_add_f32 v19, v19, v21
    v_add_f32 v22, v22, v24
    v_add_f32 v23, v23, v25
    v_add_f32 v10, v10, v14
    v_add_f32 v11, v11, v15
    v_add_f32 v18, v18, v22
    v_add_f32 v19, v19, v23
    v_add_f32 v10, v10, v18
    v_add_f32 v11, v11, v19
    v_and_b32 v47, 0xffff0000, v4
    s_nop 0
    v_permlane32_swap_b32 v10, v11
    v_add_f32 v26, v10, v11
    v_add_f32 v27, v10, v11
    s_nop 1
    v_permlane16_swap_b32 v26, v27
    s_mov_b32 exec_lo, 0x1ff0000
    s_mov_b32 exec_hi, 0x1ff0000
    v_add_f32 v26, v26, v27
    v_add_f32 v26, v26, v47
    v_cvt_pk_bf16_f32 v4, v26, v26
    ds_write_b16 v45, v4
    s_mov_b64 exec, -1
    ds_read_b64_tr_b16 v[20:21], v54 offset:0
    ds_read_b64_tr_b16 v[22:23], v54 offset:4608
    ds_read_b64_tr_b16 v[24:25], v54 offset:9216
    ds_read_b64_tr_b16 v[26:27], v54 offset:13824
    ds_read_b64_tr_b16 v[28:29], v54 offset:18432
    ds_read_b64_tr_b16 v[30:31], v54 offset:32
    ds_read_b64_tr_b16 v[32:33], v54 offset:4640
    ds_read_b64_tr_b16 v[34:35], v54 offset:9248
    ds_read_b64_tr_b16 v[36:37], v54 offset:13856
    ds_read_b64_tr_b16 v[38:39], v54 offset:18464
    s_waitcnt lgkmcnt(10)
    s_barrier
    ds_read2_b64 v[10:13], v55 offset0:0 offset1:4
    ds_read2_b64 v[14:17], v55 offset0:8 offset1:12
    ds_read_b64 v[18:19], v55 offset:128
    s_waitcnt lgkmcnt(0)
    v_mfma_f32_16x16x32_bf16 v[40:43], v[10:13], v[10:13], 0
    v_mfma_f32_16x16x32_bf16 v[44:47], v[20:23], v[10:13], 0
    v_mfma_f32_16x16x32_bf16 v[48:51], v[30:33], v[10:13], 0
    v_mfma_f32_16x16x32_bf16 v[40:43], v[14:17], v[14:17], v[40:43]
    v_mfma_f32_16x16x32_bf16 v[44:47], v[24:27], v[14:17], v[44:47]
    v_mfma_f32_16x16x32_bf16 v[48:51], v[34:37], v[14:17], v[48:51]
    s_nop 4
    v_mfma_f32_16x16x16_bf16 v[40:43], v[18:19], v[18:19], v[40:43]
    v_mfma_f32_16x16x16_bf16 v[44:47], v[28:29], v[18:19], v[44:47]
    v_mfma_f32_16x16x16_bf16 v[48:51], v[38:39], v[18:19], v[48:51]
    ds_read_b64_tr_b16 v[20:21], v54 offset:64
    ds_read_b64_tr_b16 v[22:23], v54 offset:4672
    ds_read_b64_tr_b16 v[24:25], v54 offset:9280
    ds_read_b64_tr_b16 v[26:27], v54 offset:13888
    ds_read_b64_tr_b16 v[28:29], v54 offset:18496
    ds_read_b64_tr_b16 v[30:31], v54 offset:96
    ds_read_b64_tr_b16 v[32:33], v54 offset:4704
    ds_read_b64_tr_b16 v[34:35], v54 offset:9312
    ds_read_b64_tr_b16 v[36:37], v54 offset:13920
    ds_read_b64_tr_b16 v[38:39], v54 offset:18528
    s_mov_b32 vcc_lo, 0x30003
    s_mov_b32 vcc_hi, 0x30003
    v_cndmask_b32 v40, v40, v44, vcc
    v_cndmask_b32 v41, v41, v45, vcc
    v_cndmask_b32 v42, v42, v46, vcc
    v_cndmask_b32 v43, v43, v47, vcc
    s_mov_b32 vcc_lo, 0xc000c
    s_mov_b32 vcc_hi, 0xc000c
    v_cndmask_b32 v40, v40, v48, vcc
    v_cndmask_b32 v41, v41, v49, vcc
    v_cndmask_b32 v42, v42, v50, vcc
    v_cndmask_b32 v43, v43, v51, vcc
    s_waitcnt lgkmcnt(0)
    v_mfma_f32_16x16x32_bf16 v[44:47], v[20:23], v[10:13], 0
    v_mfma_f32_16x16x32_bf16 v[48:51], v[30:33], v[10:13], 0
    v_mfma_f32_16x16x32_bf16 v[44:47], v[24:27], v[14:17], v[44:47]
    v_mfma_f32_16x16x32_bf16 v[48:51], v[34:37], v[14:17], v[48:51]
    s_nop 5
    v_mfma_f32_16x16x16_bf16 v[44:47], v[28:29], v[18:19], v[44:47]
    v_mfma_f32_16x16x16_bf16 v[48:51], v[38:39], v[18:19], v[48:51]
    ds_read_b64_tr_b16 v[20:21], v54 offset:128
    ds_read_b64_tr_b16 v[22:23], v54 offset:4736
    ds_read_b64_tr_b16 v[24:25], v54 offset:9344
    ds_read_b64_tr_b16 v[26:27], v54 offset:13952
    ds_read_b64_tr_b16 v[28:29], v54 offset:18560
    s_nop 0
    s_mov_b32 vcc_lo, 0x300030
    s_mov_b32 vcc_hi, 0x300030
    v_cndmask_b32 v40, v40, v44, vcc
    v_cndmask_b32 v41, v41, v45, vcc
    v_cndmask_b32 v42, v42, v46, vcc
    v_cndmask_b32 v43, v43, v47, vcc
    s_mov_b32 vcc_lo, 0xc000c0
    s_mov_b32 vcc_hi, 0xc000c0
    v_cndmask_b32 v40, v40, v48, vcc
    v_cndmask_b32 v41, v41, v49, vcc
    v_cndmask_b32 v42, v42, v50, vcc
    v_cndmask_b32 v43, v43, v51, vcc
    s_waitcnt lgkmcnt(0)
    v_mfma_f32_16x16x32_bf16 v[44:47], v[20:23], v[10:13], 0
    v_mfma_f32_16x16x32_bf16 v[44:47], v[24:27], v[14:17], v[44:47]
    s_nop 6
    v_mfma_f32_16x16x16_bf16 v[44:47], v[28:29], v[18:19], v[44:47]
    s_nop 5
    s_mov_b32 vcc_lo, 0x3000300
    s_mov_b32 vcc_hi, 0x3000300
    v_cndmask_b32 v40, v40, v44, vcc
    v_cndmask_b32 v41, v41, v45, vcc
    v_cndmask_b32 v42, v42, v46, vcc
    v_cndmask_b32 v43, v43, v47, vcc
    s_cmp_eq_u32 s97, 0
    s_cbranch_scc1 Y23
    buffer_store_dwordx4 v[40:43], v52, s[48:51], s64 offen
Y23d:
    s_waitcnt vmcnt(1)
    v_and_b32 v51, 15, v0
    s_mul_i32 s7, s3, 9
    v_add_u32 v51, s7, v51
    v_cmp_lt_u32 vcc, 19, v51
    v_lshrrev_b32 v53, 4, v0
    v_mul_u32_u24 v52, 768, v53
    v_lshl_add_u32 v52, v51, 4, v52
    v_add_u32 v50, 128, v52
    v_cndmask_b32 v52, v52, v50, vcc
    s_mov_b32 vcc_lo, 0x1ff01ff
    s_mov_b32 vcc_hi, 0x1ff01ff
    v_bfrev_b32 v50, 1
    v_cndmask_b32 v52, v50, v52, vcc
    v_bfrev_b32 v53, v53
    v_lshrrev_b32 v53, 29, v53
    v_lshl_add_u32 v51, v51, 3, v53
    v_add_u32 v51, 157440, v51
    v_mul_u32_u24 v53, 1536, v0
    v_cmp_gt_u32 vcc, 8, v0
    v_or_b32 v50, 0x80000000, v53
    s_nop 0
    v_cndmask_b32 v53, v50, v53, vcc
    s_mul_i32 s7, s4, 12288
    s_add_u32 s60, s7, 3342336
    s_add_u32 s61, s7, 3348480
    s_waitcnt vmcnt(0)
    buffer_load_dwordx4 v[46:49], v53, s[48:51], s60 offen offset:368 sc1
    buffer_load_dwordx4 v[10:13], v52, s[48:51], s60 offen offset:0 sc1
    buffer_load_dwordx4 v[14:17], v52, s[48:51], s60 offen offset:3072 sc1
    buffer_load_dwordx4 v[18:21], v52, s[48:51], s61 offen offset:0 sc1
    buffer_load_dwordx4 v[22:25], v52, s[48:51], s61 offen offset:3072 sc1
    v_and_b32 v50, 1, v0
    v_lshlrev_b32 v54, 31, v50
    v_and_b32 v50, 2, v0
    v_lshl_add_u32 v54, v50, 5, v54
    v_and_b32 v50, 48, v0
    v_add_u32 v54, v54, v50
    s_mov_b32 vcc_lo, 0xf000f
    s_mov_b32 vcc_hi, 0xf000f
    v_bfrev_b32 v50, 1
    v_cndmask_b32 v54, v50, v54, vcc
    s_lshl_b32 s64, s5, 5
    s_add_u32 s64, s64, s4
    s_lshl_b32 s64, s64, 2
    s_add_u32 s64, s64, s3
    s_lshl_b32 s64, s64, 7
    s_add_u32 s64, s64, 2162688
    v_lshrrev_b32 v55, 2, v0
    v_mul_u32_u24 v55, 144, v55
    v_and_b32 v50, 24, v1
    v_add_u32 v55, v55, v50
    v_add_u32 v55, 135680, v55
    v_and_b32 v5, 1, v0
    v_mul_u32_u24 v5, 288, v5
    v_lshrrev_b32 v50, 4, v0
    v_lshl_add_u32 v5, v50, 3, v5
    v_add_u32 v5, 157440, v5
    s_waitcnt vmcnt(0)
    v_max_u32 v50, v46, v48
    v_max3_u32 v50, v50, v10, v11
    v_max3_u32 v50, v50, v12, v13
    v_max3_u32 v50, v50, v14, v15
    v_max3_u32 v50, v50, v16, v17
    v_max3_u32 v50, v50, v18, v19
    v_max3_u32 v50, v50, v20, v21
    v_max3_u32 v50, v50, v22, v23
    v_max3_u32 v50, v50, v24, v25
    v_cmp_eq_u32 vcc, -1, v50
    s_cbranch_vccz P24d
P24:
    buffer_load_dwordx4 v[46:49], v53, s[48:51], s60 offen offset:368 sc1
    buffer_load_dwordx4 v[10:13], v52, s[48:51], s60 offen offset:0 sc1
    buffer_load_dwordx4 v[14:17], v52, s[48:51], s60 offen offset:3072 sc1
    buffer_load_dwordx4 v[18:21], v52, s[48:51], s61 offen offset:0 sc1
    buffer_load_dwordx4 v[22:25], v52, s[48:51], s61 offen offset:3072 sc1
    s_waitcnt vmcnt(0)
    s_sub_u32 s6, s6, 1
    s_cselect_b32 s6, 0, s6
    s_cbranch_scc1 P24x
    v_max_u32 v50, v46, v48
    v_max3_u32 v50, v50, v10, v11
    v_max3_u32 v50, v50, v12, v13
    v_max3_u32 v50, v50, v14, v15
    v_max3_u32 v50, v50, v16, v17
    v_max3_u32 v50, v50, v18, v19
    v_max3_u32 v50, v50, v20, v21
    v_max3_u32 v50, v50, v22, v23
    v_max3_u32 v50, v50, v24, v25
    v_cmp_eq_u32 vcc, -1, v50
    s_cbranch_vccnz P24
P24x:
P24d:
    v_add_f32 v10, v10, v14
    v_add_f32 v11, v11, v15
    v_add_f32_dpp v46, v46, v46 quad_perm:[1,0,3,2] row_mask:0xf bank_mask:0xf
    v_add_f32 v12, v12, v16
    v_add_f32_dpp v48, v48, v48 quad_perm:[1,0,3,2] row_mask:0xf bank_mask:0xf
    v_add_f32 v13, v13, v17
    v_add_f32_dpp v46, v46, v46 quad_perm:[2,3,0,1] row_mask:0xf bank_mask:0xf
    v_add_f32 v18, v18, v22
    v_add_f32_dpp v48, v48, v48 quad_perm:[2,3,0,1] row_mask:0xf bank_mask:0xf
    v_add_f32 v19, v19, v23
    v_add_f32_dpp v46, v46, v46 row_half_mirror row_mask:0xf bank_mask:0xf
    v_add_f32 v20, v20, v24
    v_add_f32_dpp v48, v48, v48 row_half_mirror row_mask:0xf bank_mask:0xf
    v_add_f32 v21, v21, v25
    v_mul_f32 v48, 0x3ae38e39, v48
    v_add_f32 v10, v10, v18
    v_mul_f32 v46, 0x3ae38e39, v46
    v_add_f32 v11, v11, v19
    v_fma_f32 v46, -v48, v48, v46
    v_add_f32 v12, v12, v20
    v_max_f32 v46, 0, v46
    v_add_f32 v13, v13, v21
    v_add_f32 v46, 0x3727c5ac, v46
    v_permlane32_swap_b32 v10, v11
    v_rsq_f32 v46, v46
    v_permlane32_swap_b32 v12, v13
    v_readfirstlane_b32 s0, v48
    v_add_f32 v10, v10, v11
    v_readfirstlane_b32 s1, v46
    v_add_f32 v11, v12, v13
    s_nop 1
    v_permlane16_swap_b32 v10, v11
    v_fma_f32 v10, -s0, v6, v10
    v_mul_f32 v10, s1, v10
    v_fma_f32 v11, -s0, v7, v11
    v_mul_f32 v11, s1, v11
    v_mul_f32 v12, v10, v10
    v_mov_b32 v13, 0xc0135761
    v_fmac_f32 v13, 0xbdd2d3e8, v12
    v_mul_f32 v13, v13, v10
    v_exp_f32 v13, v13
    v_mul_f32 v10, v10, v11
    v_add_f32 v13, 1.0, v13
    v_rcp_f32 v13, v13
    s_nop 0
    v_mul_f32 v50, v10, v13
    v_cvt_pk_bf16_f32 v50, v50, v50
    s_mov_b32 exec_lo, 0x1ff01ff
    s_mov_b32 exec_hi, 0x1ff01ff
    ds_write_b16 v51, v50
    s_mov_b64 exec, -1
    v_lshl_add_u32 v47, s3, 5, v55
    ds_read_b64_tr_b16 v[28:29], v47 offset:0
    ds_read_b64_tr_b16 v[30:31], v47 offset:2304
    ds_read_b64_tr_b16 v[32:33], v47 offset:4608
    ds_read_b64_tr_b16 v[34:35], v47 offset:6912
    ds_read_b64_tr_b16 v[36:37], v47 offset:9216
    ds_read_b64_tr_b16 v[38:39], v47 offset:11520
    ds_read_b64_tr_b16 v[40:41], v47 offset:13824
    ds_read_b64_tr_b16 v[42:43], v47 offset:16128
    ds_read_b64_tr_b16 v[44:45], v47 offset:18432
    s_waitcnt lgkmcnt(9)
    s_barrier
    ds_read2_b64 v[10:13], v5 offset0:0 offset1:4
    ds_read2_b64 v[14:17], v5 offset0:8 offset1:12
    ds_read2_b64 v[18:21], v5 offset0:16 offset1:20
    ds_read2_b64 v[22:25], v5 offset0:24 offset1:28
    ds_read_b64 v[26:27], v5 offset:256
    s_waitcnt lgkmcnt(0)
    v_mfma_f32_16x16x32_bf16 v[46:49], v[28:31], v[10:13], 0
    ds_read_b64_tr_b16 v[28:29], v55 offset:128
    ds_read_b64_tr_b16 v[30:31], v55 offset:2432
    v_mfma_f32_16x16x32_bf16 v[46:49], v[32:35], v[14:17], v[46:49]
    ds_read_b64_tr_b16 v[32:33], v55 offset:4736
    ds_read_b64_tr_b16 v[34:35], v55 offset:7040
    v_mfma_f32_16x16x32_bf16 v[46:49], v[36:39], v[18:21], v[46:49]
    ds_read_b64_tr_b16 v[36:37], v55 offset:9344
    ds_read_b64_tr_b16 v[38:39], v55 offset:11648
    v_mfma_f32_16x16x32_bf16 v[46:49], v[40:43], v[22:25], v[46:49]
    ds_read_b64_tr_b16 v[40:41], v55 offset:13952
    ds_read_b64_tr_b16 v[42:43], v55 offset:16256
    s_nop 6
    v_mfma_f32_16x16x16_bf16 v[46:49], v[44:45], v[26:27], v[46:49]
    ds_read_b64_tr_b16 v[44:45], v55 offset:18560
    s_waitcnt lgkmcnt(0)
    v_mfma_f32_16x16x32_bf16 v[50:53], v[28:31], v[10:13], 0
    v_mfma_f32_16x16x32_bf16 v[50:53], v[32:35], v[14:17], v[50:53]
    v_mfma_f32_16x16x32_bf16 v[50:53], v[36:39], v[18:21], v[50:53]
    v_mfma_f32_16x16x32_bf16 v[50:53], v[40:43], v[22:25], v[50:53]
    s_nop 6
    v_mfma_f32_16x16x16_bf16 v[50:53], v[44:45], v[26:27], v[50:53]
    s_nop 5
    s_mov_b32 vcc_lo, 0xc000c
    s_mov_b32 vcc_hi, 0xc000c
    v_cndmask_b32 v46, v46, v50, vcc
    v_cndmask_b32 v47, v47, v51, vcc
    v_cndmask_b32 v48, v48, v52, vcc
    v_cndmask_b32 v49, v49, v53, vcc
    buffer_store_dwordx4 v[46:49], v54, s[48:51], s64 offen sc1
    v_and_b32 v47, 15, v0
    v_bfe_u32 v44, v0, 3, 1
    v_mad_u32_u24 v46, v44, s3, v47
    v_lshlrev_b32 v46, 3, v46
    v_lshl_add_u32 v47, s3, 3, v47
    s_mul_i32 s7, s3, 7
    s_sub_u32 s7, 24, s7
    v_mad_u32_u24 v47, v44, s7, v47
    v_lshrrev_b32 v45, 5, v0
    v_lshlrev_b32 v45, 1, v45
    v_lshl_add_u32 v45, v47, 2, v45
    v_lshrrev_b32 v44, 4, v0
    v_lshl_add_u32 v46, v44, 12, v46
    s_mov_b32 vcc_lo, 0x1ff01ff
    s_mov_b32 vcc_hi, 0x1ff01ff
    v_bfrev_b32 v44, 1
    v_cndmask_b32 v46, v44, v46, vcc
    s_lshl_b32 s60, s5, 7
    s_add_u32 s60, s60, s3
    s_lshl_b32 s60, s60, 7
    s_add_u32 s60, s60, 2162688
    v_add_u32 v45, 156416, v45
    s_waitcnt vmcnt(0)
    buffer_load_dwordx2 v[10:11], v46, s[48:51], s60 offen offset:0 sc1
    buffer_load_dwordx2 v[12:13], v46, s[48:51], s60 offen offset:512 sc1
    buffer_load_dwordx2 v[14:15], v46, s[48:51], s60 offen offset:1024 sc1
    buffer_load_dwordx2 v[16:17], v46, s[48:51], s60 offen offset:1536 sc1
    buffer_load_dwordx2 v[18:19], v46, s[48:51], s60 offen offset:2048 sc1
    buffer_load_dwordx2 v[20:21], v46, s[48:51], s60 offen offset:2560 sc1
    buffer_load_dwordx2 v[22:23], v46, s[48:51], s60 offen offset:3072 sc1
    buffer_load_dwordx2 v[24:25], v46, s[48:51], s60 offen offset:3584 sc1
    v_and_b32 v48, 15, v0
    v_lshlrev_b32 v55, 1, v48
    s_mov_b32 s98, 0xa8888888
    v_lshrrev_b32_e64 v55, v55, s98
    v_and_b32 v55, 3, v55
    v_mul_u32_u24 v55, 160, v55
    v_lshrrev_b32 v49, 4, v0
    v_lshl_add_u32 v55, v49, 3, v55
    v_add_u32 v55, 156416, v55
    v_lshrrev_b32 v50, 1, v48
    v_and_b32 v52, 14, v48
    v_sub_u32 v48, v48, v52
    v_lshlrev_b32 v52, 31, v48
    v_lshl_add_u32 v52, v49, 4, v52
    v_lshl_add_u32 v52, v50, 6, v52
    v_lshrrev_b32 v48, 1, v50
    v_mul_u32_u24 v48, 384, v48
    v_add_u32 v52, v52, v48
    s_cmp_eq_u32 s3, 0
    s_cselect_b32 s98, 4, 2
    v_cmp_gt_u32 vcc, s98, v50
    v_or_b32 v48, 0x80000000, v52
    s_nop 0
    v_cndmask_b32 v52, v48, v52, vcc
    s_mul_i32 s64, s2, 640
    s_mul_i32 s98, s3, 128
    s_add_u32 s64, s64, s98
    s_add_u32 s64, s64, 688128
    v_lshrrev_b32 v54, 2, v0
    v_mul_u32_u24 v54, 256, v54
    v_and_b32 v48, 24, v1
    v_add_u32 v54, v54, v48
    v_bfe_u32 v48, v0, 2, 3
    s_lshl_b32 s99, s3, 1
    v_xor_b32 v48, s99, v48
    v_lshl_add_u32 v54, v48, 5, v54
    v_xor_b32 v51, 32, v54
    v_add_u32 v54, 0, v54
    v_add_u32 v51, 0, v51
    s_waitcnt vmcnt(0)
    v_max_u32 v44, v10, v11
    v_max3_u32 v44, v44, v12, v13
    v_max3_u32 v44, v44, v14, v15
    v_max3_u32 v44, v44, v16, v17
    v_max3_u32 v44, v44, v18, v19
    v_max3_u32 v44, v44, v20, v21
    v_max3_u32 v44, v44, v22, v23
    v_max3_u32 v44, v44, v24, v25
    v_cmp_eq_u32 vcc, -1, v44
    s_cbranch_vccz P25d
P25:
    buffer_load_dwordx2 v[10:11], v46, s[48:51], s60 offen offset:0 sc1
    buffer_load_dwordx2 v[12:13], v46, s[48:51], s60 offen offset:512 sc1
    buffer_load_dwordx2 v[14:15], v46, s[48:51], s60 offen offset:1024 sc1
    buffer_load_dwordx2 v[16:17], v46, s[48:51], s60 offen offset:1536 sc1
    buffer_load_dwordx2 v[18:19], v46, s[48:51], s60 offen offset:2048 sc1
    buffer_load_dwordx2 v[20:21], v46, s[48:51], s60 offen offset:2560 sc1
    buffer_load_dwordx2 v[22:23], v46, s[48:51], s60 offen offset:3072 sc1
    buffer_load_dwordx2 v[24:25], v46, s[48:51], s60 offen offset:3584 sc1
    s_waitcnt vmcnt(0)
    s_sub_u32 s6, s6, 1
    s_cselect_b32 s6, 0, s6
    s_cbranch_scc1 P25x
    v_max_u32 v44, v10, v11
    v_max3_u32 v44, v44, v12, v13
    v_max3_u32 v44, v44, v14, v15
    v_max3_u32 v44, v44, v16, v17
    v_max3_u32 v44, v44, v18, v19
    v_max3_u32 v44, v44, v20, v21
    v_max3_u32 v44, v44, v22, v23
    v_max3_u32 v44, v44, v24, v25
    v_cmp_eq_u32 vcc, -1, v44
    s_cbranch_vccnz P25
P25x:
P25d:
    v_add_f32 v10, v10, v12
    v_add_f32 v11, v11, v13
    v_add_f32 v14, v14, v16
    v_add_f32 v15, v15, v17
    v_add_f32 v18, v18, v20
    v_add_f32 v19, v19, v21
    v_add_f32 v22, v22, v24
    v_add_f32 v23, v23, v25
    v_add_f32 v10, v10, v14
    v_add_f32 v11, v11, v15
    v_add_f32 v18, v18, v22
    v_add_f32 v19, v19, v23
    v_add_f32 v10, v10, v18
    v_add_f32 v11, v11, v19
    v_and_b32 v47, 0xffff0000, v4
    s_nop 0
    v_permlane32_swap_b32 v10, v11
    v_add_f32 v26, v10, v11
    v_add_f32 v27, v10, v11
    s_nop 1
    v_permlane16_swap_b32 v26, v27
    s_mov_b32 exec_lo, 0x1ff0000
    s_mov_b32 exec_hi, 0x1ff0000
    v_add_f32 v26, v26, v27
    v_add_f32 v26, v26, v47
    v_cvt_pk_bf16_f32 v4, v26, v26
    ds_write_b16 v45, v4
    s_mov_b64 exec, -1
    ds_read_b64_tr_b16 v[20:21], v54 offset:0
    ds_read_b64_tr_b16 v[22:23], v54 offset:4096
    ds_read_b64_tr_b16 v[24:25], v54 offset:8192
    ds_read_b64_tr_b16 v[26:27], v54 offset:12288
    ds_read_b64_tr_b16 v[28:29], v54 offset:16384
    ds_read_b64_tr_b16 v[30:31], v51 offset:0
    ds_read_b64_tr_b16 v[32:33], v51 offset:4096
    ds_read_b64_tr_b16 v[34:35], v51 offset:8192
    ds_read_b64_tr_b16 v[36:37], v51 offset:12288
    ds_read_b64_tr_b16 v[38:39], v51 offset:16384
    s_waitcnt lgkmcnt(10)
    s_barrier
    ds_read2_b64 v[10:13], v55 offset0:0 offset1:4
    ds_read2_b64 v[14:17], v55 offset0:8 offset1:12
    ds_read_b64 v[18:19], v55 offset:128
    s_waitcnt lgkmcnt(0)
    v_mfma_f32_16x16x32_bf16 v[40:43], v[10:13], v[10:13], 0
    v_mfma_f32_16x16x32_bf16 v[44:47], v[20:23], v[10:13], 0
    v_mfma_f32_16x16x32_bf16 v[48:51], v[30:33], v[10:13], 0
    v_mfma_f32_16x16x32_bf16 v[40:43], v[14:17], v[14:17], v[40:43]
    v_mfma_f32_16x16x32_bf16 v[44:47], v[24:27], v[14:17], v[44:47]
    v_mfma_f32_16x16x32_bf16 v[48:51], v[34:37], v[14:17], v[48:51]
    s_nop 4
    v_mfma_f32_16x16x16_bf16 v[40:43], v[18:19], v[18:19], v[40:43]
    v_mfma_f32_16x16x16_bf16 v[44:47], v[28:29], v[18:19], v[44:47]
    v_mfma_f32_16x16x16_bf16 v[48:51], v[38:39], v[18:19], v[48:51]
    s_nop 5
    s_mov_b32 vcc_lo, 0x30003
    s_mov_b32 vcc_hi, 0x30003
    v_cndmask_b32 v40, v40, v44, vcc
    v_cndmask_b32 v41, v41, v45, vcc
    v_cndmask_b32 v42, v42, v46, vcc
    v_cndmask_b32 v43, v43, v47, vcc
    s_mov_b32 vcc_lo, 0xc000c
    s_mov_b32 vcc_hi, 0xc000c
    v_cndmask_b32 v40, v40, v48, vcc
    v_cndmask_b32 v41, v41, v49, vcc
    v_cndmask_b32 v42, v42, v50, vcc
    v_cndmask_b32 v43, v43, v51, vcc
    s_cmp_eq_u32 s97, 0
    s_cbranch_scc1 Y26
    buffer_store_dwordx4 v[40:43], v52, s[48:51], s64 offen
Y26d:
    v_lshrrev_b32 v46, 3, v0
    v_mul_u32_u24 v46, 640, v46
    v_and_b32 v45, 7, v0
    v_lshl_add_u32 v45, s3, 3, v45
    v_lshl_add_u32 v47, v45, 4, v46
    s_mul_i32 s60, s4, 5120
    s_add_u32 s60, s60, 688128
    v_mul_u32_u24 v46, 640, v0
    v_cmp_gt_u32 vcc, 8, v0
    v_or_b32 v44, 0x80000000, v46
    s_nop 0
    v_cndmask_b32 v46, v44, v46, vcc
    s_waitcnt vmcnt(0)
    buffer_load_dwordx4 v[18:21], v46, s[48:51], s60 offen offset:560 sc1
    buffer_load_dwordx4 v[10:13], v47, s[48:51], s60 offen offset:0 sc1
    v_lshrrev_b32 v5, 4, v0
    v_and_b32 v9, 3, v0
    v_lshl_add_u32 v5, v5, 2, v9
    v_lshlrev_b32 v5, 4, v5
    v_add_u32 v5, 162688, v5
    v_lshl_add_u32 v9, v1, 1, s62
    ds_read_b128 v[28:31], v9 offset:0
    ds_read_b128 v[52:55], v9 offset:1024
    ds_read_b128 v[32:35], v9 offset:2048
    ds_read_b128 v[40:43], v9 offset:3072
    ds_read_b128 v[36:39], v9 offset:4096
    v_lshrrev_b32 v44, 4, v0
    v_bfrev_b32 v44, v44
    v_lshrrev_b32 v44, 29, v44
    v_lshl_add_u32 v45, v45, 3, v44
    v_add_u32 v45, 162688, v45
    s_waitcnt vmcnt(0)
    v_max_u32 v44, v10, v11
    v_max3_u32 v44, v44, v12, v13
    v_max3_u32 v44, v44, v18, v20
    v_cmp_eq_u32 vcc, -1, v44
    s_cbranch_vccz P27d
P27:
    buffer_load_dwordx4 v[18:21], v46, s[48:51], s60 offen offset:560 sc1
    buffer_load_dwordx4 v[10:13], v47, s[48:51], s60 offen offset:0 sc1
    s_waitcnt vmcnt(0)
    s_sub_u32 s6, s6, 1
    s_cselect_b32 s6, 0, s6
    s_cbranch_scc1 P27x
    v_max_u32 v44, v10, v11
    v_max3_u32 v44, v44, v12, v13
    v_max3_u32 v44, v44, v18, v20
    v_cmp_eq_u32 vcc, -1, v44
    s_cbranch_vccnz P27
P27x:
P27d:
    v_permlane32_swap_b32 v10, v11
    v_permlane32_swap_b32 v12, v13
    v_add_f32_dpp v18, v18, v18 quad_perm:[1,0,3,2] row_mask:0xf bank_mask:0xf
    v_add_f32 v10, v10, v11
    v_add_f32_dpp v20, v20, v20 quad_perm:[1,0,3,2] row_mask:0xf bank_mask:0xf
    v_add_f32 v11, v12, v13
    v_add_f32_dpp v18, v18, v18 quad_perm:[2,3,0,1] row_mask:0xf bank_mask:0xf
    v_add_f32_dpp v20, v20, v20 quad_perm:[2,3,0,1] row_mask:0xf bank_mask:0xf
    v_permlane16_swap_b32 v10, v11
    v_add_f32_dpp v18, v18, v18 row_half_mirror row_mask:0xf bank_mask:0xf
    v_add_f32 v10, v10, v11
    v_add_f32_dpp v20, v20, v20 row_half_mirror row_mask:0xf bank_mask:0xf
    v_mul_f32 v20, 0x3ae38e39, v20
    v_add_f32_dpp v10, v10, v10 row_ror:8 row_mask:0xf bank_mask:0xf
    v_mul_f32 v18, 0x3ae38e39, v18
    v_fma_f32 v18, -v20, v20, v18
    v_max_f32 v18, 0, v18
    v_add_f32 v18, 0x3727c5ac, v18
    v_rsq_f32 v18, v18
    v_readfirstlane_b32 s0, v20
    v_readfirstlane_b32 s1, v18
    s_nop 0
    v_fma_f32 v10, -s0, v8, v10
    v_mul_f32 v10, s1, v10
    v_cvt_pk_bf16_f32 v10, v10, v10
    ds_write_b16 v45, v10
    s_waitcnt lgkmcnt(0)
    s_barrier
    ds_read_b128 v[48:51], v5
    s_waitcnt lgkmcnt(0)
    v_cndmask_b32 v12, 0, v48, s[52:53]
    v_cndmask_b32 v13, 0, v49, s[52:53]
    v_cndmask_b32 v14, 0, v50, s[52:53]
    v_cndmask_b32 v15, 0, v51, s[52:53]
    v_cndmask_b32 v16, 0, v48, s[54:55]
    v_cndmask_b32 v17, 0, v49, s[54:55]
    v_cndmask_b32 v18, 0, v50, s[54:55]
    v_cndmask_b32 v19, 0, v51, s[54:55]
    s_waitcnt lgkmcnt(2)
    v_mfma_f32_16x16x32_bf16 v[44:47], v[28:31], v[12:15], 0
    v_cndmask_b32 v20, 0, v48, s[56:57]
    v_cndmask_b32 v21, 0, v49, s[56:57]
    v_cndmask_b32 v22, 0, v50, s[56:57]
    v_cndmask_b32 v23, 0, v51, s[56:57]
    v_mfma_f32_16x16x32_bf16 v[44:47], v[56:59], v[16:19], v[44:47]
    v_cndmask_b32 v24, 0, v48, s[58:59]
    v_cndmask_b32 v25, 0, v49, s[58:59]
    v_cndmask_b32 v26, 0, v50, s[58:59]
    v_cndmask_b32 v27, 0, v51, s[58:59]
    s_waitcnt lgkmcnt(2)
    v_mfma_f32_16x16x32_bf16 v[44:47], v[52:55], v[20:23], v[44:47]
    s_nop 0
    v_mfma_f32_16x16x32_bf16 v[44:47], v[60:63], v[24:27], v[44:47]
    s_waitcnt lgkmcnt(2)
    v_mfma_f32_16x16x32_bf16 v[48:51], v[32:35], v[12:15], 0
    ds_read_b128 v[32:35], v9 offset:5120
    v_mfma_f32_16x16x32_bf16 v[48:51], v[64:67], v[16:19], v[48:51]
    s_waitcnt lgkmcnt(2)
    v_mfma_f32_16x16x32_bf16 v[48:51], v[40:43], v[20:23], v[48:51]
    ds_read_b128 v[40:43], v9 offset:6144
    v_mfma_f32_16x16x32_bf16 v[48:51], v[68:71], v[24:27], v[48:51]
    s_waitcnt lgkmcnt(2)
    v_mfma_f32_16x16x32_bf16 v[52:55], v[36:39], v[12:15], 0
    ds_read_b128 v[36:39], v9 offset:7168
    v_mov_b32_dpp v28, v44 quad_perm:[0,0,0,0] row_mask:0xf bank_mask:0xf
    v_mfma_f32_16x16x32_bf16 v[52:55], v[72:75], v[16:19], v[52:55]
    v_add_f32_dpp v28, v45, v28 quad_perm:[1,1,1,1] row_mask:0xf bank_mask:0xf
    s_waitcnt lgkmcnt(2)
    v_mfma_f32_16x16x32_bf16 v[52:55], v[32:35], v[20:23], v[52:55]
    ds_read_b128 v[32:35], v9 offset:8192
    v_add_f32_dpp v28, v46, v28 quad_perm:[2,2,2,2] row_mask:0xf bank_mask:0xf
    v_mfma_f32_16x16x32_bf16 v[52:55], v[76:79], v[24:27], v[52:55]
    v_add_f32_dpp v28, v47, v28 quad_perm:[3,3,3,3] row_mask:0xf bank_mask:0xf
    v_max_f32 v10, v28, v28
    s_waitcnt lgkmcnt(2)
    v_mfma_f32_16x16x32_bf16 v[44:47], v[40:43], v[12:15], 0
    ds_read_b128 v[40:43], v9 offset:9216
    v_mov_b32_dpp v29, v48 quad_perm:[0,0,0,0] row_mask:0xf bank_mask:0xf
    v_mfma_f32_16x16x32_bf16 v[44:47], v[80:83], v[16:19], v[44:47]
    v_add_f32_dpp v29, v49, v29 quad_perm:[1,1,1,1] row_mask:0xf bank_mask:0xf
    s_waitcnt lgkmcnt(2)
    v_mfma_f32_16x16x32_bf16 v[44:47], v[36:39], v[20:23], v[44:47]
    ds_read_b128 v[36:39], v9 offset:10240
    v_add_f32_dpp v29, v50, v29 quad_perm:[2,2,2,2] row_mask:0xf bank_mask:0xf
    v_mfma_f32_16x16x32_bf16 v[44:47], v[84:87], v[24:27], v[44:47]
    v_add_f32_dpp v29, v51, v29 quad_perm:[3,3,3,3] row_mask:0xf bank_mask:0xf
    v_max_f32 v10, v10, v29
    s_waitcnt lgkmcnt(2)
    v_mfma_f32_16x16x32_bf16 v[48:51], v[32:35], v[12:15], 0
    ds_read_b128 v[32:35], v9 offset:11264
    v_mov_b32_dpp v30, v52 quad_perm:[0,0,0,0] row_mask:0xf bank_mask:0xf
    v_mfma_f32_16x16x32_bf16 v[48:51], v[88:91], v[16:19], v[48:51]
    v_add_f32_dpp v30, v53, v30 quad_perm:[1,1,1,1] row_mask:0xf bank_mask:0xf
    s_waitcnt lgkmcnt(2)
    v_mfma_f32_16x16x32_bf16 v[48:51], v[40:43], v[20:23], v[48:51]
    ds_read_b128 v[40:43], v9 offset:12288
    v_add_f32_dpp v30, v54, v30 quad_perm:[2,2,2,2] row_mask:0xf bank_mask:0xf
    v_mfma_f32_16x16x32_bf16 v[48:51], v[92:95], v[24:27], v[48:51]
    v_add_f32_dpp v30, v55, v30 quad_perm:[3,3,3,3] row_mask:0xf bank_mask:0xf
    v_max_f32 v10, v10, v30
    s_waitcnt lgkmcnt(2)
    v_mfma_f32_16x16x32_bf16 v[52:55], v[36:39], v[12:15], 0
    ds_read_b128 v[36:39], v9 offset:13312
    v_mov_b32_dpp v31, v44 quad_perm:[0,0,0,0] row_mask:0xf bank_mask:0xf
    v_mfma_f32_16x16x32_bf16 v[52:55], v[96:99], v[16:19], v[52:55]
    v_add_f32_dpp v31, v45, v31 quad_perm:[1,1,1,1] row_mask:0xf bank_mask:0xf
    s_waitcnt lgkmcnt(2)
    v_mfma_f32_16x16x32_bf16 v[52:55], v[32:35], v[20:23], v[52:55]
    v_add_f32_dpp v31, v46, v31 quad_perm:[2,2,2,2] row_mask:0xf bank_mask:0xf
    v_mfma_f32_16x16x32_bf16 v[52:55], v[100:103], v[24:27], v[52:55]
    v_add_f32_dpp v31, v47, v31 quad_perm:[3,3,3,3] row_mask:0xf bank_mask:0xf
    v_max_f32 v10, v10, v31
    s_waitcnt lgkmcnt(1)
    v_mfma_f32_16x16x32_bf16 v[44:47], v[40:43], v[12:15], 0
    v_mov_b32_dpp v32, v48 quad_perm:[0,0,0,0] row_mask:0xf bank_mask:0xf
    v_mfma_f32_16x16x32_bf16 v[44:47], v[104:107], v[16:19], v[44:47]
    v_add_f32_dpp v32, v49, v32 quad_perm:[1,1,1,1] row_mask:0xf bank_mask:0xf
    s_waitcnt lgkmcnt(0)
    v_mfma_f32_16x16x32_bf16 v[44:47], v[36:39], v[20:23], v[44:47]
    v_add_f32_dpp v32, v50, v32 quad_perm:[2,2,2,2] row_mask:0xf bank_mask:0xf
    v_mfma_f32_16x16x32_bf16 v[44:47], v[108:111], v[24:27], v[44:47]
    v_add_f32_dpp v32, v51, v32 quad_perm:[3,3,3,3] row_mask:0xf bank_mask:0xf
    v_max_f32 v10, v10, v32
    v_mfma_f32_16x16x32_bf16 v[48:51], v[112:115], v[12:15], 0
    v_mov_b32_dpp v33, v52 quad_perm:[0,0,0,0] row_mask:0xf bank_mask:0xf
    v_mfma_f32_16x16x32_bf16 v[48:51], v[116:119], v[16:19], v[48:51]
    v_add_f32_dpp v33, v53, v33 quad_perm:[1,1,1,1] row_mask:0xf bank_mask:0xf
    v_mfma_f32_16x16x32_bf16 v[48:51], v[120:123], v[20:23], v[48:51]
    v_add_f32_dpp v33, v54, v33 quad_perm:[2,2,2,2] row_mask:0xf bank_mask:0xf
    v_mfma_f32_16x16x32_bf16 v[48:51], v[124:127], v[24:27], v[48:51]
    v_add_f32_dpp v33, v55, v33 quad_perm:[3,3,3,3] row_mask:0xf bank_mask:0xf
    v_max_f32 v10, v10, v33
    v_mfma_f32_16x16x32_bf16 v[52:55], v[128:131], v[12:15], 0
    v_mov_b32_dpp v34, v44 quad_perm:[0,0,0,0] row_mask:0xf bank_mask:0xf
    v_mfma_f32_16x16x32_bf16 v[52:55], v[132:135], v[16:19], v[52:55]
    v_add_f32_dpp v34, v45, v34 quad_perm:[1,1,1,1] row_mask:0xf bank_mask:0xf
    v_mfma_f32_16x16x32_bf16 v[52:55], v[136:139], v[20:23], v[52:55]
    v_add_f32_dpp v34, v46, v34 quad_perm:[2,2,2,2] row_mask:0xf bank_mask:0xf
    v_mfma_f32_16x16x32_bf16 v[52:55], v[140:143], v[24:27], v[52:55]
    v_add_f32_dpp v34, v47, v34 quad_perm:[3,3,3,3] row_mask:0xf bank_mask:0xf
    v_max_f32 v10, v10, v34
    v_mfma_f32_16x16x32_bf16 v[44:47], v[144:147], v[12:15], 0
    v_mov_b32_dpp v35, v48 quad_perm:[0,0,0,0] row_mask:0xf bank_mask:0xf
    v_mfma_f32_16x16x32_bf16 v[44:47], v[148:151], v[16:19], v[44:47]
    v_add_f32_dpp v35, v49, v35 quad_perm:[1,1,1,1] row_mask:0xf bank_mask:0xf
    v_mfma_f32_16x16x32_bf16 v[44:47], v[152:155], v[20:23], v[44:47]
    v_add_f32_dpp v35, v50, v35 quad_perm:[2,2,2,2] row_mask:0xf bank_mask:0xf
    v_mfma_f32_16x16x32_bf16 v[44:47], v[156:159], v[24:27], v[44:47]
    v_add_f32_dpp v35, v51, v35 quad_perm:[3,3,3,3] row_mask:0xf bank_mask:0xf
    v_max_f32 v10, v10, v35
    v_mfma_f32_16x16x32_bf16 v[48:51], v[160:163], v[12:15], 0
    v_mov_b32_dpp v36, v52 quad_perm:[0,0,0,0] row_mask:0xf bank_mask:0xf
    v_mfma_f32_16x16x32_bf16 v[48:51], v[164:167], v[16:19], v[48:51]
    v_add_f32_dpp v36, v53, v36 quad_perm:[1,1,1,1] row_mask:0xf bank_mask:0xf
    v_mfma_f32_16x16x32_bf16 v[48:51], v[168:171], v[20:23], v[48:51]
    v_add_f32_dpp v36, v54, v36 quad_perm:[2,2,2,2] row_mask:0xf bank_mask:0xf
    v_mfma_f32_16x16x32_bf16 v[48:51], v[172:175], v[24:27], v[48:51]
    v_add_f32_dpp v36, v55, v36 quad_perm:[3,3,3,3] row_mask:0xf bank_mask:0xf
    v_max_f32 v10, v10, v36
    v_mfma_f32_16x16x32_bf16 v[52:55], v[176:179], v[12:15], 0
    v_mov_b32_dpp v37, v44 quad_perm:[0,0,0,0] row_mask:0xf bank_mask:0xf
    v_mfma_f32_16x16x32_bf16 v[52:55], v[180:183], v[16:19], v[52:55]
    v_add_f32_dpp v37, v45, v37 quad_perm:[1,1,1,1] row_mask:0xf bank_mask:0xf
    v_mfma_f32_16x16x32_bf16 v[52:55], v[184:187], v[20:23], v[52:55]
    v_add_f32_dpp v37, v46, v37 quad_perm:[2,2,2,2] row_mask:0xf bank_mask:0xf
    v_mfma_f32_16x16x32_bf16 v[52:55], v[188:191], v[24:27], v[52:55]
    v_add_f32_dpp v37, v47, v37 quad_perm:[3,3,3,3] row_mask:0xf bank_mask:0xf
    v_max_f32 v10, v10, v37
    v_mfma_f32_16x16x32_bf16 v[44:47], v[192:195], v[12:15], 0
    v_mov_b32_dpp v38, v48 quad_perm:[0,0,0,0] row_mask:0xf bank_mask:0xf
    v_mfma_f32_16x16x32_bf16 v[44:47], v[196:199], v[16:19], v[44:47]
    v_add_f32_dpp v38, v49, v38 quad_perm:[1,1,1,1] row_mask:0xf bank_mask:0xf
    v_mfma_f32_16x16x32_bf16 v[44:47], v[200:203], v[20:23], v[44:47]
    v_add_f32_dpp v38, v50, v38 quad_perm:[2,2,2,2] row_mask:0xf bank_mask:0xf
    v_mfma_f32_16x16x32_bf16 v[44:47], v[204:207], v[24:27], v[44:47]
    v_add_f32_dpp v38, v51, v38 quad_perm:[3,3,3,3] row_mask:0xf bank_mask:0xf
    v_max_f32 v10, v10, v38
    v_mfma_f32_16x16x32_bf16 v[48:51], v[208:211], v[12:15], 0
    v_mov_b32_dpp v39, v52 quad_perm:[0,0,0,0] row_mask:0xf bank_mask:0xf
    v_mfma_f32_16x16x32_bf16 v[48:51], v[212:215], v[16:19], v[48:51]
    v_add_f32_dpp v39, v53, v39 quad_perm:[1,1,1,1] row_mask:0xf bank_mask:0xf
    v_mfma_f32_16x16x32_bf16 v[48:51], v[216:219], v[20:23], v[48:51]
    v_add_f32_dpp v39, v54, v39 quad_perm:[2,2,2,2] row_mask:0xf bank_mask:0xf
    v_mfma_f32_16x16x32_bf16 v[48:51], v[220:223], v[24:27], v[48:51]
    v_add_f32_dpp v39, v55, v39 quad_perm:[3,3,3,3] row_mask:0xf bank_mask:0xf
    v_max_f32 v10, v10, v39
    v_mfma_f32_16x16x32_bf16 v[52:55], v[224:227], v[12:15], 0
    v_mov_b32_dpp v40, v44 quad_perm:[0,0,0,0] row_mask:0xf bank_mask:0xf
    v_mfma_f32_16x16x32_bf16 v[52:55], v[228:231], v[16:19], v[52:55]
    v_add_f32_dpp v40, v45, v40 quad_perm:[1,1,1,1] row_mask:0xf bank_mask:0xf
    v_mfma_f32_16x16x32_bf16 v[52:55], v[232:235], v[20:23], v[52:55]
    v_add_f32_dpp v40, v46, v40 quad_perm:[2,2,2,2] row_mask:0xf bank_mask:0xf
    v_mfma_f32_16x16x32_bf16 v[52:55], v[236:239], v[24:27], v[52:55]
    v_add_f32_dpp v40, v47, v40 quad_perm:[3,3,3,3] row_mask:0xf bank_mask:0xf
    v_max_f32 v10, v10, v40
    v_mfma_f32_16x16x32_bf16 v[44:47], v[240:243], v[12:15], 0
    v_mov_b32_dpp v41, v48 quad_perm:[0,0,0,0] row_mask:0xf bank_mask:0xf
    v_mfma_f32_16x16x32_bf16 v[44:47], v[244:247], v[16:19], v[44:47]
    v_add_f32_dpp v41, v49, v41 quad_perm:[1,1,1,1] row_mask:0xf bank_mask:0xf
    v_mfma_f32_16x16x32_bf16 v[44:47], v[248:251], v[20:23], v[44:47]
    v_add_f32_dpp v41, v50, v41 quad_perm:[2,2,2,2] row_mask:0xf bank_mask:0xf
    v_mfma_f32_16x16x32_bf16 v[44:47], v[252:255], v[24:27], v[44:47]
    v_add_f32_dpp v41, v51, v41 quad_perm:[3,3,3,3] row_mask:0xf bank_mask:0xf
    v_max_f32 v10, v10, v41
    v_mov_b32_dpp v42, v52 quad_perm:[0,0,0,0] row_mask:0xf bank_mask:0xf
    v_add_f32_dpp v42, v53, v42 quad_perm:[1,1,1,1] row_mask:0xf bank_mask:0xf
    v_add_f32_dpp v42, v54, v42 quad_perm:[2,2,2,2] row_mask:0xf bank_mask:0xf
    v_add_f32_dpp v42, v55, v42 quad_perm:[3,3,3,3] row_mask:0xf bank_mask:0xf
    v_max_f32 v10, v10, v42
    v_and_b32 v11, 1, v0
    v_lshlrev_b32 v11, 4, v11
    v_mov_b32 v48, 0xffff
    v_lshlrev_b32 v48, v11, v48
    v_mov_b32_dpp v43, v44 quad_perm:[0,0,0,0] row_mask:0xf bank_mask:0xf
    v_add_f32_dpp v43, v45, v43 quad_perm:[1,1,1,1] row_mask:0xf bank_mask:0xf
    v_add_f32_dpp v43, v46, v43 quad_perm:[2,2,2,2] row_mask:0xf bank_mask:0xf
    v_add_f32_dpp v43, v47, v43 quad_perm:[3,3,3,3] row_mask:0xf bank_mask:0xf
    v_max_f32 v10, v10, v43
    s_mov_b32 vcc_lo, 0x33333333
    s_mov_b32 vcc_hi, 0x33333333
    v_cndmask_b32 v44, 0, v48, vcc
    s_mov_b32 vcc_lo, 0xcccccccc
    s_mov_b32 vcc_hi, 0xcccccccc
    v_cndmask_b32 v45, 0, v48, vcc
    s_mov_b32 s7, 0x3e0293ee
    s_nop 1
    v_max_f32_dpp v10, v10, v10 row_ror:4 row_mask:0xf bank_mask:0xf
    s_nop 1
    v_max_f32_dpp v10, v10, v10 row_ror:8 row_mask:0xf bank_mask:0xf
    v_mov_b32 v11, v10
    s_nop 1
    v_permlane32_swap_b32 v10, v11
    v_max_f32 v10, v10, v11
    v_mov_b32 v11, v10
    s_nop 1
    v_permlane16_swap_b32 v10, v11
    v_max_f32 v10, v10, v11
    v_mul_f32 v10, s7, v10
    v_mov_b32 v11, 0
    v_fma_f32 v28, v28, s7, -v10
    v_fma_f32 v29, v29, s7, -v10
    v_exp_f32 v28, v28
    v_exp_f32 v29, v29
    v_add_f32 v11, v11, v28
    v_add_f32 v11, v11, v29
    v_cvt_pk_bf16_f32 v28, v28, v28
    v_cvt_pk_bf16_f32 v29, v29, v29
    v_and_b32 v48, v28, v44
    v_and_b32 v49, v28, v45
    s_nop 1
    v_mfma_f32_4x4x4_16b_bf16 v[12:15], v[48:49], a[0:1], 0 cbsz:2 abid:0
    v_and_b32 v50, v29, v44
    v_mfma_f32_4x4x4_16b_bf16 v[16:19], v[48:49], a[2:3], 0 cbsz:2 abid:0
    v_and_b32 v51, v29, v45
    v_mfma_f32_4x4x4_16b_bf16 v[20:23], v[48:49], a[4:5], 0 cbsz:2 abid:1
    v_fma_f32 v30, v30, s7, -v10
    v_mfma_f32_4x4x4_16b_bf16 v[24:27], v[48:49], a[6:7], 0 cbsz:2 abid:1
    v_exp_f32 v30, v30
    v_mfma_f32_4x4x4_16b_bf16 v[12:15], v[48:49], a[8:9], v[12:15] cbsz:2 abid:2
    v_add_f32 v11, v11, v30
    v_mfma_f32_4x4x4_16b_bf16 v[16:19], v[48:49], a[10:11], v[16:19] cbsz:2 abid:2
    v_cvt_pk_bf16_f32 v30, v30, v30
    v_mfma_f32_4x4x4_16b_bf16 v[20:23], v[48:49], a[12:13], v[20:23] cbsz:2 abid:3
    v_mfma_f32_4x4x4_16b_bf16 v[24:27], v[48:49], a[14:15], v[24:27] cbsz:2 abid:3
    v_mfma_f32_4x4x4_16b_bf16 v[12:15], v[50:51], a[16:17], v[12:15] cbsz:2 abid:0
    v_and_b32 v48, v30, v44
    v_mfma_f32_4x4x4_16b_bf16 v[16:19], v[50:51], a[18:19], v[16:19] cbsz:2 abid:0
    v_and_b32 v49, v30, v45
    v_mfma_f32_4x4x4_16b_bf16 v[20:23], v[50:51], a[20:21], v[20:23] cbsz:2 abid:1
    v_fma_f32 v31, v31, s7, -v10
    v_mfma_f32_4x4x4_16b_bf16 v[24:27], v[50:51], a[22:23], v[24:27] cbsz:2 abid:1
    v_exp_f32 v31, v31
    v_mfma_f32_4x4x4_16b_bf16 v[12:15], v[50:51], a[24:25], v[12:15] cbsz:2 abid:2
    v_add_f32 v11, v11, v31
    v_mfma_f32_4x4x4_16b_bf16 v[16:19], v[50:51], a[26:27], v[16:19] cbsz:2 abid:2
    v_cvt_pk_bf16_f32 v31, v31, v31
    v_mfma_f32_4x4x4_16b_bf16 v[20:23], v[50:51], a[28:29], v[20:23] cbsz:2 abid:3
    v_mfma_f32_4x4x4_16b_bf16 v[24:27], v[50:51], a[30:31], v[24:27] cbsz:2 abid:3
    v_mfma_f32_4x4x4_16b_bf16 v[12:15], v[48:49], a[32:33], v[12:15] cbsz:2 abid:0
    v_and_b32 v50, v31, v44
    v_mfma_f32_4x4x4_16b_bf16 v[16:19], v[48:49], a[34:35], v[16:19] cbsz:2 abid:0
    v_and_b32 v51, v31, v45
    v_mfma_f32_4x4x4_16b_bf16 v[20:23], v[48:49], a[36:37], v[20:23] cbsz:2 abid:1
    v_fma_f32 v32, v32, s7, -v10
    v_mfma_f32_4x4x4_16b_bf16 v[24:27], v[48:49], a[38:39], v[24:27] cbsz:2 abid:1
    v_exp_f32 v32, v32
    v_mfma_f32_4x4x4_16b_bf16 v[12:15], v[48:49], a[40:41], v[12:15] cbsz:2 abid:2
    v_add_f32 v11, v11, v32
    v_mfma_f32_4x4x4_16b_bf16 v[16:19], v[48:49], a[42:43], v[16:19] cbsz:2 abid:2
    v_cvt_pk_bf16_f32 v32, v32, v32
    v_mfma_f32_4x4x4_16b_bf16 v[20:23], v[48:49], a[44:45], v[20:23] cbsz:2 abid:3
    v_mfma_f32_4x4x4_16b_bf16 v[24:27], v[48:49], a[46:47], v[24:27] cbsz:2 abid:3
    v_mfma_f32_4x4x4_16b_bf16 v[12:15], v[50:51], a[48:49], v[12:15] cbsz:2 abid:0
    v_and_b32 v48, v32, v44
    v_mfma_f32_4x4x4_16b_bf16 v[16:19], v[50:51], a[50:51], v[16:19] cbsz:2 abid:0
    v_and_b32 v49, v32, v45
    v_mfma_f32_4x4x4_16b_bf16 v[20:23], v[50:51], a[52:53], v[20:23] cbsz:2 abid:1
    v_fma_f32 v33, v33, s7, -v10
    v_mfma_f32_4x4x4_16b_bf16 v[24:27], v[50:51], a[54:55], v[24:27] cbsz:2 abid:1
    v_exp_f32 v33, v33
    v_mfma_f32_4x4x4_16b_bf16 v[12:15], v[50:51], a[56:57], v[12:15] cbsz:2 abid:2
    v_add_f32 v11, v11, v33
    v_mfma_f32_4x4x4_16b_bf16 v[16:19], v[50:51], a[58:59], v[16:19] cbsz:2 abid:2
    v_cvt_pk_bf16_f32 v33, v33, v33
    v_mfma_f32_4x4x4_16b_bf16 v[20:23], v[50:51], a[60:61], v[20:23] cbsz:2 abid:3
    v_mfma_f32_4x4x4_16b_bf16 v[24:27], v[50:51], a[62:63], v[24:27] cbsz:2 abid:3
    v_mfma_f32_4x4x4_16b_bf16 v[12:15], v[48:49], a[64:65], v[12:15] cbsz:2 abid:0
    v_and_b32 v50, v33, v44
    v_mfma_f32_4x4x4_16b_bf16 v[16:19], v[48:49], a[66:67], v[16:19] cbsz:2 abid:0
    v_and_b32 v51, v33, v45
    v_mfma_f32_4x4x4_16b_bf16 v[20:23], v[48:49], a[68:69], v[20:23] cbsz:2 abid:1
    v_fma_f32 v34, v34, s7, -v10
    v_mfma_f32_4x4x4_16b_bf16 v[24:27], v[48:49], a[70:71], v[24:27] cbsz:2 abid:1
    v_exp_f32 v34, v34
    v_mfma_f32_4x4x4_16b_bf16 v[12:15], v[48:49], a[72:73], v[12:15] cbsz:2 abid:2
    v_add_f32 v11, v11, v34
    v_mfma_f32_4x4x4_16b_bf16 v[16:19], v[48:49], a[74:75], v[16:19] cbsz:2 abid:2
    v_cvt_pk_bf16_f32 v34, v34, v34
    v_mfma_f32_4x4x4_16b_bf16 v[20:23], v[48:49], a[76:77], v[20:23] cbsz:2 abid:3
    v_mfma_f32_4x4x4_16b_bf16 v[24:27], v[48:49], a[78:79], v[24:27] cbsz:2 abid:3
    v_mfma_f32_4x4x4_16b_bf16 v[12:15], v[50:51], a[80:81], v[12:15] cbsz:2 abid:0
    v_and_b32 v48, v34, v44
    v_mfma_f32_4x4x4_16b_bf16 v[16:19], v[50:51], a[82:83], v[16:19] cbsz:2 abid:0
    v_and_b32 v49, v34, v45
    v_mfma_f32_4x4x4_16b_bf16 v[20:23], v[50:51], a[84:85], v[20:23] cbsz:2 abid:1
    v_fma_f32 v35, v35, s7, -v10
    v_mfma_f32_4x4x4_16b_bf16 v[24:27], v[50:51], a[86:87], v[24:27] cbsz:2 abid:1
    v_exp_f32 v35, v35
    v_mfma_f32_4x4x4_16b_bf16 v[12:15], v[50:51], a[88:89], v[12:15] cbsz:2 abid:2
    v_add_f32 v11, v11, v35
    v_mfma_f32_4x4x4_16b_bf16 v[16:19], v[50:51], a[90:91], v[16:19] cbsz:2 abid:2
    v_cvt_pk_bf16_f32 v35, v35, v35
    v_mfma_f32_4x4x4_16b_bf16 v[20:23], v[50:51], a[92:93], v[20:23] cbsz:2 abid:3
    v_mfma_f32_4x4x4_16b_bf16 v[24:27], v[50:51], a[94:95], v[24:27] cbsz:2 abid:3
    v_mfma_f32_4x4x4_16b_bf16 v[12:15], v[48:49], a[96:97], v[12:15] cbsz:2 abid:0
    v_and_b32 v50, v35, v44
    v_mfma_f32_4x4x4_16b_bf16 v[16:19], v[48:49], a[98:99], v[16:19] cbsz:2 abid:0
    v_and_b32 v51, v35, v45
    v_mfma_f32_4x4x4_16b_bf16 v[20:23], v[48:49], a[100:101], v[20:23] cbsz:2 abid:1
    v_fma_f32 v36, v36, s7, -v10
    v_mfma_f32_4x4x4_16b_bf16 v[24:27], v[48:49], a[102:103], v[24:27] cbsz:2 abid:1
    v_exp_f32 v36, v36
    v_mfma_f32_4x4x4_16b_bf16 v[12:15], v[48:49], a[104:105], v[12:15] cbsz:2 abid:2
    v_add_f32 v11, v11, v36
    v_mfma_f32_4x4x4_16b_bf16 v[16:19], v[48:49], a[106:107], v[16:19] cbsz:2 abid:2
    v_cvt_pk_bf16_f32 v36, v36, v36
    v_mfma_f32_4x4x4_16b_bf16 v[20:23], v[48:49], a[108:109], v[20:23] cbsz:2 abid:3
    v_mfma_f32_4x4x4_16b_bf16 v[24:27], v[48:49], a[110:111], v[24:27] cbsz:2 abid:3
    v_mfma_f32_4x4x4_16b_bf16 v[12:15], v[50:51], a[112:113], v[12:15] cbsz:2 abid:0
    v_and_b32 v48, v36, v44
    v_mfma_f32_4x4x4_16b_bf16 v[16:19], v[50:51], a[114:115], v[16:19] cbsz:2 abid:0
    v_and_b32 v49, v36, v45
    v_mfma_f32_4x4x4_16b_bf16 v[20:23], v[50:51], a[116:117], v[20:23] cbsz:2 abid:1
    v_fma_f32 v37, v37, s7, -v10
    v_mfma_f32_4x4x4_16b_bf16 v[24:27], v[50:51], a[118:119], v[24:27] cbsz:2 abid:1
    v_exp_f32 v37, v37
    v_mfma_f32_4x4x4_16b_bf16 v[12:15], v[50:51], a[120:121], v[12:15] cbsz:2 abid:2
    v_add_f32 v11, v11, v37
    v_mfma_f32_4x4x4_16b_bf16 v[16:19], v[50:51], a[122:123], v[16:19] cbsz:2 abid:2
    v_cvt_pk_bf16_f32 v37, v37, v37
    v_mfma_f32_4x4x4_16b_bf16 v[20:23], v[50:51], a[124:125], v[20:23] cbsz:2 abid:3
    v_mfma_f32_4x4x4_16b_bf16 v[24:27], v[50:51], a[126:127], v[24:27] cbsz:2 abid:3
    v_mfma_f32_4x4x4_16b_bf16 v[12:15], v[48:49], a[128:129], v[12:15] cbsz:2 abid:0
    v_and_b32 v50, v37, v44
    v_mfma_f32_4x4x4_16b_bf16 v[16:19], v[48:49], a[130:131], v[16:19] cbsz:2 abid:0
    v_and_b32 v51, v37, v45
    v_mfma_f32_4x4x4_16b_bf16 v[20:23], v[48:49], a[132:133], v[20:23] cbsz:2 abid:1
    v_fma_f32 v38, v38, s7, -v10
    v_mfma_f32_4x4x4_16b_bf16 v[24:27], v[48:49], a[134:135], v[24:27] cbsz:2 abid:1
    v_exp_f32 v38, v38
    v_mfma_f32_4x4x4_16b_bf16 v[12:15], v[48:49], a[136:137], v[12:15] cbsz:2 abid:2
    v_add_f32 v11, v11, v38
    v_mfma_f32_4x4x4_16b_bf16 v[16:19], v[48:49], a[138:139], v[16:19] cbsz:2 abid:2
    v_cvt_pk_bf16_f32 v38, v38, v38
    v_mfma_f32_4x4x4_16b_bf16 v[20:23], v[48:49], a[140:141], v[20:23] cbsz:2 abid:3
    v_mfma_f32_4x4x4_16b_bf16 v[24:27], v[48:49], a[142:143], v[24:27] cbsz:2 abid:3
    v_mfma_f32_4x4x4_16b_bf16 v[12:15], v[50:51], a[144:145], v[12:15] cbsz:2 abid:0
    v_and_b32 v48, v38, v44
    v_mfma_f32_4x4x4_16b_bf16 v[16:19], v[50:51], a[146:147], v[16:19] cbsz:2 abid:0
    v_and_b32 v49, v38, v45
    v_mfma_f32_4x4x4_16b_bf16 v[20:23], v[50:51], a[148:149], v[20:23] cbsz:2 abid:1
    v_fma_f32 v39, v39, s7, -v10
    v_mfma_f32_4x4x4_16b_bf16 v[24:27], v[50:51], a[150:151], v[24:27] cbsz:2 abid:1
    v_exp_f32 v39, v39
    v_mfma_f32_4x4x4_16b_bf16 v[12:15], v[50:51], a[152:153], v[12:15] cbsz:2 abid:2
    v_add_f32 v11, v11, v39
    v_mfma_f32_4x4x4_16b_bf16 v[16:19], v[50:51], a[154:155], v[16:19] cbsz:2 abid:2
    v_cvt_pk_bf16_f32 v39, v39, v39
    v_mfma_f32_4x4x4_16b_bf16 v[20:23], v[50:51], a[156:157], v[20:23] cbsz:2 abid:3
    v_mfma_f32_4x4x4_16b_bf16 v[24:27], v[50:51], a[158:159], v[24:27] cbsz:2 abid:3
    v_mfma_f32_4x4x4_16b_bf16 v[12:15], v[48:49], a[160:161], v[12:15] cbsz:2 abid:0
    v_and_b32 v50, v39, v44
    v_mfma_f32_4x4x4_16b_bf16 v[16:19], v[48:49], a[162:163], v[16:19] cbsz:2 abid:0
    v_and_b32 v51, v39, v45
    v_mfma_f32_4x4x4_16b_bf16 v[20:23], v[48:49], a[164:165], v[20:23] cbsz:2 abid:1
    v_fma_f32 v40, v40, s7, -v10
    v_mfma_f32_4x4x4_16b_bf16 v[24:27], v[48:49], a[166:167], v[24:27] cbsz:2 abid:1
    v_exp_f32 v40, v40
    v_mfma_f32_4x4x4_16b_bf16 v[12:15], v[48:49], a[168:169], v[12:15] cbsz:2 abid:2
    v_add_f32 v11, v11, v40
    v_mfma_f32_4x4x4_16b_bf16 v[16:19], v[48:49], a[170:171], v[16:19] cbsz:2 abid:2
    v_cvt_pk_bf16_f32 v40, v40, v40
    v_mfma_f32_4x4x4_16b_bf16 v[20:23], v[48:49], a[172:173], v[20:23] cbsz:2 abid:3
    v_mfma_f32_4x4x4_16b_bf16 v[24:27], v[48:49], a[174:175], v[24:27] cbsz:2 abid:3
    v_mfma_f32_4x4x4_16b_bf16 v[12:15], v[50:51], a[176:177], v[12:15] cbsz:2 abid:0
    v_and_b32 v48, v40, v44
    v_mfma_f32_4x4x4_16b_bf16 v[16:19], v[50:51], a[178:179], v[16:19] cbsz:2 abid:0
    v_and_b32 v49, v40, v45
    v_mfma_f32_4x4x4_16b_bf16 v[20:23], v[50:51], a[180:181], v[20:23] cbsz:2 abid:1
    v_fma_f32 v41, v41, s7, -v10
    v_mfma_f32_4x4x4_16b_bf16 v[24:27], v[50:51], a[182:183], v[24:27] cbsz:2 abid:1
    v_exp_f32 v41, v41
    v_mfma_f32_4x4x4_16b_bf16 v[12:15], v[50:51], a[184:185], v[12:15] cbsz:2 abid:2
    v_add_f32 v11, v11, v41
    v_mfma_f32_4x4x4_16b_bf16 v[16:19], v[50:51], a[186:187], v[16:19] cbsz:2 abid:2
    v_cvt_pk_bf16_f32 v41, v41, v41
    v_mfma_f32_4x4x4_16b_bf16 v[20:23], v[50:51], a[188:189], v[20:23] cbsz:2 abid:3
    v_mfma_f32_4x4x4_16b_bf16 v[24:27], v[50:51], a[190:191], v[24:27] cbsz:2 abid:3
    v_mfma_f32_4x4x4_16b_bf16 v[12:15], v[48:49], a[192:193], v[12:15] cbsz:2 abid:0
    v_and_b32 v50, v41, v44
    v_mfma_f32_4x4x4_16b_bf16 v[16:19], v[48:49], a[194:195], v[16:19] cbsz:2 abid:0
    v_and_b32 v51, v41, v45
    v_mfma_f32_4x4x4_16b_bf16 v[20:23], v[48:49], a[196:197], v[20:23] cbsz:2 abid:1
    v_fma_f32 v42, v42, s7, -v10
    v_mfma_f32_4x4x4_16b_bf16 v[24:27], v[48:49], a[198:199], v[24:27] cbsz:2 abid:1
    v_exp_f32 v42, v42
    v_mfma_f32_4x4x4_16b_bf16 v[12:15], v[48:49], a[200:201], v[12:15] cbsz:2 abid:2
    v_add_f32 v11, v11, v42
    v_mfma_f32_4x4x4_16b_bf16 v[16:19], v[48:49], a[202:203], v[16:19] cbsz:2 abid:2
    v_cvt_pk_bf16_f32 v42, v42, v42
    v_mfma_f32_4x4x4_16b_bf16 v[20:23], v[48:49], a[204:205], v[20:23] cbsz:2 abid:3
    v_mfma_f32_4x4x4_16b_bf16 v[24:27], v[48:49], a[206:207], v[24:27] cbsz:2 abid:3
    v_mfma_f32_4x4x4_16b_bf16 v[12:15], v[50:51], a[208:209], v[12:15] cbsz:2 abid:0
    v_and_b32 v48, v42, v44
    v_mfma_f32_4x4x4_16b_bf16 v[16:19], v[50:51], a[210:211], v[16:19] cbsz:2 abid:0
    v_and_b32 v49, v42, v45
    v_mfma_f32_4x4x4_16b_bf16 v[20:23], v[50:51], a[212:213], v[20:23] cbsz:2 abid:1
    v_fma_f32 v43, v43, s7, -v10
    v_mfma_f32_4x4x4_16b_bf16 v[24:27], v[50:51], a[214:215], v[24:27] cbsz:2 abid:1
    v_exp_f32 v43, v43
    v_mfma_f32_4x4x4_16b_bf16 v[12:15], v[50:51], a[216:217], v[12:15] cbsz:2 abid:2
    v_add_f32 v11, v11, v43
    v_mfma_f32_4x4x4_16b_bf16 v[16:19], v[50:51], a[218:219], v[16:19] cbsz:2 abid:2
    v_cvt_pk_bf16_f32 v43, v43, v43
    v_mfma_f32_4x4x4_16b_bf16 v[20:23], v[50:51], a[220:221], v[20:23] cbsz:2 abid:3
    v_mfma_f32_4x4x4_16b_bf16 v[24:27], v[50:51], a[222:223], v[24:27] cbsz:2 abid:3
    s_mov_b32 s60, 158080
    s_mov_b32 s61, 162304
    v_mfma_f32_4x4x4_16b_bf16 v[12:15], v[48:49], a[224:225], v[12:15] cbsz:2 abid:0
    v_and_b32 v50, v43, v44
    v_mfma_f32_4x4x4_16b_bf16 v[16:19], v[48:49], a[226:227], v[16:19] cbsz:2 abid:0
    v_and_b32 v51, v43, v45
    v_mfma_f32_4x4x4_16b_bf16 v[20:23], v[48:49], a[228:229], v[20:23] cbsz:2 abid:1
    v_lshrrev_b32 v52, 5, v0
    v_mfma_f32_4x4x4_16b_bf16 v[24:27], v[48:49], a[230:231], v[24:27] cbsz:2 abid:1
    v_lshl_add_u32 v52, s3, 1, v52
    v_mfma_f32_4x4x4_16b_bf16 v[12:15], v[48:49], a[232:233], v[12:15] cbsz:2 abid:2
    v_mul_u32_u24 v52, 528, v52
    v_mfma_f32_4x4x4_16b_bf16 v[16:19], v[48:49], a[234:235], v[16:19] cbsz:2 abid:2
    v_and_b32 v5, 15, v0
    v_mfma_f32_4x4x4_16b_bf16 v[20:23], v[48:49], a[236:237], v[20:23] cbsz:2 abid:3
    v_lshl_add_u32 v52, v5, 5, v52
    v_mfma_f32_4x4x4_16b_bf16 v[24:27], v[48:49], a[238:239], v[24:27] cbsz:2 abid:3
    v_and_b32 v5, 16, v0
    v_mfma_f32_4x4x4_16b_bf16 v[12:15], v[50:51], a[240:241], v[12:15] cbsz:2 abid:0
    v_add3_u32 v52, v52, v5, s60
    v_mfma_f32_4x4x4_16b_bf16 v[16:19], v[50:51], a[242:243], v[16:19] cbsz:2 abid:0
    v_lshrrev_b32 v54, 3, v0
    v_mfma_f32_4x4x4_16b_bf16 v[20:23], v[50:51], a[244:245], v[20:23] cbsz:2 abid:1
    v_lshl_add_u32 v54, s3, 3, v54
    v_mfma_f32_4x4x4_16b_bf16 v[24:27], v[50:51], a[246:247], v[24:27] cbsz:2 abid:1
    v_lshlrev_b32 v54, 4, v54
    v_mfma_f32_4x4x4_16b_bf16 v[12:15], v[50:51], a[248:249], v[12:15] cbsz:2 abid:2
    v_and_b32 v5, 7, v0
    v_mfma_f32_4x4x4_16b_bf16 v[16:19], v[50:51], a[250:251], v[16:19] cbsz:2 abid:2
    v_mul_u32_u24 v55, 528, v5
    v_mfma_f32_4x4x4_16b_bf16 v[20:23], v[50:51], a[252:253], v[20:23] cbsz:2 abid:3
    v_add3_u32 v55, v55, v54, s60
    v_mfma_f32_4x4x4_16b_bf16 v[24:27], v[50:51], a[254:255], v[24:27] cbsz:2 abid:3
    v_and_b32 v5, 6, v0
    v_lshl_add_u32 v5, v5, 2, s61
    s_nop 1
    v_add_f32_dpp v11, v11, v11 row_ror:4 row_mask:0xf bank_mask:0xf
    s_nop 1
    v_add_f32_dpp v11, v11, v11 row_ror:8 row_mask:0xf bank_mask:0xf
    v_mov_b32 v28, v11
    s_nop 1
    v_permlane32_swap_b32 v11, v28
    v_add_f32 v11, v11, v28
    v_mov_b32 v28, v11
    s_nop 1
    v_permlane16_swap_b32 v11, v28
    v_add_f32 v11, v11, v28
    s_lshl_b32 s60, s3, 3
    s_add_u32 s60, s60, s61
    v_mov_b32 v28, s60
    v_add_f32 v12, v12, v20
    v_add_f32 v13, v13, v21
    v_add_f32 v14, v14, v22
    v_add_f32 v15, v15, v23
    v_add_f32 v16, v16, v24
    v_add_f32 v17, v17, v25
    v_add_f32 v18, v18, v26
    v_add_f32 v19, v19, v27
    v_permlane16_swap_b32 v12, v16
    v_permlane16_swap_b32 v13, v17
    v_permlane16_swap_b32 v14, v18
    v_permlane16_swap_b32 v15, v19
    v_add_f32 v12, v12, v16
    v_add_f32 v13, v13, v17
    v_add_f32 v14, v14, v18
    v_add_f32 v15, v15, v19
    ds_write_b128 v52, v[12:15]
    ds_write_b64 v28, v[10:11]
    s_mov_b32 vcc_lo, 0x1010101
    s_mov_b32 vcc_hi, 0x1010101
    v_bfrev_b32 v23, 1
    v_cndmask_b32 v54, v23, v54, vcc
    v_or_b32 v24, s3, v0
    v_cmp_eq_u32 vcc, 0, v24
    s_mul_i32 s64, s2, 640
    s_add_u32 s64, s64, 1343488
    v_cndmask_b32 v23, v23, v24, vcc
    s_waitcnt lgkmcnt(0)
    s_barrier
    ds_read_b64 v[16:17], v5
    ds_read_b128 v[12:15], v55
    s_waitcnt lgkmcnt(1)
    v_max_f32_dpp v10, v16, v16 quad_perm:[2,3,0,1] row_mask:0xf bank_mask:0xf
    s_nop 1
    v_max_f32_dpp v10, v10, v10 row_half_mirror row_mask:0xf bank_mask:0xf
    v_sub_f32 v16, v16, v10
    v_exp_f32 v16, v16
    s_waitcnt lgkmcnt(0)
    v_mul_f32 v11, v17, v16
    v_mul_f32 v12, v12, v16
    v_mul_f32 v13, v13, v16
    v_mul_f32 v14, v14, v16
    v_mul_f32 v15, v15, v16
    v_add_f32_dpp v12, v12, v12 quad_perm:[1,0,3,2] row_mask:0xf bank_mask:0xf
    v_add_f32_dpp v13, v13, v13 quad_perm:[1,0,3,2] row_mask:0xf bank_mask:0xf
    v_add_f32_dpp v14, v14, v14 quad_perm:[1,0,3,2] row_mask:0xf bank_mask:0xf
    v_add_f32_dpp v15, v15, v15 quad_perm:[1,0,3,2] row_mask:0xf bank_mask:0xf
    v_add_f32_dpp v11, v11, v11 quad_perm:[2,3,0,1] row_mask:0xf bank_mask:0xf
    v_add_f32_dpp v12, v12, v12 quad_perm:[2,3,0,1] row_mask:0xf bank_mask:0xf
    v_add_f32_dpp v13, v13, v13 quad_perm:[2,3,0,1] row_mask:0xf bank_mask:0xf
    v_add_f32_dpp v14, v14, v14 quad_perm:[2,3,0,1] row_mask:0xf bank_mask:0xf
    v_add_f32_dpp v15, v15, v15 quad_perm:[2,3,0,1] row_mask:0xf bank_mask:0xf
    v_add_f32_dpp v11, v11, v11 row_half_mirror row_mask:0xf bank_mask:0xf
    v_add_f32_dpp v12, v12, v12 row_half_mirror row_mask:0xf bank_mask:0xf
    v_add_f32_dpp v13, v13, v13 row_half_mirror row_mask:0xf bank_mask:0xf
    v_add_f32_dpp v14, v14, v14 row_half_mirror row_mask:0xf bank_mask:0xf
    v_add_f32_dpp v15, v15, v15 row_half_mirror row_mask:0xf bank_mask:0xf
    s_cmp_eq_u32 s97, 0
    s_cbranch_scc1 Y28
    buffer_store_dwordx4 v[12:15], v54, s[48:51], s64 offen
    buffer_store_dwordx2 v[10:11], v23, s[48:51], s64 offen offset:512
Y28d:
    v_and_b32 v47, 31, v0
    v_lshl_add_u32 v47, s3, 5, v47
    v_lshrrev_b32 v44, 5, v0
    v_lshlrev_b32 v45, 7, v44
    v_add_lshl_u32 v45, v45, v47, 1
    v_add_u32 v45, 156928, v45
    v_lshlrev_b32 v44, 31, v44
    v_lshl_add_u32 v47, v47, 2, v44
    v_and_b32 v46, 7, v0
    v_mul_u32_u24 v46, 640, v46
    v_add_u32 v46, v46, v44
    s_mov_b32 vcc_lo, 0xff00ff
    s_mov_b32 vcc_hi, 0xff00ff
    v_bfrev_b32 v44, 1
    v_cndmask_b32 v46, v44, v46, vcc
    s_mul_i32 s60, s4, 5120
    s_add_u32 s60, s60, 1343488
    s_add_u32 s61, s60, 2560
    s_waitcnt vmcnt(0)
    buffer_load_dwordx2 v[18:19], v46, s[48:51], s60 offen offset:512 sc1
    buffer_load_dword v10, v47, s[48:51], s60 offen offset:0 sc1
    buffer_load_dword v11, v47, s[48:51], s60 offen offset:640 sc1
    buffer_load_dword v12, v47, s[48:51], s60 offen offset:1280 sc1
    buffer_load_dword v13, v47, s[48:51], s60 offen offset:1920 sc1
    buffer_load_dword v14, v47, s[48:51], s61 offen offset:0 sc1
    buffer_load_dword v15, v47, s[48:51], s61 offen offset:640 sc1
    buffer_load_dword v16, v47, s[48:51], s61 offen offset:1280 sc1
    buffer_load_dword v17, v47, s[48:51], s61 offen offset:1920 sc1
    v_and_b32 v50, 1, v0
    v_lshlrev_b32 v54, 31, v50
    v_and_b32 v50, 2, v0
    v_lshl_add_u32 v54, v50, 5, v54
    v_and_b32 v50, 48, v0
    v_add_u32 v54, v54, v50
    s_mov_b32 vcc_lo, 0xf000f
    s_mov_b32 vcc_hi, 0xf000f
    v_bfrev_b32 v50, 1
    v_cndmask_b32 v54, v50, v54, vcc
    s_lshl_b32 s64, s5, 5
    s_add_u32 s64, s64, s4
    s_lshl_b32 s64, s64, 2
    s_add_u32 s64, s64, s3
    s_lshl_b32 s64, s64, 7
    s_add_u32 s64, s64, 1900544
    v_lshrrev_b32 v55, 2, v0
    v_mul_u32_u24 v55, 144, v55
    v_and_b32 v50, 24, v1
    v_add_u32 v55, v55, v50
    v_add_u32 v55, 117248, v55
    v_and_b32 v5, 1, v0
    v_mul_u32_u24 v5, 256, v5
    v_lshrrev_b32 v50, 4, v0
    v_lshl_add_u32 v5, v50, 3, v5
    v_add_u32 v5, 156928, v5
    s_waitcnt vmcnt(0)
    v_max_u32 v44, v10, v11
    v_max3_u32 v44, v44, v12, v13
    v_max3_u32 v44, v44, v14, v15
    v_max3_u32 v44, v44, v16, v17
    v_max3_u32 v44, v44, v18, v19
    v_cmp_eq_u32 vcc, -1, v44
    s_cbranch_vccz P29d
P29:
    buffer_load_dwordx2 v[18:19], v46, s[48:51], s60 offen offset:512 sc1
    buffer_load_dword v10, v47, s[48:51], s60 offen offset:0 sc1
    buffer_load_dword v11, v47, s[48:51], s60 offen offset:640 sc1
    buffer_load_dword v12, v47, s[48:51], s60 offen offset:1280 sc1
    buffer_load_dword v13, v47, s[48:51], s60 offen offset:1920 sc1
    buffer_load_dword v14, v47, s[48:51], s61 offen offset:0 sc1
    buffer_load_dword v15, v47, s[48:51], s61 offen offset:640 sc1
    buffer_load_dword v16, v47, s[48:51], s61 offen offset:1280 sc1
    buffer_load_dword v17, v47, s[48:51], s61 offen offset:1920 sc1
    s_waitcnt vmcnt(0)
    s_sub_u32 s6, s6, 1
    s_cselect_b32 s6, 0, s6
    s_cbranch_scc1 P29x
    v_max_u32 v44, v10, v11
    v_max3_u32 v44, v44, v12, v13
    v_max3_u32 v44, v44, v14, v15
    v_max3_u32 v44, v44, v16, v17
    v_max3_u32 v44, v44, v18, v19
    v_cmp_eq_u32 vcc, -1, v44
    s_cbranch_vccnz P29
P29x:
P29d:
    v_max_f32_dpp v20, v18, v18 quad_perm:[1,0,3,2] row_mask:0xf bank_mask:0xf
    s_nop 1
    v_max_f32_dpp v20, v20, v20 quad_perm:[2,3,0,1] row_mask:0xf bank_mask:0xf
    s_nop 1
    v_max_f32_dpp v20, v20, v20 row_half_mirror row_mask:0xf bank_mask:0xf
    v_sub_f32 v18, v18, v20
    v_exp_f32 v18, v18
    s_nop 0
    v_mul_f32 v19, v19, v18
    s_nop 0
    v_mul_f32_dpp v44, v18, v10 row_newbcast:0 row_mask:0xf bank_mask:0xf
    v_add_f32_dpp v19, v19, v19 quad_perm:[1,0,3,2] row_mask:0xf bank_mask:0xf
    v_fmac_f32_dpp v44, v18, v11 row_newbcast:1 row_mask:0xf bank_mask:0xf
    v_fmac_f32_dpp v44, v18, v12 row_newbcast:2 row_mask:0xf bank_mask:0xf
    v_add_f32_dpp v19, v19, v19 quad_perm:[2,3,0,1] row_mask:0xf bank_mask:0xf
    v_fmac_f32_dpp v44, v18, v13 row_newbcast:3 row_mask:0xf bank_mask:0xf
    v_fmac_f32_dpp v44, v18, v14 row_newbcast:4 row_mask:0xf bank_mask:0xf
    v_add_f32_dpp v19, v19, v19 row_half_mirror row_mask:0xf bank_mask:0xf
    v_fmac_f32_dpp v44, v18, v15 row_newbcast:5 row_mask:0xf bank_mask:0xf
    v_fmac_f32_dpp v44, v18, v16 row_newbcast:6 row_mask:0xf bank_mask:0xf
    v_rcp_f32 v19, v19
    v_fmac_f32_dpp v44, v18, v17 row_newbcast:7 row_mask:0xf bank_mask:0xf
    s_nop 0
    v_mul_f32_dpp v44, v19, v44 row_newbcast:0 row_mask:0xf bank_mask:0xf
    v_cvt_pk_bf16_f32 v44, v44, v44
    ds_write_b16 v45, v44
    v_lshl_add_u32 v47, s3, 5, v55
    ds_read_b64_tr_b16 v[28:29], v47 offset:0
    ds_read_b64_tr_b16 v[30:31], v47 offset:2304
    ds_read_b64_tr_b16 v[32:33], v47 offset:4608
    ds_read_b64_tr_b16 v[34:35], v47 offset:6912
    ds_read_b64_tr_b16 v[36:37], v47 offset:9216
    ds_read_b64_tr_b16 v[38:39], v47 offset:11520
    ds_read_b64_tr_b16 v[40:41], v47 offset:13824
    ds_read_b64_tr_b16 v[42:43], v47 offset:16128
    s_waitcnt lgkmcnt(8)
    s_barrier
    ds_read2_b64 v[10:13], v5 offset0:0 offset1:4
    ds_read2_b64 v[14:17], v5 offset0:8 offset1:12
    ds_read2_b64 v[18:21], v5 offset0:16 offset1:20
    ds_read2_b64 v[22:25], v5 offset0:24 offset1:28
    s_waitcnt lgkmcnt(0)
    v_mfma_f32_16x16x32_bf16 v[46:49], v[28:31], v[10:13], 0
    ds_read_b64_tr_b16 v[28:29], v55 offset:128
    ds_read_b64_tr_b16 v[30:31], v55 offset:2432
    v_mfma_f32_16x16x32_bf16 v[46:49], v[32:35], v[14:17], v[46:49]
    ds_read_b64_tr_b16 v[32:33], v55 offset:4736
    ds_read_b64_tr_b16 v[34:35], v55 offset:7040
    v_mfma_f32_16x16x32_bf16 v[46:49], v[36:39], v[18:21], v[46:49]
    ds_read_b64_tr_b16 v[36:37], v55 offset:9344
    ds_read_b64_tr_b16 v[38:39], v55 offset:11648
    v_mfma_f32_16x16x32_bf16 v[46:49], v[40:43], v[22:25], v[46:49]
    ds_read_b64_tr_b16 v[40:41], v55 offset:13952
    ds_read_b64_tr_b16 v[42:43], v55 offset:16256
    s_waitcnt lgkmcnt(0)
    v_mfma_f32_16x16x32_bf16 v[50:53], v[28:31], v[10:13], 0
    v_mfma_f32_16x16x32_bf16 v[50:53], v[32:35], v[14:17], v[50:53]
    v_mfma_f32_16x16x32_bf16 v[50:53], v[36:39], v[18:21], v[50:53]
    v_mfma_f32_16x16x32_bf16 v[50:53], v[40:43], v[22:25], v[50:53]
    s_nop 5
    s_mov_b32 vcc_lo, 0xc000c
    s_mov_b32 vcc_hi, 0xc000c
    v_cndmask_b32 v46, v46, v50, vcc
    v_cndmask_b32 v47, v47, v51, vcc
    v_cndmask_b32 v48, v48, v52, vcc
    v_cndmask_b32 v49, v49, v53, vcc
    buffer_store_dwordx4 v[46:49], v54, s[48:51], s64 offen sc1
    v_and_b32 v47, 15, v0
    v_bfe_u32 v44, v0, 3, 1
    v_mad_u32_u24 v46, v44, s3, v47
    v_lshlrev_b32 v46, 3, v46
    v_lshl_add_u32 v47, s3, 3, v47
    s_mul_i32 s7, s3, 7
    s_sub_u32 s7, 24, s7
    v_mad_u32_u24 v47, v44, s7, v47
    v_lshrrev_b32 v45, 5, v0
    v_lshlrev_b32 v45, 1, v45
    v_lshl_add_u32 v45, v47, 2, v45
    v_lshrrev_b32 v44, 4, v0
    v_lshl_add_u32 v46, v44, 12, v46
    s_mov_b32 vcc_lo, 0x1ff01ff
    s_mov_b32 vcc_hi, 0x1ff01ff
    v_bfrev_b32 v44, 1
    v_cndmask_b32 v46, v44, v46, vcc
    s_lshl_b32 s60, s5, 7
    s_add_u32 s60, s60, s3
    s_lshl_b32 s60, s60, 7
    s_add_u32 s60, s60, 1900544
    v_add_u32 v45, 156416, v45
    s_waitcnt vmcnt(0)
    buffer_load_dwordx2 v[10:11], v46, s[48:51], s60 offen offset:0 sc1
    buffer_load_dwordx2 v[12:13], v46, s[48:51], s60 offen offset:512 sc1
    buffer_load_dwordx2 v[14:15], v46, s[48:51], s60 offen offset:1024 sc1
    buffer_load_dwordx2 v[16:17], v46, s[48:51], s60 offen offset:1536 sc1
    buffer_load_dwordx2 v[18:19], v46, s[48:51], s60 offen offset:2048 sc1
    buffer_load_dwordx2 v[20:21], v46, s[48:51], s60 offen offset:2560 sc1
    buffer_load_dwordx2 v[22:23], v46, s[48:51], s60 offen offset:3072 sc1
    buffer_load_dwordx2 v[24:25], v46, s[48:51], s60 offen offset:3584 sc1
    v_and_b32 v48, 15, v0
    v_lshlrev_b32 v55, 1, v48
    s_mov_b32 s98, 0xa8888888
    v_lshrrev_b32_e64 v55, v55, s98
    v_and_b32 v55, 3, v55
    v_mul_u32_u24 v55, 160, v55
    v_lshrrev_b32 v49, 4, v0
    v_lshl_add_u32 v55, v49, 3, v55
    v_add_u32 v55, 156416, v55
    v_lshrrev_b32 v50, 1, v48
    v_and_b32 v52, 14, v48
    v_sub_u32 v48, v48, v52
    v_lshlrev_b32 v52, 31, v48
    v_lshl_add_u32 v52, v49, 4, v52
    v_lshl_add_u32 v52, v50, 6, v52
    s_mov_b32 s98, 6
    v_cmp_gt_u32 vcc, s98, v50
    v_or_b32 v48, 0x80000000, v52
    s_nop 0
    v_cndmask_b32 v52, v48, v52, vcc
    s_mul_i32 s64, s2, 1536
    s_mul_i32 s98, s3, 384
    s_add_u32 s64, s64, s98
    s_add_u32 s64, s64, 4128768
    v_lshrrev_b32 v54, 2, v0
    v_mul_u32_u24 v54, 288, v54
    v_and_b32 v48, 24, v1
    v_add_u32 v54, v54, v48
    s_lshr_b32 s98, s3, 1
    s_mul_i32 s98, s98, 20736
    s_and_b32 s99, s3, 1
    s_lshl_b32 s99, s99, 7
    s_add_u32 s98, s98, s99
    s_add_u32 s98, s98, 75776
    v_add_u32 v54, s98, v54
    s_waitcnt vmcnt(0)
    v_max_u32 v44, v10, v11
    v_max3_u32 v44, v44, v12, v13
    v_max3_u32 v44, v44, v14, v15
    v_max3_u32 v44, v44, v16, v17
    v_max3_u32 v44, v44, v18, v19
    v_max3_u32 v44, v44, v20, v21
    v_max3_u32 v44, v44, v22, v23
    v_max3_u32 v44, v44, v24, v25
    v_cmp_eq_u32 vcc, -1, v44
    s_cbranch_vccz P30d
P30:
    buffer_load_dwordx2 v[10:11], v46, s[48:51], s60 offen offset:0 sc1
    buffer_load_dwordx2 v[12:13], v46, s[48:51], s60 offen offset:512 sc1
    buffer_load_dwordx2 v[14:15], v46, s[48:51], s60 offen offset:1024 sc1
    buffer_load_dwordx2 v[16:17], v46, s[48:51], s60 offen offset:1536 sc1
    buffer_load_dwordx2 v[18:19], v46, s[48:51], s60 offen offset:2048 sc1
    buffer_load_dwordx2 v[20:21], v46, s[48:51], s60 offen offset:2560 sc1
    buffer_load_dwordx2 v[22:23], v46, s[48:51], s60 offen offset:3072 sc1
    buffer_load_dwordx2 v[24:25], v46, s[48:51], s60 offen offset:3584 sc1
    s_waitcnt vmcnt(0)
    s_sub_u32 s6, s6, 1
    s_cselect_b32 s6, 0, s6
    s_cbranch_scc1 P30x
    v_max_u32 v44, v10, v11
    v_max3_u32 v44, v44, v12, v13
    v_max3_u32 v44, v44, v14, v15
    v_max3_u32 v44, v44, v16, v17
    v_max3_u32 v44, v44, v18, v19
    v_max3_u32 v44, v44, v20, v21
    v_max3_u32 v44, v44, v22, v23
    v_max3_u32 v44, v44, v24, v25
    v_cmp_eq_u32 vcc, -1, v44
    s_cbranch_vccnz P30
P30x:
P30d:
    v_add_f32 v10, v10, v12
    v_add_f32 v11, v11, v13
    v_add_f32 v14, v14, v16
    v_add_f32 v15, v15, v17
    v_add_f32 v18, v18, v20
    v_add_f32 v19, v19, v21
    v_add_f32 v22, v22, v24
    v_add_f32 v23, v23, v25
    v_add_f32 v10, v10, v14
    v_add_f32 v11, v11, v15
    v_add_f32 v18, v18, v22
    v_add_f32 v19, v19, v23
    v_add_f32 v10, v10, v18
    v_add_f32 v11, v11, v19
    v_and_b32 v47, 0xffff0000, v4
    s_nop 0
    v_permlane32_swap_b32 v10, v11
    v_add_f32 v26, v10, v11
    v_add_f32 v27, v10, v11
    s_nop 1
    v_permlane16_swap_b32 v26, v27
    s_mov_b32 exec_lo, 0x1ff0000
    s_mov_b32 exec_hi, 0x1ff0000
    v_add_f32 v26, v26, v27
    v_add_f32 v26, v26, v47
    v_cvt_pk_bf16_f32 v4, v26, v26
    ds_write_b16 v45, v4
    s_mov_b64 exec, -1
    ds_read_b64_tr_b16 v[20:21], v54 offset:0
    ds_read_b64_tr_b16 v[22:23], v54 offset:4608
    ds_read_b64_tr_b16 v[24:25], v54 offset:9216
    ds_read_b64_tr_b16 v[26:27], v54 offset:13824
    ds_read_b64_tr_b16 v[28:29], v54 offset:18432
    ds_read_b64_tr_b16 v[30:31], v54 offset:32
    ds_read_b64_tr_b16 v[32:33], v54 offset:4640
    ds_read_b64_tr_b16 v[34:35], v54 offset:9248
    ds_read_b64_tr_b16 v[36:37], v54 offset:13856
    ds_read_b64_tr_b16 v[38:39], v54 offset:18464
    s_waitcnt lgkmcnt(10)
    s_barrier
    ds_read2_b64 v[10:13], v55 offset0:0 offset1:4
    ds_read2_b64 v[14:17], v55 offset0:8 offset1:12
    ds_read_b64 v[18:19], v55 offset:128
    s_waitcnt lgkmcnt(0)
    v_mfma_f32_16x16x32_bf16 v[40:43], v[10:13], v[10:13], 0
    v_mfma_f32_16x16x32_bf16 v[44:47], v[20:23], v[10:13], 0
    v_mfma_f32_16x16x32_bf16 v[48:51], v[30:33], v[10:13], 0
    v_mfma_f32_16x16x32_bf16 v[40:43], v[14:17], v[14:17], v[40:43]
    v_mfma_f32_16x16x32_bf16 v[44:47], v[24:27], v[14:17], v[44:47]
    v_mfma_f32_16x16x32_bf16 v[48:51], v[34:37], v[14:17], v[48:51]
    s_nop 4
    v_mfma_f32_16x16x16_bf16 v[40:43], v[18:19], v[18:19], v[40:43]
    v_mfma_f32_16x16x16_bf16 v[44:47], v[28:29], v[18:19], v[44:47]
    v_mfma_f32_16x16x16_bf16 v[48:51], v[38:39], v[18:19], v[48:51]
    ds_read_b64_tr_b16 v[20:21], v54 offset:64
    ds_read_b64_tr_b16 v[22:23], v54 offset:4672
    ds_read_b64_tr_b16 v[24:25], v54 offset:9280
    ds_read_b64_tr_b16 v[26:27], v54 offset:13888
    ds_read_b64_tr_b16 v[28:29], v54 offset:18496
    ds_read_b64_tr_b16 v[30:31], v54 offset:96
    ds_read_b64_tr_b16 v[32:33], v54 offset:4704
    ds_read_b64_tr_b16 v[34:35], v54 offset:9312
    ds_read_b64_tr_b16 v[36:37], v54 offset:13920
    ds_read_b64_tr_b16 v[38:39], v54 offset:18528
    s_mov_b32 vcc_lo, 0x30003
    s_mov_b32 vcc_hi, 0x30003
    v_cndmask_b32 v40, v40, v44, vcc
    v_cndmask_b32 v41, v41, v45, vcc
    v_cndmask_b32 v42, v42, v46, vcc
    v_cndmask_b32 v43, v43, v47, vcc
    s_mov_b32 vcc_lo, 0xc000c
    s_mov_b32 vcc_hi, 0xc000c
    v_cndmask_b32 v40, v40, v48, vcc
    v_cndmask_b32 v41, v41, v49, vcc
    v_cndmask_b32 v42, v42, v50, vcc
    v_cndmask_b32 v43, v43, v51, vcc
    s_waitcnt lgkmcnt(0)
    v_mfma_f32_16x16x32_bf16 v[44:47], v[20:23], v[10:13], 0
    v_mfma_f32_16x16x32_bf16 v[48:51], v[30:33], v[10:13], 0
    v_mfma_f32_16x16x32_bf16 v[44:47], v[24:27], v[14:17], v[44:47]
    v_mfma_f32_16x16x32_bf16 v[48:51], v[34:37], v[14:17], v[48:51]
    s_nop 5
    v_mfma_f32_16x16x16_bf16 v[44:47], v[28:29], v[18:19], v[44:47]
    v_mfma_f32_16x16x16_bf16 v[48:51], v[38:39], v[18:19], v[48:51]
    ds_read_b64_tr_b16 v[20:21], v54 offset:128
    ds_read_b64_tr_b16 v[22:23], v54 offset:4736
    ds_read_b64_tr_b16 v[24:25], v54 offset:9344
    ds_read_b64_tr_b16 v[26:27], v54 offset:13952
    ds_read_b64_tr_b16 v[28:29], v54 offset:18560
    s_nop 0
    s_mov_b32 vcc_lo, 0x300030
    s_mov_b32 vcc_hi, 0x300030
    v_cndmask_b32 v40, v40, v44, vcc
    v_cndmask_b32 v41, v41, v45, vcc
    v_cndmask_b32 v42, v42, v46, vcc
    v_cndmask_b32 v43, v43, v47, vcc
    s_mov_b32 vcc_lo, 0xc000c0
    s_mov_b32 vcc_hi, 0xc000c0
    v_cndmask_b32 v40, v40, v48, vcc
    v_cndmask_b32 v41, v41, v49, vcc
    v_cndmask_b32 v42, v42, v50, vcc
    v_cndmask_b32 v43, v43, v51, vcc
    s_waitcnt lgkmcnt(0)
    v_mfma_f32_16x16x32_bf16 v[44:47], v[20:23], v[10:13], 0
    v_mfma_f32_16x16x32_bf16 v[44:47], v[24:27], v[14:17], v[44:47]
    s_nop 6
    v_mfma_f32_16x16x16_bf16 v[44:47], v[28:29], v[18:19], v[44:47]
    s_nop 5
    s_mov_b32 vcc_lo, 0x3000300
    s_mov_b32 vcc_hi, 0x3000300
    v_cndmask_b32 v40, v40, v44, vcc
    v_cndmask_b32 v41, v41, v45, vcc
    v_cndmask_b32 v42, v42, v46, vcc
    v_cndmask_b32 v43, v43, v47, vcc
    s_cmp_eq_u32 s97, 0
    s_cbranch_scc1 Y31
    buffer_store_dwordx4 v[40:43], v52, s[48:51], s64 offen
Y31d:
    v_and_b32 v51, 15, v0
    s_mul_i32 s7, s3, 9
    v_add_u32 v51, s7, v51
    v_cmp_lt_u32 vcc, 19, v51
    v_lshrrev_b32 v53, 4, v0
    v_mul_u32_u24 v52, 768, v53
    v_lshl_add_u32 v52, v51, 4, v52
    v_add_u32 v50, 128, v52
    v_cndmask_b32 v52, v52, v50, vcc
    s_mov_b32 vcc_lo, 0x1ff01ff
    s_mov_b32 vcc_hi, 0x1ff01ff
    v_bfrev_b32 v50, 1
    v_cndmask_b32 v52, v50, v52, vcc
    v_bfrev_b32 v53, v53
    v_lshrrev_b32 v53, 29, v53
    v_lshl_add_u32 v51, v51, 3, v53
    v_add_u32 v51, 157440, v51
    v_mul_u32_u24 v53, 1536, v0
    v_cmp_gt_u32 vcc, 8, v0
    v_or_b32 v50, 0x80000000, v53
    s_nop 0
    v_cndmask_b32 v53, v50, v53, vcc
    s_mul_i32 s7, s4, 12288
    s_add_u32 s60, s7, 4128768
    s_add_u32 s61, s7, 4134912
    s_waitcnt vmcnt(0)
    buffer_load_dwordx4 v[46:49], v53, s[48:51], s60 offen offset:368 sc1
    buffer_load_dwordx4 v[10:13], v52, s[48:51], s60 offen offset:0 sc1
    buffer_load_dwordx4 v[14:17], v52, s[48:51], s60 offen offset:3072 sc1
    buffer_load_dwordx4 v[18:21], v52, s[48:51], s61 offen offset:0 sc1
    buffer_load_dwordx4 v[22:25], v52, s[48:51], s61 offen offset:3072 sc1
    v_and_b32 v50, 1, v0
    v_lshlrev_b32 v54, 31, v50
    v_and_b32 v50, 2, v0
    v_lshl_add_u32 v54, v50, 5, v54
    v_and_b32 v50, 48, v0
    v_add_u32 v54, v54, v50
    s_mov_b32 vcc_lo, 0xf000f
    s_mov_b32 vcc_hi, 0xf000f
    v_bfrev_b32 v50, 1
    v_cndmask_b32 v54, v50, v54, vcc
    s_lshl_b32 s64, s5, 5
    s_add_u32 s64, s64, s4
    s_lshl_b32 s64, s64, 2
    s_add_u32 s64, s64, s3
    s_lshl_b32 s64, s64, 7
    s_add_u32 s64, s64, 2424832
    v_lshrrev_b32 v55, 2, v0
    v_mul_u32_u24 v55, 144, v55
    v_and_b32 v50, 24, v1
    v_add_u32 v55, v55, v50
    v_add_u32 v55, 135680, v55
    v_and_b32 v5, 1, v0
    v_mul_u32_u24 v5, 288, v5
    v_lshrrev_b32 v50, 4, v0
    v_lshl_add_u32 v5, v50, 3, v5
    v_add_u32 v5, 157440, v5
    s_waitcnt vmcnt(0)
    v_max_u32 v50, v46, v48
    v_max3_u32 v50, v50, v10, v11
    v_max3_u32 v50, v50, v12, v13
    v_max3_u32 v50, v50, v14, v15
    v_max3_u32 v50, v50, v16, v17
    v_max3_u32 v50, v50, v18, v19
    v_max3_u32 v50, v50, v20, v21
    v_max3_u32 v50, v50, v22, v23
    v_max3_u32 v50, v50, v24, v25
    v_cmp_eq_u32 vcc, -1, v50
    s_cbranch_vccz P32d
P32:
    buffer_load_dwordx4 v[46:49], v53, s[48:51], s60 offen offset:368 sc1
    buffer_load_dwordx4 v[10:13], v52, s[48:51], s60 offen offset:0 sc1
    buffer_load_dwordx4 v[14:17], v52, s[48:51], s60 offen offset:3072 sc1
    buffer_load_dwordx4 v[18:21], v52, s[48:51], s61 offen offset:0 sc1
    buffer_load_dwordx4 v[22:25], v52, s[48:51], s61 offen offset:3072 sc1
    s_waitcnt vmcnt(0)
    s_sub_u32 s6, s6, 1
    s_cselect_b32 s6, 0, s6
    s_cbranch_scc1 P32x
    v_max_u32 v50, v46, v48
    v_max3_u32 v50, v50, v10, v11
    v_max3_u32 v50, v50, v12, v13
    v_max3_u32 v50, v50, v14, v15
    v_max3_u32 v50, v50, v16, v17
    v_max3_u32 v50, v50, v18, v19
    v_max3_u32 v50, v50, v20, v21
    v_max3_u32 v50, v50, v22, v23
    v_max3_u32 v50, v50, v24, v25
    v_cmp_eq_u32 vcc, -1, v50
    s_cbranch_vccnz P32
P32x:
P32d:
    v_add_f32 v10, v10, v14
    v_add_f32 v11, v11, v15
    v_add_f32_dpp v46, v46, v46 quad_perm:[1,0,3,2] row_mask:0xf bank_mask:0xf
    v_add_f32 v12, v12, v16
    v_add_f32_dpp v48, v48, v48 quad_perm:[1,0,3,2] row_mask:0xf bank_mask:0xf
    v_add_f32 v13, v13, v17
    v_add_f32_dpp v46, v46, v46 quad_perm:[2,3,0,1] row_mask:0xf bank_mask:0xf
    v_add_f32 v18, v18, v22
    v_add_f32_dpp v48, v48, v48 quad_perm:[2,3,0,1] row_mask:0xf bank_mask:0xf
    v_add_f32 v19, v19, v23
    v_add_f32_dpp v46, v46, v46 row_half_mirror row_mask:0xf bank_mask:0xf
    v_add_f32 v20, v20, v24
    v_add_f32_dpp v48, v48, v48 row_half_mirror row_mask:0xf bank_mask:0xf
    v_add_f32 v21, v21, v25
    v_mul_f32 v48, 0x3ae38e39, v48
    v_add_f32 v10, v10, v18
    v_mul_f32 v46, 0x3ae38e39, v46
    v_add_f32 v11, v11, v19
    v_fma_f32 v46, -v48, v48, v46
    v_add_f32 v12, v12, v20
    v_max_f32 v46, 0, v46
    v_add_f32 v13, v13, v21
    v_add_f32 v46, 0x3727c5ac, v46
    v_permlane32_swap_b32 v10, v11
    v_rsq_f32 v46, v46
    v_permlane32_swap_b32 v12, v13
    v_readfirstlane_b32 s0, v48
    v_add_f32 v10, v10, v11
    v_readfirstlane_b32 s1, v46
    v_add_f32 v11, v12, v13
    s_nop 1
    v_permlane16_swap_b32 v10, v11
    v_fma_f32 v10, -s0, v6, v10
    v_mul_f32 v10, s1, v10
    v_fma_f32 v11, -s0, v7, v11
    v_mul_f32 v11, s1, v11
    v_mul_f32 v12, v10, v10
    v_mov_b32 v13, 0xc0135761
    v_fmac_f32 v13, 0xbdd2d3e8, v12
    v_mul_f32 v13, v13, v10
    v_exp_f32 v13, v13
    v_mul_f32 v10, v10, v11
    v_add_f32 v13, 1.0, v13
    v_rcp_f32 v13, v13
    s_nop 0
    v_mul_f32 v50, v10, v13
    v_cvt_pk_bf16_f32 v50, v50, v50
    s_mov_b32 exec_lo, 0x1ff01ff
    s_mov_b32 exec_hi, 0x1ff01ff
    ds_write_b16 v51, v50
    s_mov_b64 exec, -1
    v_lshl_add_u32 v47, s3, 5, v55
    ds_read_b64_tr_b16 v[28:29], v47 offset:0
    ds_read_b64_tr_b16 v[30:31], v47 offset:2304
    ds_read_b64_tr_b16 v[32:33], v47 offset:4608
    ds_read_b64_tr_b16 v[34:35], v47 offset:6912
    ds_read_b64_tr_b16 v[36:37], v47 offset:9216
    ds_read_b64_tr_b16 v[38:39], v47 offset:11520
    ds_read_b64_tr_b16 v[40:41], v47 offset:13824
    ds_read_b64_tr_b16 v[42:43], v47 offset:16128
    ds_read_b64_tr_b16 v[44:45], v47 offset:18432
    s_waitcnt lgkmcnt(9)
    s_barrier
    ds_read2_b64 v[10:13], v5 offset0:0 offset1:4
    ds_read2_b64 v[14:17], v5 offset0:8 offset1:12
    ds_read2_b64 v[18:21], v5 offset0:16 offset1:20
    ds_read2_b64 v[22:25], v5 offset0:24 offset1:28
    ds_read_b64 v[26:27], v5 offset:256
    s_waitcnt lgkmcnt(0)
    v_mfma_f32_16x16x32_bf16 v[46:49], v[28:31], v[10:13], 0
    ds_read_b64_tr_b16 v[28:29], v55 offset:128
    ds_read_b64_tr_b16 v[30:31], v55 offset:2432
    v_mfma_f32_16x16x32_bf16 v[46:49], v[32:35], v[14:17], v[46:49]
    ds_read_b64_tr_b16 v[32:33], v55 offset:4736
    ds_read_b64_tr_b16 v[34:35], v55 offset:7040
    v_mfma_f32_16x16x32_bf16 v[46:49], v[36:39], v[18:21], v[46:49]
    ds_read_b64_tr_b16 v[36:37], v55 offset:9344
    ds_read_b64_tr_b16 v[38:39], v55 offset:11648
    v_mfma_f32_16x16x32_bf16 v[46:49], v[40:43], v[22:25], v[46:49]
    ds_read_b64_tr_b16 v[40:41], v55 offset:13952
    ds_read_b64_tr_b16 v[42:43], v55 offset:16256
    s_nop 6
    v_mfma_f32_16x16x16_bf16 v[46:49], v[44:45], v[26:27], v[46:49]
    ds_read_b64_tr_b16 v[44:45], v55 offset:18560
    s_waitcnt lgkmcnt(0)
    v_mfma_f32_16x16x32_bf16 v[50:53], v[28:31], v[10:13], 0
    v_mfma_f32_16x16x32_bf16 v[50:53], v[32:35], v[14:17], v[50:53]
    v_mfma_f32_16x16x32_bf16 v[50:53], v[36:39], v[18:21], v[50:53]
    v_mfma_f32_16x16x32_bf16 v[50:53], v[40:43], v[22:25], v[50:53]
    s_nop 6
    v_mfma_f32_16x16x16_bf16 v[50:53], v[44:45], v[26:27], v[50:53]
    s_nop 5
    s_mov_b32 vcc_lo, 0xc000c
    s_mov_b32 vcc_hi, 0xc000c
    v_cndmask_b32 v46, v46, v50, vcc
    v_cndmask_b32 v47, v47, v51, vcc
    v_cndmask_b32 v48, v48, v52, vcc
    v_cndmask_b32 v49, v49, v53, vcc
    buffer_store_dwordx4 v[46:49], v54, s[48:51], s64 offen sc1
    s_lshl_b32 s7, s5, 2
    s_cmp_lg_u32 s4, s7
    s_cbranch_scc1 L_f0
    v_and_b32 v47, 15, v0
    v_bfe_u32 v44, v0, 3, 1
    v_mad_u32_u24 v46, v44, s3, v47
    v_lshlrev_b32 v46, 3, v46
    v_lshl_add_u32 v47, s3, 3, v47
    s_mul_i32 s7, s3, 7
    s_sub_u32 s7, 24, s7
    v_mad_u32_u24 v47, v44, s7, v47
    v_lshrrev_b32 v45, 5, v0
    v_lshlrev_b32 v45, 1, v45
    v_lshl_add_u32 v45, v47, 2, v45
    v_bfe_u32 v44, v0, 4, 1
    v_mul_u32_u24 v44, 1152, v44
    v_add_u32 v45, v45, v44
    v_lshrrev_b32 v44, 4, v0
    v_lshl_add_u32 v46, v44, 12, v46
    s_mov_b32 vcc_lo, 0x1ff01ff
    s_mov_b32 vcc_hi, 0x1ff01ff
    v_bfrev_b32 v44, 1
    v_cndmask_b32 v46, v44, v46, vcc
    s_lshl_b32 s60, s5, 7
    s_add_u32 s60, s60, s3
    s_lshl_b32 s60, s60, 7
    s_add_u32 s60, s60, 2424832
    s_mul_i32 s7, s5, 144
    s_waitcnt vmcnt(0)
    buffer_load_dwordx2 v[10:11], v46, s[48:51], s60 offen offset:0 sc1
    buffer_load_dwordx2 v[12:13], v46, s[48:51], s60 offen offset:512 sc1
    buffer_load_dwordx2 v[14:15], v46, s[48:51], s60 offen offset:1024 sc1
    buffer_load_dwordx2 v[16:17], v46, s[48:51], s60 offen offset:1536 sc1
    buffer_load_dwordx2 v[18:19], v46, s[48:51], s60 offen offset:2048 sc1
    buffer_load_dwordx2 v[20:21], v46, s[48:51], s60 offen offset:2560 sc1
    buffer_load_dwordx2 v[22:23], v46, s[48:51], s60 offen offset:3072 sc1
    buffer_load_dwordx2 v[24:25], v46, s[48:51], s60 offen offset:3584 sc1
    s_waitcnt vmcnt(0)
    v_max_u32 v44, v10, v11
    v_max3_u32 v44, v44, v12, v13
    v_max3_u32 v44, v44, v14, v15
    v_max3_u32 v44, v44, v16, v17
    v_max3_u32 v44, v44, v18, v19
    v_max3_u32 v44, v44, v20, v21
    v_max3_u32 v44, v44, v22, v23
    v_max3_u32 v44, v44, v24, v25
    v_cmp_eq_u32 vcc, -1, v44
    s_cbranch_vccz P33d
P33:
    buffer_load_dwordx2 v[10:11], v46, s[48:51], s60 offen offset:0 sc1
    buffer_load_dwordx2 v[12:13], v46, s[48:51], s60 offen offset:512 sc1
    buffer_load_dwordx2 v[14:15], v46, s[48:51], s60 offen offset:1024 sc1
    buffer_load_dwordx2 v[16:17], v46, s[48:51], s60 offen offset:1536 sc1
    buffer_load_dwordx2 v[18:19], v46, s[48:51], s60 offen offset:2048 sc1
    buffer_load_dwordx2 v[20:21], v46, s[48:51], s60 offen offset:2560 sc1
    buffer_load_dwordx2 v[22:23], v46, s[48:51], s60 offen offset:3072 sc1
    buffer_load_dwordx2 v[24:25], v46, s[48:51], s60 offen offset:3584 sc1
    s_waitcnt vmcnt(0)
    s_sub_u32 s6, s6, 1
    s_cselect_b32 s6, 0, s6
    s_cbranch_scc1 P33x
    v_max_u32 v44, v10, v11
    v_max3_u32 v44, v44, v12, v13
    v_max3_u32 v44, v44, v14, v15
    v_max3_u32 v44, v44, v16, v17
    v_max3_u32 v44, v44, v18, v19
    v_max3_u32 v44, v44, v20, v21
    v_max3_u32 v44, v44, v22, v23
    v_max3_u32 v44, v44, v24, v25
    v_cmp_eq_u32 vcc, -1, v44
    s_cbranch_vccnz P33
P33x:
P33d:
    v_add_f32 v10, v10, v12
    v_add_f32 v11, v11, v13
    v_add_f32 v14, v14, v16
    v_add_f32 v15, v15, v17
    v_add_f32 v18, v18, v20
    v_add_f32 v19, v19, v21
    v_add_f32 v22, v22, v24
    v_add_f32 v23, v23, v25
    v_add_f32 v10, v10, v14
    v_add_f32 v11, v11, v15
    v_add_f32 v18, v18, v22
    v_add_f32 v19, v19, v23
    v_add_f32 v10, v10, v18
    v_add_f32 v11, v11, v19
    v_and_b32 v47, 0xffff0000, v4
    s_nop 0
    v_permlane32_swap_b32 v10, v11
    v_add_f32 v26, v10, v11
    v_add_f32 v27, v10, v11
    s_nop 1
    v_permlane16_swap_b32 v26, v27
    s_mov_b32 exec_lo, 0x1ff0000
    s_mov_b32 exec_hi, 0x1ff0000
    v_add_f32 v26, v26, v27
    v_add_f32 v26, v26, v47
    v_cvt_pk_bf16_f32 v4, v26, v26
    buffer_store_short v4, v45, s[40:43], s7 offen
    s_mov_b64 exec, -1
    s_branch L_fin
L_f0:
    s_add_u32 s7, s7, 1
    s_cmp_lg_u32 s4, s7
    s_cbranch_scc1 L_fin
    v_and_b32 v47, 15, v0
    v_bfe_u32 v44, v0, 3, 1
    v_mad_u32_u24 v46, v44, s3, v47
    v_lshlrev_b32 v46, 3, v46
    v_lshl_add_u32 v47, s3, 3, v47
    s_mul_i32 s7, s3, 7
    s_sub_u32 s7, 24, s7
    v_mad_u32_u24 v47, v44, s7, v47
    v_lshrrev_b32 v45, 5, v0
    v_lshlrev_b32 v45, 1, v45
    v_lshl_add_u32 v45, v47, 2, v45
    v_bfe_u32 v44, v0, 4, 1
    v_mul_u32_u24 v44, 1152, v44
    v_add_u32 v45, v45, v44
    v_lshrrev_b32 v44, 4, v0
    v_lshl_add_u32 v46, v44, 12, v46
    s_mov_b32 vcc_lo, 0x1ff01ff
    s_mov_b32 vcc_hi, 0x1ff01ff
    v_bfrev_b32 v44, 1
    v_cndmask_b32 v46, v44, v46, vcc
    s_lshl_b32 s60, s5, 7
    s_add_u32 s60, s60, s3
    s_lshl_b32 s60, s60, 7
    s_add_u32 s60, s60, 2293760
    s_mul_i32 s7, s5, 144
    s_waitcnt vmcnt(0)
    buffer_load_dwordx2 v[10:11], v46, s[48:51], s60 offen offset:0 sc1
    buffer_load_dwordx2 v[12:13], v46, s[48:51], s60 offen offset:512 sc1
    buffer_load_dwordx2 v[14:15], v46, s[48:51], s60 offen offset:1024 sc1
    buffer_load_dwordx2 v[16:17], v46, s[48:51], s60 offen offset:1536 sc1
    buffer_load_dwordx2 v[18:19], v46, s[48:51], s60 offen offset:2048 sc1
    buffer_load_dwordx2 v[20:21], v46, s[48:51], s60 offen offset:2560 sc1
    buffer_load_dwordx2 v[22:23], v46, s[48:51], s60 offen offset:3072 sc1
    buffer_load_dwordx2 v[24:25], v46, s[48:51], s60 offen offset:3584 sc1
    s_waitcnt vmcnt(0)
    v_max_u32 v44, v10, v11
    v_max3_u32 v44, v44, v12, v13
    v_max3_u32 v44, v44, v14, v15
    v_max3_u32 v44, v44, v16, v17
    v_max3_u32 v44, v44, v18, v19
    v_max3_u32 v44, v44, v20, v21
    v_max3_u32 v44, v44, v22, v23
    v_max3_u32 v44, v44, v24, v25
    v_cmp_eq_u32 vcc, -1, v44
    s_cbranch_vccz P34d
P34:
    buffer_load_dwordx2 v[10:11], v46, s[48:51], s60 offen offset:0 sc1
    buffer_load_dwordx2 v[12:13], v46, s[48:51], s60 offen offset:512 sc1
    buffer_load_dwordx2 v[14:15], v46, s[48:51], s60 offen offset:1024 sc1
    buffer_load_dwordx2 v[16:17], v46, s[48:51], s60 offen offset:1536 sc1
    buffer_load_dwordx2 v[18:19], v46, s[48:51], s60 offen offset:2048 sc1
    buffer_load_dwordx2 v[20:21], v46, s[48:51], s60 offen offset:2560 sc1
    buffer_load_dwordx2 v[22:23], v46, s[48:51], s60 offen offset:3072 sc1
    buffer_load_dwordx2 v[24:25], v46, s[48:51], s60 offen offset:3584 sc1
    s_waitcnt vmcnt(0)
    s_sub_u32 s6, s6, 1
    s_cselect_b32 s6, 0, s6
    s_cbranch_scc1 P34x
    v_max_u32 v44, v10, v11
    v_max3_u32 v44, v44, v12, v13
    v_max3_u32 v44, v44, v14, v15
    v_max3_u32 v44, v44, v16, v17
    v_max3_u32 v44, v44, v18, v19
    v_max3_u32 v44, v44, v20, v21
    v_max3_u32 v44, v44, v22, v23
    v_max3_u32 v44, v44, v24, v25
    v_cmp_eq_u32 vcc, -1, v44
    s_cbranch_vccnz P34
P34x:
P34d:
    v_add_f32 v10, v10, v12
    v_add_f32 v11, v11, v13
    v_add_f32 v14, v14, v16
    v_add_f32 v15, v15, v17
    v_add_f32 v18, v18, v20
    v_add_f32 v19, v19, v21
    v_add_f32 v22, v22, v24
    v_add_f32 v23, v23, v25
    v_add_f32 v10, v10, v14
    v_add_f32 v11, v11, v15
    v_add_f32 v18, v18, v22
    v_add_f32 v19, v19, v23
    v_add_f32 v10, v10, v18
    v_add_f32 v11, v11, v19
    v_and_b32 v47, 0xffff0000, v4
    s_nop 0
    v_permlane32_swap_b32 v10, v11
    v_add_f32 v26, v10, v11
    v_add_f32 v27, v10, v11
    s_nop 1
    v_permlane16_swap_b32 v26, v27
    s_mov_b32 exec_lo, 0x1ff
    s_mov_b32 exec_hi, 0x1ff
    v_add_f32 v26, v26, v27
    v_add_f32 v26, v26, v47
    v_cvt_pk_bf16_f32 v4, v26, v26
    buffer_store_short v4, v45, s[40:43], s7 offen
    s_mov_b64 exec, -1
L_fin:
L_x:
    s_endpgm
Y6:
    buffer_store_dwordx4 v[12:15], v54, s[48:51], s64 offen sc1
    buffer_store_dwordx2 v[10:11], v23, s[48:51], s64 offen offset:512 sc1
    s_branch Y6d
Y9:
    buffer_store_dwordx4 v[40:43], v52, s[48:51], s64 offen sc1
    s_branch Y9d
Y12:
    buffer_store_dwordx4 v[40:43], v52, s[48:51], s64 offen sc1
    s_branch Y12d
Y14:
    buffer_store_dwordx4 v[12:15], v54, s[48:51], s64 offen sc1
    buffer_store_dwordx2 v[10:11], v23, s[48:51], s64 offen offset:512 sc1
    s_branch Y14d
Y17:
    buffer_store_dwordx4 v[40:43], v52, s[48:51], s64 offen sc1
    s_branch Y17d
Y20:
    buffer_store_dwordx4 v[12:15], v54, s[48:51], s64 offen sc1
    buffer_store_dwordx2 v[10:11], v23, s[48:51], s64 offen offset:512 sc1
    s_branch Y20d
Y23:
    buffer_store_dwordx4 v[40:43], v52, s[48:51], s64 offen sc1
    s_branch Y23d
Y26:
    buffer_store_dwordx4 v[40:43], v52, s[48:51], s64 offen sc1
    s_branch Y26d
Y28:
    buffer_store_dwordx4 v[12:15], v54, s[48:51], s64 offen sc1
    buffer_store_dwordx2 v[10:11], v23, s[48:51], s64 offen offset:512 sc1
    s_branch Y28d
Y31:
    buffer_store_dwordx4 v[40:43], v52, s[48:51], s64 offen sc1
    s_branch Y31d
L_end:
s_endpgm
.section .rodata,"a"
.p2align 6
.amdhsa_kernel interleave_layers__mha_block_cached__glu_gated_geglu__decode_kernel
  .amdhsa_next_free_vgpr 512
  .amdhsa_next_free_sgpr 102
  .amdhsa_accum_offset 256
  .amdhsa_group_segment_fixed_size 0
  .amdhsa_kernarg_size 96
  .amdhsa_user_sgpr_count 2
  .amdhsa_user_sgpr_kernarg_segment_ptr 1
  .amdhsa_system_sgpr_workgroup_id_x 1
.end_amdhsa_kernel
```
